```python
import torch

def _softmax(x, axis=-1):
    return torch.softmax(x, dim=axis)
def _gelu(x):
    return torch.nn.functional.gelu(x, approximate="tanh")
def _silu(x):
    return torch.nn.functional.silu(x)
def _sigmoid(x):
    return torch.sigmoid(x)
def _layernorm(x, axis=-1, eps=1e-5):
    m = x.mean(dim=axis, keepdim=True)
    v = x.var(dim=axis, keepdim=True, unbiased=False)
    return (x - m) / torch.sqrt(v + eps)
def _scatter_add(tgt, idx, src, axis=0):
    return tgt.clone().index_add_(axis, idx, src)
def _segment_sum(src, seg, n):
    out = torch.zeros((n,) + src.shape[1:], dtype=src.dtype)
    return out.index_add_(0, seg, src)
def _pad(x, pw):
    flat = tuple(v for pair in reversed(pw) for v in pair)
    return torch.nn.functional.pad(x, flat)

kernel_name = 'interleave_layers__gqa_block_cached__glu_gated_reglu__decode'

def setup_inputs():

    _w = (lambda a: (lambda t: t.to(torch.bfloat16) if t.is_floating_point() else t)(torch.as_tensor(a)))
    def _A_setup():
        B, Sq, D = 1, 1, 576
        Hq, Hkv, Sk, Dh = 32, 16, 65536, 128
        assert Hq % Hkv == 0, (Hq, Hkv)
        return {
            "x": _w((lambda *s: torch.randn(*s, dtype=torch.bfloat16) * 0.05)(B, Sq, D)),
            "k_cache": _w((lambda *s: torch.randn(*s, dtype=torch.bfloat16) * 0.8)(B, Hkv, Sk, Dh)),
            "v_cache": _w((lambda *s: torch.randn(*s, dtype=torch.bfloat16) * 1.6)(B, Hkv, Sk, Dh)),
            "wq": _w((lambda *s: torch.randn(*s, dtype=torch.bfloat16) * 0.8)(D, Hq * Dh) * (D ** -0.5)),
            "wo": _w((lambda *s: torch.randn(*s, dtype=torch.bfloat16) * 1.6)(Hq * Dh, D) * ((Hq * Dh) ** -0.5)),
        }
    _A_in = _A_setup()

    def _B_setup():
        B, S, D, F = 1, 1, 576, 4608
        return {
            "x": _w((lambda *s: torch.randn(*s, dtype=torch.bfloat16) * 0.05)(B, S, D)),
            "W_gate": _w((lambda *s: torch.randn(*s, dtype=torch.bfloat16) * 0.4)(D, F) * (2.0 / D) ** 0.5),
            "W_up": _w((lambda *s: torch.randn(*s, dtype=torch.bfloat16) * 0.4)(D, F) * (2.0 / D) ** 0.5),
            "W_down": _w((lambda *s: torch.randn(*s, dtype=torch.bfloat16) * 0.4)(F, D) * (1.0 / F) ** 0.5),
        }
    _B_in = _B_setup()

    return {
        "A_x": _A_in["x"],
        "A_k_cache": _A_in["k_cache"],
        "A_v_cache": _A_in["v_cache"],
        "A_wq": _A_in["wq"],
        "A_wo": _A_in["wo"],
        "B_x": _B_in["x"],
        "B_W_gate": _B_in["W_gate"],
        "B_W_up": _B_in["W_up"],
        "B_W_down": _B_in["W_down"],
    }

def reference(A_x, A_k_cache, A_v_cache, A_wq, A_wo, B_x, B_W_gate, B_W_up, B_W_down):
    def _A_ref(x, k_cache, v_cache, wq, wo):
        B, Sq, D = x.shape
        Hq, Dh = 32, 128
        Hkv = k_cache.shape[1]
        rep = Hq // Hkv
        q = (lambda x, *d: x.permute(*d))((x @ wq).reshape(B, Sq, Hq, Dh), 0, 2, 1, 3)
        k = (lambda x, n, axis: torch.repeat_interleave(x, n, dim=axis))(k_cache, rep, axis=1)
        v = (lambda x, n, axis: torch.repeat_interleave(x, n, dim=axis))(v_cache, rep, axis=1)
        scores = torch.einsum("bhqd,bhkd->bhqk", q, k) * (Dh ** -0.5)
        p = _softmax(scores, axis=-1)
        o = torch.einsum("bhqk,bhkd->bhqd", p, v)
        return (lambda x, *d: x.permute(*d))(o, 0, 2, 1, 3).reshape(B, Sq, Hq * Dh) @ wo

    def _B_ref(x, W_gate, W_up, W_down):
        gate = torch.einsum("bsd,df->bsf", x, W_gate)
        up = torch.einsum("bsd,df->bsf", x, W_up)
        gate = gate * (lambda x, dt: x.to(dt))(gate > 0, gate.dtype)
        h = gate * up
        return torch.einsum("bsf,fd->bsd", h, W_down)

    x = A_x
    x = x + _A_ref(_layernorm(x, axis=-1), A_k_cache, A_v_cache, A_wq, A_wo)
    x = x + _B_ref(_layernorm(x, axis=-1), B_W_gate, B_W_up, B_W_down)
    x = x + _A_ref(_layernorm(x, axis=-1), A_k_cache, A_v_cache, A_wq, A_wo)
    x = x + _B_ref(_layernorm(x, axis=-1), B_W_gate, B_W_up, B_W_down)
    return x
```

```asm
; @launch grid=(256,1,1) block=(256,1,1) lds=163072
.amdgcn_target "amdgcn-amd-amdhsa--gfx950"
.text
.globl interleave_layers__gqa_block_cached__glu_gated_reglu__decode_kernel
.p2align 8
.type interleave_layers__gqa_block_cached__glu_gated_reglu__decode_kernel,@function
interleave_layers__gqa_block_cached__glu_gated_reglu__decode_kernel:
    s_cmp_ge_u32 s2, 256
    s_cbranch_scc1 LEND
    s_load_dwordx16 s[64:79], s[0:1], 0
    s_load_dwordx8 s[80:87], s[0:1], 64
    v_and_b32 v1, 63, v0
    v_lshrrev_b32 v40, 6, v0
    s_nop 0
    v_readfirstlane_b32 s24, v40
    s_and_b32 s28, s2, 7
    s_lshr_b32 s27, s2, 4
    s_and_b32 s44, s2, 15
    s_lshl_b32 s44, s44, 1
    s_add_u32 s27, s27, s44
    s_and_b32 s27, s27, 31
    s_lshr_b32 s25, s2, 4
    s_and_b32 s26, s2, 15
    s_mov_b32 s30, 0x3e0293ee
    s_mov_b32 s31, 0
    s_mov_b32 s38, 400000
    s_mov_b32 s39, 131072
    s_mov_b32 s42, 0xf0f0f0f0
    s_mov_b32 s43, 0xf0f0f0f0
    s_lshl_b32 s44, s26, 2
    s_add_u32 s44, s44, s24
    s_lshl_b32 s32, s44, 13
    s_mov_b32 s34, s32
    s_xor_b32 s35, s34, 4096
    s_xor_b32 s33, s32, 4096
    s_lshl_b32 s57, s44, 14
    s_add_u32 s57, s57, 15728640
    s_mov_b32 s55, -1
    s_mov_b32 s56, -1
    s_mov_b32 s96, -1
    s_mov_b32 s97, -1
    v_lshlrev_b32 v3, 4, v1
    v_bfe_u32 v40, v1, 2, 2
    v_lshlrev_b32 v2, 8, v40
    v_lshrrev_b32 v40, 4, v1
    v_lshl_add_u32 v2, v40, 6, v2
    v_and_b32 v40, 3, v1
    v_lshl_add_u32 v2, v40, 4, v2
    s_waitcnt lgkmcnt(0)
    s_load_dword s29, s[86:87], 0
    s_lshl_b32 s44, s25, 24
    s_add_u32 s4, s66, s44
    s_addc_u32 s5, s67, 0
    s_and_b32 s5, s5, 0xffff
    s_mov_b32 s6, 0x1000000
    s_mov_b32 s7, 0x20000
    s_add_u32 s8, s68, s44
    s_addc_u32 s9, s69, 0
    s_and_b32 s9, s9, 0xffff
    s_mov_b32 s10, 0x1000000
    s_mov_b32 s11, 0x20000
    s_mov_b32 s12, s86
    s_and_b32 s13, s87, 0xffff
    s_mov_b32 s14, 4194304
    s_mov_b32 s15, 0x20000
    s_cmp_ge_u32 s27, 24
    s_cbranch_scc0 LPRO1
    s_mov_b32 s60, s64
    s_and_b32 s61, s65, 0xffff
    s_mov_b32 s62, 1152
    s_mov_b32 s63, 0x20000
    s_mov_b32 s92, s70
    s_and_b32 s93, s71, 0xffff
    s_mov_b32 s94, 4718592
    s_mov_b32 s95, 0x20000
    v_lshrrev_b32 v41, 3, v1
    v_lshlrev_b32 v40, 13, v41
    v_and_b32 v42, 7, v1
    v_lshl_add_u32 v40, v42, 4, v40
    s_lshl_b32 s46, s28, 3
    s_add_u32 s46, s46, s27
    s_sub_u32 s46, s46, 24
    s_lshl_b32 s44, s46, 7
    s_mul_i32 s45, s24, 1179648
    s_add_u32 s44, s44, s45
    buffer_load_dwordx4 v[64:67], v40, s[92:95], s44 offen nt
    s_add_u32 s44, s44, 65536
    buffer_load_dwordx4 v[68:71], v40, s[92:95], s44 offen nt
    s_add_u32 s44, s44, 65536
    buffer_load_dwordx4 v[72:75], v40, s[92:95], s44 offen nt
    s_add_u32 s44, s44, 65536
    buffer_load_dwordx4 v[76:79], v40, s[92:95], s44 offen nt
    s_add_u32 s44, s44, 65536
    buffer_load_dwordx4 v[80:83], v40, s[92:95], s44 offen nt
    s_add_u32 s44, s44, 65536
    buffer_load_dwordx4 v[84:87], v40, s[92:95], s44 offen nt
    s_add_u32 s44, s44, 65536
    buffer_load_dwordx4 v[88:91], v40, s[92:95], s44 offen nt
    s_add_u32 s44, s44, 65536
    buffer_load_dwordx4 v[92:95], v40, s[92:95], s44 offen nt
    s_add_u32 s44, s44, 65536
    buffer_load_dwordx4 v[96:99], v40, s[92:95], s44 offen nt
    s_add_u32 s44, s44, 65536
    buffer_load_dwordx4 v[100:103], v40, s[92:95], s44 offen nt
    s_add_u32 s44, s44, 65536
    buffer_load_dwordx4 v[104:107], v40, s[92:95], s44 offen nt
    s_add_u32 s44, s44, 65536
    buffer_load_dwordx4 v[108:111], v40, s[92:95], s44 offen nt
    s_add_u32 s44, s44, 65536
    buffer_load_dwordx4 v[112:115], v40, s[92:95], s44 offen nt
    s_add_u32 s44, s44, 65536
    buffer_load_dwordx4 v[116:119], v40, s[92:95], s44 offen nt
    s_add_u32 s44, s44, 65536
    buffer_load_dwordx4 v[120:123], v40, s[92:95], s44 offen nt
    s_add_u32 s44, s44, 65536
    buffer_load_dwordx4 v[124:127], v40, s[92:95], s44 offen nt
    s_add_u32 s44, s44, 65536
    buffer_load_dwordx4 v[128:131], v40, s[92:95], s44 offen nt
    s_add_u32 s44, s44, 65536
    buffer_load_dwordx4 v[132:135], v40, s[92:95], s44 offen nt
    s_add_u32 s44, s44, 65536
    buffer_load_dwordx4 v[8:11], v3, s[60:63], 0 offen
    buffer_load_dwordx4 v[12:15], v3, s[60:63], 0 offen offset:1024
    s_and_b32 s44, s46, 3
    s_or_b32 s44, s44, s24
    s_cmp_eq_u32 s44, 0
    s_cbranch_scc0 LPRO0
    v_and_b32 v40, 1, v1
    v_lshlrev_b32 v40, 12, v40
    v_bfe_u32 v43, v1, 1, 1
    v_lshl_add_u32 v40, v43, 13, v40
    v_lshrrev_b32 v43, 2, v1
    v_lshl_add_u32 v40, v43, 4, v40
    v_mov_b32 v36, 0
    v_mov_b32 v37, 0
    v_mov_b32 v38, 0
    v_mov_b32 v39, 0
    s_lshl_b32 s44, s46, 6
    s_add_u32 s44, s44, 69632
    s_mov_b64 exec, 0xff
    buffer_store_dwordx4 v[36:39], v40, s[12:15], s44 offen sc1
    s_mov_b64 exec, -1
    s_nop 0
LPRO0:
    v_lshrrev_b32 v40, 1, v42
    v_mul_u32_u24 v40, 18432, v40
    v_and_b32 v43, 3, v41
    v_lshl_add_u32 v40, v43, 5, v40
    v_lshrrev_b32 v43, 2, v41
    v_lshl_add_u32 v40, v43, 9, v40
    v_and_b32 v42, 1, v42
    v_lshl_add_u32 v40, v42, 4, v40
    s_mul_i32 s44, s24, 18
    s_add_u32 s44, s44, 0
    s_lshr_b32 s45, s44, 2
    s_lshl_b32 s45, s45, 10
    s_and_b32 s44, s44, 3
    s_lshl_b32 s44, s44, 7
    s_add_u32 s44, s44, s45
    s_add_u32 s44, s44, 49152
    v_add_u32 v41, s44, v40
    s_mul_i32 s44, s24, 18
    s_add_u32 s44, s44, 2
    s_lshr_b32 s45, s44, 2
    s_lshl_b32 s45, s45, 10
    s_and_b32 s44, s44, 3
    s_lshl_b32 s44, s44, 7
    s_add_u32 s44, s44, s45
    s_add_u32 s44, s44, 49152
    v_add_u32 v42, s44, v40
    v_mov_b32 v16, 0x3f803f80
    v_mov_b32 v17, 0x3f803f80
    v_mov_b32 v18, 0x3f803f80
    v_mov_b32 v19, 0x3f803f80
    v_add_u32 v20, 129088, v3
    ds_write_b128 v20, v[16:19]
    s_mov_b64 exec, 0xff
    ds_write_b128 v20, v[16:19] offset:1024
    s_mov_b64 exec, -1
    s_waitcnt vmcnt(0) lgkmcnt(0)
    s_mul_i32 s29, s29, 0x9e3779b1
    s_add_u32 s29, s29, 0x7f4a7c15
    ds_write_b128 v41, v[64:67] offset:0
    ds_write_b128 v41, v[68:71] offset:128
    ds_write_b128 v42, v[72:75] offset:0
    ds_write_b128 v42, v[76:79] offset:128
    ds_write_b128 v41, v[80:83] offset:1024
    ds_write_b128 v41, v[84:87] offset:1152
    ds_write_b128 v42, v[88:91] offset:1024
    ds_write_b128 v42, v[92:95] offset:1152
    ds_write_b128 v41, v[96:99] offset:2048
    ds_write_b128 v41, v[100:103] offset:2176
    ds_write_b128 v42, v[104:107] offset:2048
    ds_write_b128 v42, v[108:111] offset:2176
    ds_write_b128 v41, v[112:115] offset:3072
    ds_write_b128 v41, v[116:119] offset:3200
    ds_write_b128 v42, v[120:123] offset:3072
    ds_write_b128 v42, v[124:127] offset:3200
    ds_write_b128 v41, v[128:131] offset:4096
    ds_write_b128 v41, v[132:135] offset:4224
    s_waitcnt lgkmcnt(0)
    s_barrier
    s_mul_i32 s44, s24, 1152
    s_add_u32 s44, s44, 122880
    s_mul_i32 s45, s24, 18432
    s_add_u32 s45, s45, 49152
    v_add_u32 v2, s44, v3
    v_mov_b32 v57, s44
    v_mov_b32 v58, 129088
    s_mov_b32 s46, 0x00020002
    s_mov_b32 s47, 0x00020002
    v_cndmask_b32 v57, v57, v58, s[46:47]
    v_lshrrev_b32 v58, 4, v1
    v_lshl_add_u32 v57, v58, 4, v57
    v_lshlrev_b32 v58, 3, v1
    v_add_u32 v58, s45, v58
    s_lshl_b32 s54, s28, 3
    s_add_u32 s54, s54, s27
    s_sub_u32 s54, s54, 24
    s_lshl_b32 s54, s54, 2
    s_add_u32 s54, s54, s24
    s_lshl_b32 s54, s54, 7
    s_add_u32 s54, s54, 4096
    s_call_b64 s[36:37], LQSTAGE
    v_bfe_u32 v40, v1, 2, 2
    v_lshlrev_b32 v2, 8, v40
    v_lshrrev_b32 v40, 4, v1
    v_lshl_add_u32 v2, v40, 6, v2
    v_and_b32 v40, 3, v1
    v_lshl_add_u32 v2, v40, 4, v2
    s_nop 1
    s_branch LPRO2
LPRO1:
    s_waitcnt lgkmcnt(0)
    v_mov_b32 v16, 0x3f803f80
    v_mov_b32 v17, 0x3f803f80
    v_mov_b32 v18, 0x3f803f80
    v_mov_b32 v19, 0x3f803f80
    v_add_u32 v20, 129088, v3
    ds_write_b128 v20, v[16:19]
    s_mov_b64 exec, 0xff
    ds_write_b128 v20, v[16:19] offset:1024
    s_mov_b64 exec, -1
    s_mul_i32 s29, s29, 0x9e3779b1
    s_add_u32 s29, s29, 0x7f4a7c15
LPRO2:
    buffer_load_dwordx4 a[0:3], v2, s[4:7], s32 offen offset:0 nt
    buffer_load_dwordx4 a[4:7], v2, s[4:7], s32 offen offset:1024 nt
    buffer_load_dwordx4 a[8:11], v2, s[4:7], s32 offen offset:2048 nt
    buffer_load_dwordx4 a[12:15], v2, s[4:7], s32 offen offset:3072 nt
    buffer_load_dwordx4 a[16:19], v2, s[4:7], s33 offen offset:0 nt
    buffer_load_dwordx4 a[20:23], v2, s[4:7], s33 offen offset:1024 nt
    buffer_load_dwordx4 a[24:27], v2, s[4:7], s33 offen offset:2048 nt
    buffer_load_dwordx4 a[28:31], v2, s[4:7], s33 offen offset:3072 nt
    buffer_load_dwordx4 a[32:35], v3, s[8:11], s34 offen offset:0
    buffer_load_dwordx4 a[36:39], v3, s[8:11], s34 offen offset:1024
    buffer_load_dwordx4 a[40:43], v3, s[8:11], s34 offen offset:2048
    buffer_load_dwordx4 a[44:47], v3, s[8:11], s34 offen offset:3072
    buffer_load_dwordx4 a[48:51], v3, s[8:11], s35 offen offset:0
    buffer_load_dwordx4 a[52:55], v3, s[8:11], s35 offen offset:1024
    buffer_load_dwordx4 a[56:59], v3, s[8:11], s35 offen offset:2048
    buffer_load_dwordx4 a[60:63], v3, s[8:11], s35 offen offset:3072
    s_add_u32 s32, s32, 524288
    s_add_u32 s33, s33, 524288
    s_add_u32 s34, s34, 524288
    s_add_u32 s35, s35, 524288
    s_cmp_eq_u32 s24, 0
    s_cbranch_scc0 LPRO3
    v_mov_b32 v24, -1
    v_mov_b32 v25, -1
    v_mov_b32 v26, -1
    v_mov_b32 v27, -1
    s_mul_i32 s44, s2, 6144
    s_add_u32 s44, s44, 131072
    s_add_u32 s45, s44, 4096
    buffer_store_dwordx4 v[24:27], v3, s[12:15], s44 offen offset:0 sc1
    buffer_store_dwordx4 v[24:27], v3, s[12:15], s44 offen offset:1024 sc1
    buffer_store_dwordx4 v[24:27], v3, s[12:15], s44 offen offset:2048 sc1
    buffer_store_dwordx4 v[24:27], v3, s[12:15], s44 offen offset:3072 sc1
    buffer_store_dwordx4 v[24:27], v3, s[12:15], s45 offen offset:0 sc1
    buffer_store_dwordx4 v[24:27], v3, s[12:15], s45 offen offset:1024 sc1
    s_nop 1
LPRO3:
    s_mov_b32 s16, s82
    s_and_b32 s17, s83, 0xffff
    s_mov_b32 s18, 1152
    s_mov_b32 s19, 0x20000
    s_mov_b32 s20, s84
    s_and_b32 s21, s85, 0xffff
    s_mov_b32 s22, 256
    s_mov_b32 s23, 0x20000
    v_and_b32 v40, 1, v1
    v_lshlrev_b32 v40, 4, v40
    v_mov_b32 v41, 0xffff
    v_lshlrev_b32 v40, v40, v41
    s_mov_b32 s46, 0x03030303
    s_mov_b32 s47, 0x03030303
    v_cndmask_b32 v4, 0, v40, s[46:47]
    s_mov_b32 s46, 0x0c0c0c0c
    s_mov_b32 s47, 0x0c0c0c0c
    v_cndmask_b32 v5, 0, v40, s[46:47]
    s_mov_b32 s46, 0x30303030
    s_mov_b32 s47, 0x30303030
    v_cndmask_b32 v6, 0, v40, s[46:47]
    s_mov_b32 s46, 0xc0c0c0c0
    s_mov_b32 s47, 0xc0c0c0c0
    v_cndmask_b32 v7, 0, v40, s[46:47]
    s_lshl_b32 s44, s25, 8
    s_add_u32 s44, s44, 69632
    s_add_u32 s88, s86, s44
    s_addc_u32 s89, s87, 0
    s_cmp_lt_u32 s27, 18
    s_cbranch_scc0 LWB
    s_mov_b32 s60, s76
    s_and_b32 s61, s77, 0xffff
    s_mov_b32 s62, 5308416
    s_mov_b32 s63, 0x20000
    s_mov_b32 s92, s78
    s_and_b32 s93, s79, 0xffff
    s_mov_b32 s94, 5308416
    s_mov_b32 s95, 0x20000
    v_lshrrev_b32 v41, 2, v1
    v_and_b32 v42, 3, v1
    v_mul_u32_u24 v40, 9216, v41
    v_lshl_add_u32 v40, v42, 4, v40
    s_mul_i32 s46, s28, 18
    s_add_u32 s46, s46, s27
    s_lshl_b32 s44, s46, 6
    s_mul_i32 s45, s24, 1327104
    s_add_u32 s44, s44, s45
    buffer_load_dwordx4 v[64:67], v40, s[60:63], s44 offen nt
    buffer_load_dwordx4 v[68:71], v40, s[92:95], s44 offen nt
    s_add_u32 s44, s44, 147456
    buffer_load_dwordx4 v[72:75], v40, s[60:63], s44 offen nt
    buffer_load_dwordx4 v[76:79], v40, s[92:95], s44 offen nt
    s_add_u32 s44, s44, 147456
    buffer_load_dwordx4 v[80:83], v40, s[60:63], s44 offen nt
    buffer_load_dwordx4 v[84:87], v40, s[92:95], s44 offen nt
    s_add_u32 s44, s44, 147456
    buffer_load_dwordx4 v[88:91], v40, s[60:63], s44 offen nt
    buffer_load_dwordx4 v[92:95], v40, s[92:95], s44 offen nt
    s_add_u32 s44, s44, 147456
    buffer_load_dwordx4 v[96:99], v40, s[60:63], s44 offen nt
    buffer_load_dwordx4 v[100:103], v40, s[92:95], s44 offen nt
    s_add_u32 s44, s44, 147456
    buffer_load_dwordx4 v[104:107], v40, s[60:63], s44 offen nt
    buffer_load_dwordx4 v[108:111], v40, s[92:95], s44 offen nt
    s_add_u32 s44, s44, 147456
    buffer_load_dwordx4 v[112:115], v40, s[60:63], s44 offen nt
    buffer_load_dwordx4 v[116:119], v40, s[92:95], s44 offen nt
    s_add_u32 s44, s44, 147456
    buffer_load_dwordx4 v[120:123], v40, s[60:63], s44 offen nt
    buffer_load_dwordx4 v[124:127], v40, s[92:95], s44 offen nt
    s_add_u32 s44, s44, 147456
    buffer_load_dwordx4 v[128:131], v40, s[60:63], s44 offen nt
    buffer_load_dwordx4 v[132:135], v40, s[92:95], s44 offen nt
    s_add_u32 s44, s44, 147456
    v_mul_u32_u24 v43, 18432, v42
    v_and_b32 v42, 3, v41
    v_lshl_add_u32 v43, v42, 5, v43
    v_bfe_u32 v42, v41, 2, 1
    v_lshl_add_u32 v43, v42, 9, v43
    v_lshrrev_b32 v42, 3, v41
    v_lshl_add_u32 v43, v42, 7, v43
    s_mul_i32 s44, s24, 9
    s_add_u32 s44, s44, 1
    s_lshr_b32 s45, s44, 1
    s_lshl_b32 s45, s45, 10
    s_and_b32 s44, s44, 1
    s_lshl_b32 s44, s44, 8
    s_add_u32 s44, s44, s45
    v_add_u32 v34, s44, v43
    s_mul_i32 s44, s24, 9
    s_add_u32 s44, s44, 0
    s_lshr_b32 s45, s44, 1
    s_lshl_b32 s45, s45, 10
    s_and_b32 s44, s44, 1
    s_lshl_b32 s44, s44, 8
    s_add_u32 s44, s44, s45
    v_add_u32 v43, s44, v43
    s_mov_b32 s60, s80
    s_and_b32 s61, s81, 0xffff
    s_mov_b32 s62, 5308416
    s_mov_b32 s63, 0x20000
    s_mul_i32 s44, s46, 36864
    s_mul_i32 s45, s24, 9216
    s_add_u32 s44, s44, s45
    s_add_u32 s45, s44, 4096
    s_add_u32 s46, s44, 8192
    s_branch LWDONE
LWB:
    s_cmp_lt_u32 s27, 30
    s_cbranch_scc0 LWDONE
    s_mov_b32 s60, s72
    s_and_b32 s61, s73, 0xffff
    s_mov_b32 s62, 4718592
    s_mov_b32 s63, 0x20000
    v_lshrrev_b32 v41, 4, v1
    v_and_b32 v42, 15, v1
    v_mul_u32_u24 v40, 1152, v41
    v_lshl_add_u32 v40, v42, 4, v40
    s_sub_u32 s47, s27, 18
    s_lshl_b32 s46, s28, 1
    s_cmp_ge_u32 s47, 6
    s_addc_u32 s46, s46, 0
    s_cmp_ge_u32 s47, 6
    s_cselect_b32 s48, 6, 0
    s_sub_u32 s47, s47, s48
    s_lshl_b32 s44, s46, 8
    s_lshl_b32 s45, s24, 6
    s_add_u32 s44, s44, s45
    s_mul_i32 s44, s44, 1152
    s_mul_i32 s45, s47, 192
    s_add_u32 s44, s44, s45
    s_mov_b32 exec_lo, 0x0fff0fff
    s_mov_b32 exec_hi, 0x0fff0fff
    buffer_load_dwordx4 v[64:67], v40, s[60:63], s44 offen nt
    s_add_u32 s44, s44, 4608
    buffer_load_dwordx4 v[68:71], v40, s[60:63], s44 offen nt
    s_add_u32 s44, s44, 4608
    buffer_load_dwordx4 v[72:75], v40, s[60:63], s44 offen nt
    s_add_u32 s44, s44, 4608
    buffer_load_dwordx4 v[76:79], v40, s[60:63], s44 offen nt
    s_add_u32 s44, s44, 4608
    buffer_load_dwordx4 v[80:83], v40, s[60:63], s44 offen nt
    s_add_u32 s44, s44, 4608
    buffer_load_dwordx4 v[84:87], v40, s[60:63], s44 offen nt
    s_add_u32 s44, s44, 4608
    buffer_load_dwordx4 v[88:91], v40, s[60:63], s44 offen nt
    s_add_u32 s44, s44, 4608
    buffer_load_dwordx4 v[92:95], v40, s[60:63], s44 offen nt
    s_add_u32 s44, s44, 4608
    buffer_load_dwordx4 v[96:99], v40, s[60:63], s44 offen nt
    s_add_u32 s44, s44, 4608
    buffer_load_dwordx4 v[100:103], v40, s[60:63], s44 offen nt
    s_add_u32 s44, s44, 4608
    buffer_load_dwordx4 v[104:107], v40, s[60:63], s44 offen nt
    s_add_u32 s44, s44, 4608
    buffer_load_dwordx4 v[108:111], v40, s[60:63], s44 offen nt
    s_add_u32 s44, s44, 4608
    buffer_load_dwordx4 v[112:115], v40, s[60:63], s44 offen nt
    s_add_u32 s44, s44, 4608
    buffer_load_dwordx4 v[116:119], v40, s[60:63], s44 offen nt
    s_add_u32 s44, s44, 4608
    buffer_load_dwordx4 v[120:123], v40, s[60:63], s44 offen nt
    s_add_u32 s44, s44, 4608
    buffer_load_dwordx4 v[124:127], v40, s[60:63], s44 offen nt
    s_add_u32 s44, s44, 4608
    s_mov_b64 exec, -1
    v_lshrrev_b32 v43, 1, v42
    v_mul_u32_u24 v43, 8192, v43
    v_lshl_add_u32 v43, v41, 5, v43
    v_and_b32 v42, 1, v42
    v_lshl_add_u32 v43, v42, 4, v43
    s_lshl_b32 s45, s24, 11
    v_add_u32 v43, s45, v43
    s_nop 1
LWDONE:
    s_add_u32 s50, s57, 0
    s_memtime s[52:53]
    s_waitcnt lgkmcnt(0)
    s_buffer_load_dword s51, s[8:11], s50
    s_waitcnt lgkmcnt(0)
    s_memtime s[50:51]
    s_waitcnt lgkmcnt(0)
    s_sub_u32 s50, s50, s52
    s_min_u32 s56, s56, s50
    s_add_u32 s50, s57, 8192
    s_memtime s[52:53]
    s_waitcnt lgkmcnt(0)
    s_buffer_load_dword s51, s[8:11], s50
    s_waitcnt lgkmcnt(0)
    s_memtime s[50:51]
    s_waitcnt lgkmcnt(0)
    s_sub_u32 s50, s50, s52
    s_min_u32 s55, s55, s50
    s_waitcnt vmcnt(30)
    buffer_load_dwordx4 a[64:67], v2, s[4:7], s32 offen offset:0 nt
    buffer_load_dwordx4 a[68:71], v2, s[4:7], s32 offen offset:1024 nt
    buffer_load_dwordx4 a[72:75], v2, s[4:7], s32 offen offset:2048 nt
    buffer_load_dwordx4 a[76:79], v2, s[4:7], s32 offen offset:3072 nt
    buffer_load_dwordx4 a[80:83], v2, s[4:7], s33 offen offset:0 nt
    buffer_load_dwordx4 a[84:87], v2, s[4:7], s33 offen offset:1024 nt
    buffer_load_dwordx4 a[88:91], v2, s[4:7], s33 offen offset:2048 nt
    buffer_load_dwordx4 a[92:95], v2, s[4:7], s33 offen offset:3072 nt
    buffer_load_dwordx4 a[96:99], v3, s[8:11], s34 offen offset:0
    buffer_load_dwordx4 a[100:103], v3, s[8:11], s34 offen offset:1024
    buffer_load_dwordx4 a[104:107], v3, s[8:11], s34 offen offset:2048
    buffer_load_dwordx4 a[108:111], v3, s[8:11], s34 offen offset:3072
    buffer_load_dwordx4 a[112:115], v3, s[8:11], s35 offen offset:0
    buffer_load_dwordx4 a[116:119], v3, s[8:11], s35 offen offset:1024
    buffer_load_dwordx4 a[120:123], v3, s[8:11], s35 offen offset:2048
    buffer_load_dwordx4 a[124:127], v3, s[8:11], s35 offen offset:3072
    s_add_u32 s32, s32, 524288
    s_add_u32 s33, s33, 524288
    s_add_u32 s34, s34, 524288
    s_add_u32 s35, s35, 524288
    s_add_u32 s50, s57, 9344
    s_memtime s[52:53]
    s_waitcnt lgkmcnt(0)
    s_buffer_load_dword s51, s[8:11], s50
    s_waitcnt lgkmcnt(0)
    s_memtime s[50:51]
    s_waitcnt lgkmcnt(0)
    s_sub_u32 s50, s50, s52
    s_min_u32 s55, s55, s50
    s_add_u32 s50, s57, 1152
    s_memtime s[52:53]
    s_waitcnt lgkmcnt(0)
    s_buffer_load_dword s51, s[8:11], s50
    s_waitcnt lgkmcnt(0)
    s_memtime s[50:51]
    s_waitcnt lgkmcnt(0)
    s_sub_u32 s50, s50, s52
    s_min_u32 s56, s56, s50
    s_waitcnt vmcnt(30)
    buffer_load_dwordx4 a[128:131], v2, s[4:7], s32 offen offset:0 nt
    buffer_load_dwordx4 a[132:135], v2, s[4:7], s32 offen offset:1024 nt
    buffer_load_dwordx4 a[136:139], v2, s[4:7], s32 offen offset:2048 nt
    buffer_load_dwordx4 a[140:143], v2, s[4:7], s32 offen offset:3072 nt
    buffer_load_dwordx4 a[144:147], v2, s[4:7], s33 offen offset:0 nt
    buffer_load_dwordx4 a[148:151], v2, s[4:7], s33 offen offset:1024 nt
    buffer_load_dwordx4 a[152:155], v2, s[4:7], s33 offen offset:2048 nt
    buffer_load_dwordx4 a[156:159], v2, s[4:7], s33 offen offset:3072 nt
    buffer_load_dwordx4 a[160:163], v3, s[8:11], s34 offen offset:0
    buffer_load_dwordx4 a[164:167], v3, s[8:11], s34 offen offset:1024
    buffer_load_dwordx4 a[168:171], v3, s[8:11], s34 offen offset:2048
    buffer_load_dwordx4 a[172:175], v3, s[8:11], s34 offen offset:3072
    buffer_load_dwordx4 a[176:179], v3, s[8:11], s35 offen offset:0
    buffer_load_dwordx4 a[180:183], v3, s[8:11], s35 offen offset:1024
    buffer_load_dwordx4 a[184:187], v3, s[8:11], s35 offen offset:2048
    buffer_load_dwordx4 a[188:191], v3, s[8:11], s35 offen offset:3072
    s_add_u32 s32, s32, 524288
    s_add_u32 s33, s33, 524288
    s_add_u32 s34, s34, 524288
    s_add_u32 s35, s35, 524288
    s_add_u32 s50, s57, 2304
    s_memtime s[52:53]
    s_waitcnt lgkmcnt(0)
    s_buffer_load_dword s51, s[8:11], s50
    s_waitcnt lgkmcnt(0)
    s_memtime s[50:51]
    s_waitcnt lgkmcnt(0)
    s_sub_u32 s50, s50, s52
    s_min_u32 s56, s56, s50
    s_add_u32 s50, s57, 10496
    s_memtime s[52:53]
    s_waitcnt lgkmcnt(0)
    s_buffer_load_dword s51, s[8:11], s50
    s_waitcnt lgkmcnt(0)
    s_memtime s[50:51]
    s_waitcnt lgkmcnt(0)
    s_sub_u32 s50, s50, s52
    s_min_u32 s55, s55, s50
    s_lshl_b32 s45, s25, 11
    s_add_u32 s45, s45, 4096
    v_bfe_u32 v32, v1, 3, 1
    v_lshlrev_b32 v32, 10, v32
    v_lshrrev_b32 v33, 4, v1
    v_lshl_add_u32 v32, v33, 8, v32
    v_bfe_u32 v33, v1, 1, 1
    v_lshl_add_u32 v32, v33, 7, v32
    v_and_b32 v33, 1, v1
    v_lshl_add_u32 v32, v33, 5, v32
    s_waitcnt vmcnt(40)
    buffer_load_dwordx4 v[24:27], v32, s[12:15], s45 offen sc1
    buffer_load_dwordx4 v[28:31], v32, s[12:15], s45 offen offset:16 sc1
    buffer_load_dwordx4 a[192:195], v2, s[4:7], s32 offen offset:0 nt
    buffer_load_dwordx4 a[196:199], v2, s[4:7], s32 offen offset:1024 nt
    buffer_load_dwordx4 a[200:203], v2, s[4:7], s32 offen offset:2048 nt
    buffer_load_dwordx4 a[204:207], v2, s[4:7], s32 offen offset:3072 nt
    buffer_load_dwordx4 a[208:211], v2, s[4:7], s33 offen offset:0 nt
    buffer_load_dwordx4 a[212:215], v2, s[4:7], s33 offen offset:1024 nt
    buffer_load_dwordx4 a[216:219], v2, s[4:7], s33 offen offset:2048 nt
    buffer_load_dwordx4 a[220:223], v2, s[4:7], s33 offen offset:3072 nt
    buffer_load_dwordx4 a[224:227], v3, s[8:11], s34 offen offset:0
    buffer_load_dwordx4 a[228:231], v3, s[8:11], s34 offen offset:1024
    buffer_load_dwordx4 a[232:235], v3, s[8:11], s34 offen offset:2048
    buffer_load_dwordx4 a[236:239], v3, s[8:11], s34 offen offset:3072
    buffer_load_dwordx4 a[240:243], v3, s[8:11], s35 offen offset:0
    buffer_load_dwordx4 a[244:247], v3, s[8:11], s35 offen offset:1024
    buffer_load_dwordx4 a[248:251], v3, s[8:11], s35 offen offset:2048
    buffer_load_dwordx4 a[252:255], v3, s[8:11], s35 offen offset:3072
    s_add_u32 s32, s32, 524288
    s_add_u32 s33, s33, 524288
    s_add_u32 s34, s34, 524288
    s_add_u32 s35, s35, 524288
    s_waitcnt vmcnt(50)
    s_cmp_lt_u32 s27, 18
    s_cbranch_scc0 LWB2
    ds_write_b128 v43, v[64:67] offset:0
    ds_write_b128 v43, v[68:71] offset:16
    ds_write_b128 v34, v[72:75] offset:0
    ds_write_b128 v34, v[76:79] offset:16
    ds_write_b128 v43, v[80:83] offset:1024
    ds_write_b128 v43, v[84:87] offset:1040
    ds_write_b128 v34, v[88:91] offset:1024
    ds_write_b128 v34, v[92:95] offset:1040
    ds_write_b128 v43, v[96:99] offset:2048
    ds_write_b128 v43, v[100:103] offset:2064
    ds_write_b128 v34, v[104:107] offset:2048
    ds_write_b128 v34, v[108:111] offset:2064
    ds_write_b128 v43, v[112:115] offset:3072
    ds_write_b128 v43, v[116:119] offset:3088
    ds_write_b128 v34, v[120:123] offset:3072
    ds_write_b128 v34, v[124:127] offset:3088
    ds_write_b128 v43, v[128:131] offset:4096
    ds_write_b128 v43, v[132:135] offset:4112
    s_mul_i32 s44, s24, 9216
    s_add_u32 s44, s44, 73728
    v_add_u32 v40, s44, v3
    s_nop 1
    s_branch LWDONE2
LWB2:
    s_cmp_lt_u32 s27, 30
    s_cbranch_scc0 LWDONE2
    s_mov_b32 exec_lo, 0x0fff0fff
    s_mov_b32 exec_hi, 0x0fff0fff
    ds_write_b128 v43, v[64:67] offset:0
    ds_write_b128 v43, v[68:71] offset:512
    ds_write_b128 v43, v[72:75] offset:128
    ds_write_b128 v43, v[76:79] offset:640
    ds_write_b128 v43, v[80:83] offset:256
    ds_write_b128 v43, v[84:87] offset:768
    ds_write_b128 v43, v[88:91] offset:384
    ds_write_b128 v43, v[92:95] offset:896
    ds_write_b128 v43, v[96:99] offset:1024
    ds_write_b128 v43, v[100:103] offset:1536
    ds_write_b128 v43, v[104:107] offset:1152
    ds_write_b128 v43, v[108:111] offset:1664
    ds_write_b128 v43, v[112:115] offset:1280
    ds_write_b128 v43, v[116:119] offset:1792
    ds_write_b128 v43, v[120:123] offset:1408
    ds_write_b128 v43, v[124:127] offset:1920
    s_mov_b64 exec, -1
LWDONE2:
    v_mov_b32 v50, 0
    s_mov_b32 s91, 0
    s_mov_b32 s92, 0
    s_mov_b32 s94, 0
    s_mov_b32 s95, 7
    s_waitcnt lgkmcnt(0)
    s_waitcnt vmcnt(16)
    v_cmp_ne_u32 s[46:47], s29, v25
    v_cmp_ne_u32 s[48:49], s29, v27
    v_cmp_ne_u32 s[50:51], s29, v29
    v_cmp_ne_u32 s[52:53], s29, v31
    s_or_b64 s[46:47], s[46:47], s[48:49]
    s_or_b64 s[50:51], s[50:51], s[52:53]
    s_or_b64 s[46:47], s[46:47], s[50:51]
    s_nop 1
    s_cbranch_scc0 LQREADY
LQPOLL:
    buffer_load_dwordx4 v[24:27], v32, s[12:15], s45 offen sc1
    buffer_load_dwordx4 v[28:31], v32, s[12:15], s45 offen offset:16 sc1
    s_waitcnt vmcnt(0)
    v_cmp_ne_u32 s[46:47], s29, v25
    v_cmp_ne_u32 s[48:49], s29, v27
    v_cmp_ne_u32 s[50:51], s29, v29
    v_cmp_ne_u32 s[52:53], s29, v31
    s_or_b64 s[46:47], s[46:47], s[48:49]
    s_or_b64 s[50:51], s[50:51], s[52:53]
    s_or_b64 s[46:47], s[46:47], s[50:51]
    s_nop 1
    s_cbranch_scc0 LQREADY
    s_cmp_eq_u32 s38, 0
    s_cbranch_scc1 LQREADY
    s_sub_u32 s38, s38, 1
    s_sleep 1
    s_branch LQPOLL
LQREADY:
    s_cmp_eq_u32 s31, 0
    s_cbranch_scc1 LQREADY2
    ds_write_b32 v33, v24 offset:0
    ds_write_b32 v33, v26 offset:256
    ds_write_b32 v33, v28 offset:512
    ds_write_b32 v33, v30 offset:768
    s_waitcnt lgkmcnt(0)
    s_barrier
LQREADY2:
    v_cndmask_b32 v8, v24, 0, s[42:43]
    v_cndmask_b32 v12, 0, v24, s[42:43]
    v_cndmask_b32 v9, v26, 0, s[42:43]
    v_cndmask_b32 v13, 0, v26, s[42:43]
    v_cndmask_b32 v10, v28, 0, s[42:43]
    v_cndmask_b32 v14, 0, v28, s[42:43]
    v_cndmask_b32 v11, v30, 0, s[42:43]
    v_cndmask_b32 v15, 0, v30, s[42:43]
    v_mov_b32 v16, 0
    v_mov_b32 v17, 0
    v_mov_b32 v18, 0
    v_mov_b32 v19, 0
    v_mov_b32 v20, 0xf149f2ca
    v_mov_b32 v21, 0
    s_cmp_eq_u32 s31, 0
    s_nop 0
    s_cbranch_scc0 LP2
    s_getreg_b32 s47, hwreg(HW_REG_XCC_ID)
    s_bfe_u32 s47, s47, 0x10002
    s_sub_i32 s44, s55, s56
    s_min_i32 s44, s44, 300
    s_max_i32 s44, s44, -300
    s_sub_i32 s45, 0, s44
    s_cmp_eq_u32 s47, 0
    s_cselect_b32 s44, s44, s45
    s_mov_b32 s46, s44
    s_atomic_add s46, s[88:89], 16 glc
    s_waitcnt lgkmcnt(0)
    s_add_i32 s44, s44, s46
    s_cmp_gt_i32 s44, 0
    s_cselect_b32 s44, 1, 0
    s_xor_b32 s44, s44, s47
    s_lshl_b32 s45, s44, 2
    s_add_u32 s45, s45, 4
    s_mov_b32 s46, 1
    s_atomic_add s46, s[88:89], s45 glc
    s_mov_b32 s61, 0
    s_mov_b32 s62, 0
    s_mov_b32 s63, 1
    s_mov_b32 s98, 13
    s_mov_b32 s99, 0
    s_mov_b32 s96, 960
    s_waitcnt lgkmcnt(0)
    s_cmp_lt_u32 s46, 32
    s_cbranch_scc1 LBUN
    s_xor_b32 s44, s44, 1
    s_xor_b32 s45, s45, 12
    s_mov_b32 s46, 1
    s_atomic_add s46, s[88:89], s45 glc
    s_waitcnt lgkmcnt(0)
LBUN:
    s_lshl_b32 s57, s46, 1
    s_add_u32 s57, s57, s44
    s_add_u32 s57, s57, 256
    s_lshl_b32 s57, s57, 13
    s_mov_b32 s55, -1
    s_mov_b32 s37, -1
    s_mov_b32 s56, 1088
    s_mov_b32 s60, 0
    s_mov_b32 s54, 768
    s_mov_b32 s36, 0
    s_mov_b32 s101, 0
    s_mov_b32 s97, 0
    s_mov_b32 s41, 0
    s_cmp_eq_u32 s24, 0
    s_cbranch_scc0 LNOCNT
    s_mov_b32 s48, 1
    s_atomic_add s48, s[84:85], 0
LNOCNT:
    s_add_u32 s32, s57, 0
    s_xor_b32 s32, s32, 8192
    s_add_u32 s34, s57, 524288
    s_xor_b32 s34, s34, 8192
    s_xor_b32 s35, s34, 4096
    s_xor_b32 s33, s32, 4096
    s_waitcnt vmcnt(31)
    v_mfma_f32_16x16x32_bf16 v[24:27], a[0:3], v[8:11], 0
    v_mfma_f32_16x16x32_bf16 v[24:27], a[4:7], v[12:15], v[24:27]
    buffer_load_dwordx4 v[64:67], v3, s[8:11], s32 offen offset:0
    buffer_load_dwordx4 a[0:3], v2, s[4:7], s32 offen offset:0 nt
    buffer_load_dwordx4 v[68:71], v3, s[8:11], s32 offen offset:1024
    buffer_load_dwordx4 a[4:7], v2, s[4:7], s32 offen offset:1024 nt
    v_mfma_f32_16x16x32_bf16 v[28:31], a[8:11], v[8:11], 0
    v_mfma_f32_16x16x32_bf16 v[28:31], a[12:15], v[12:15], v[28:31]
    buffer_load_dwordx4 v[72:75], v3, s[8:11], s32 offen offset:2048
    buffer_load_dwordx4 a[8:11], v2, s[4:7], s32 offen offset:2048 nt
    buffer_load_dwordx4 v[76:79], v3, s[8:11], s32 offen offset:3072
    buffer_load_dwordx4 a[12:15], v2, s[4:7], s32 offen offset:3072 nt
    v_mfma_f32_16x16x32_bf16 v[32:35], a[16:19], v[8:11], 0
    v_mfma_f32_16x16x32_bf16 v[32:35], a[20:23], v[12:15], v[32:35]
    buffer_load_dwordx4 v[80:83], v3, s[8:11], s33 offen offset:0
    buffer_load_dwordx4 a[16:19], v2, s[4:7], s33 offen offset:0 nt
    buffer_load_dwordx4 v[84:87], v3, s[8:11], s33 offen offset:1024
    buffer_load_dwordx4 a[20:23], v2, s[4:7], s33 offen offset:1024 nt
    v_mfma_f32_16x16x32_bf16 v[36:39], a[24:27], v[8:11], 0
    v_mfma_f32_16x16x32_bf16 v[36:39], a[28:31], v[12:15], v[36:39]
    buffer_load_dwordx4 v[88:91], v3, s[8:11], s33 offen offset:2048
    buffer_load_dwordx4 a[24:27], v2, s[4:7], s33 offen offset:2048 nt
    buffer_load_dwordx4 v[92:95], v3, s[8:11], s33 offen offset:3072
    buffer_load_dwordx4 a[28:31], v2, s[4:7], s33 offen offset:3072 nt
    v_mov_b32_dpp v40, v24 quad_perm:[0,0,0,0] row_mask:0xf bank_mask:0xf
    v_mov_b32_dpp v41, v28 quad_perm:[0,0,0,0] row_mask:0xf bank_mask:0xf
    v_mov_b32_dpp v42, v32 quad_perm:[0,0,0,0] row_mask:0xf bank_mask:0xf
    v_add_f32_dpp v40, v25, v40 quad_perm:[1,1,1,1] row_mask:0xf bank_mask:0xf
    v_add_f32_dpp v41, v29, v41 quad_perm:[1,1,1,1] row_mask:0xf bank_mask:0xf
    v_add_f32_dpp v42, v33, v42 quad_perm:[1,1,1,1] row_mask:0xf bank_mask:0xf
    v_add_f32_dpp v40, v26, v40 quad_perm:[2,2,2,2] row_mask:0xf bank_mask:0xf
    v_add_f32_dpp v41, v30, v41 quad_perm:[2,2,2,2] row_mask:0xf bank_mask:0xf
    v_mov_b32_dpp v43, v36 quad_perm:[0,0,0,0] row_mask:0xf bank_mask:0xf
    v_add_f32_dpp v42, v34, v42 quad_perm:[2,2,2,2] row_mask:0xf bank_mask:0xf
    v_add_f32_dpp v40, v27, v40 quad_perm:[3,3,3,3] row_mask:0xf bank_mask:0xf
    v_add_f32_dpp v43, v37, v43 quad_perm:[1,1,1,1] row_mask:0xf bank_mask:0xf
    v_add_f32_dpp v41, v31, v41 quad_perm:[3,3,3,3] row_mask:0xf bank_mask:0xf
    v_add_f32_dpp v42, v35, v42 quad_perm:[3,3,3,3] row_mask:0xf bank_mask:0xf
    v_add_f32_dpp v43, v38, v43 quad_perm:[2,2,2,2] row_mask:0xf bank_mask:0xf
    v_max3_f32 v44, v40, v41, v20
    s_nop 0
    v_add_f32_dpp v43, v39, v43 quad_perm:[3,3,3,3] row_mask:0xf bank_mask:0xf
    v_max3_f32 v44, v44, v42, v43
    s_nop 1
    v_max_f32_dpp v44, v44, v44 row_half_mirror row_mask:0xf bank_mask:0xf
    v_mov_b32 v45, v44
    s_nop 1
    v_permlane16_swap_b32 v44, v45
    v_max_f32 v44, v44, v45
    v_mov_b32 v45, v44
    s_nop 1
    v_permlane32_swap_b32 v44, v45
    v_max_f32 v44, v44, v45
    v_sub_f32 v45, v20, v44
    v_mul_f32 v45, s30, v45
    v_exp_f32 v45, v45
    v_mov_b32 v20, v44
    v_mul_f32 v22, s30, v44
    v_fma_f32 v40, v40, s30, -v22
    v_fma_f32 v41, v41, s30, -v22
    v_fma_f32 v42, v42, s30, -v22
    v_fma_f32 v43, v43, s30, -v22
    v_exp_f32 v40, v40
    v_exp_f32 v41, v41
    v_exp_f32 v42, v42
    v_exp_f32 v43, v43
    v_mul_f32 v21, v21, v45
    v_mul_f32 v16, v16, v45
    v_mul_f32 v17, v17, v45
    v_mul_f32 v18, v18, v45
    v_mul_f32 v19, v19, v45
    v_add_f32 v46, v40, v41
    v_add_f32 v47, v42, v43
    v_cvt_pk_bf16_f32 v40, v40, v40
    v_cvt_pk_bf16_f32 v41, v41, v41
    v_cvt_pk_bf16_f32 v42, v42, v42
    v_cvt_pk_bf16_f32 v43, v43, v43
    v_add_f32 v46, v46, v47
    v_add_f32 v21, v21, v46
    v_and_b32 v24, v40, v4
    v_and_b32 v25, v40, v5
    v_and_b32_dpp v26, v40, v6 row_shr:4 row_mask:0xf bank_mask:0xf bound_ctrl:1
    v_and_b32_dpp v27, v40, v7 row_shr:4 row_mask:0xf bank_mask:0xf bound_ctrl:1
    v_and_b32_dpp v28, v40, v4 row_shl:4 row_mask:0xf bank_mask:0xf bound_ctrl:1
    v_and_b32_dpp v29, v40, v5 row_shl:4 row_mask:0xf bank_mask:0xf bound_ctrl:1
    v_and_b32 v30, v40, v6
    v_and_b32 v31, v40, v7
    v_mfma_f32_16x16x32_bf16 v[16:19], a[32:35], v[24:27], v[16:19]
    buffer_load_dwordx4 v[96:99], v3, s[8:11], s34 offen offset:0
    buffer_load_dwordx4 a[32:35], v2, s[4:7], s34 offen offset:0 nt
    v_and_b32 v32, v41, v4
    v_and_b32 v33, v41, v5
    v_and_b32_dpp v34, v41, v6 row_shr:4 row_mask:0xf bank_mask:0xf bound_ctrl:1
    v_and_b32_dpp v35, v41, v7 row_shr:4 row_mask:0xf bank_mask:0xf bound_ctrl:1
    v_mfma_f32_16x16x32_bf16 v[16:19], a[36:39], v[28:31], v[16:19]
    buffer_load_dwordx4 v[100:103], v3, s[8:11], s34 offen offset:1024
    buffer_load_dwordx4 a[36:39], v2, s[4:7], s34 offen offset:1024 nt
    v_and_b32_dpp v36, v41, v4 row_shl:4 row_mask:0xf bank_mask:0xf bound_ctrl:1
    v_and_b32_dpp v37, v41, v5 row_shl:4 row_mask:0xf bank_mask:0xf bound_ctrl:1
    v_and_b32 v38, v41, v6
    v_and_b32 v39, v41, v7
    v_mfma_f32_16x16x32_bf16 v[16:19], a[40:43], v[32:35], v[16:19]
    buffer_load_dwordx4 v[104:107], v3, s[8:11], s34 offen offset:2048
    buffer_load_dwordx4 a[40:43], v2, s[4:7], s34 offen offset:2048 nt
    v_and_b32 v24, v42, v4
    v_and_b32 v25, v42, v5
    v_and_b32_dpp v26, v42, v6 row_shr:4 row_mask:0xf bank_mask:0xf bound_ctrl:1
    v_and_b32_dpp v27, v42, v7 row_shr:4 row_mask:0xf bank_mask:0xf bound_ctrl:1
    v_mfma_f32_16x16x32_bf16 v[16:19], a[44:47], v[36:39], v[16:19]
    buffer_load_dwordx4 v[108:111], v3, s[8:11], s34 offen offset:3072
    buffer_load_dwordx4 a[44:47], v2, s[4:7], s34 offen offset:3072 nt
    v_and_b32_dpp v28, v42, v4 row_shl:4 row_mask:0xf bank_mask:0xf bound_ctrl:1
    v_and_b32_dpp v29, v42, v5 row_shl:4 row_mask:0xf bank_mask:0xf bound_ctrl:1
    v_and_b32 v30, v42, v6
    v_and_b32 v31, v42, v7
    v_mfma_f32_16x16x32_bf16 v[16:19], a[48:51], v[24:27], v[16:19]
    buffer_load_dwordx4 v[112:115], v3, s[8:11], s35 offen offset:0
    buffer_load_dwordx4 a[48:51], v2, s[4:7], s35 offen offset:0 nt
    v_and_b32 v32, v43, v4
    v_and_b32 v33, v43, v5
    v_and_b32_dpp v34, v43, v6 row_shr:4 row_mask:0xf bank_mask:0xf bound_ctrl:1
    v_and_b32_dpp v35, v43, v7 row_shr:4 row_mask:0xf bank_mask:0xf bound_ctrl:1
    v_mfma_f32_16x16x32_bf16 v[16:19], a[52:55], v[28:31], v[16:19]
    buffer_load_dwordx4 v[116:119], v3, s[8:11], s35 offen offset:1024
    buffer_load_dwordx4 a[52:55], v2, s[4:7], s35 offen offset:1024 nt
    v_and_b32_dpp v36, v43, v4 row_shl:4 row_mask:0xf bank_mask:0xf bound_ctrl:1
    v_and_b32_dpp v37, v43, v5 row_shl:4 row_mask:0xf bank_mask:0xf bound_ctrl:1
    v_and_b32 v38, v43, v6
    v_and_b32 v39, v43, v7
    v_mfma_f32_16x16x32_bf16 v[16:19], a[56:59], v[32:35], v[16:19]
    buffer_load_dwordx4 v[120:123], v3, s[8:11], s35 offen offset:2048
    buffer_load_dwordx4 a[56:59], v2, s[4:7], s35 offen offset:2048 nt
    v_mfma_f32_16x16x32_bf16 v[16:19], a[60:63], v[36:39], v[16:19]
    buffer_load_dwordx4 v[124:127], v3, s[8:11], s35 offen offset:3072
    buffer_load_dwordx4 a[60:63], v2, s[4:7], s35 offen offset:3072 nt
    s_add_u32 s32, s57, 1048576
    s_xor_b32 s32, s32, 8192
    s_add_u32 s34, s57, 1572864
    s_xor_b32 s34, s34, 8192
    s_xor_b32 s35, s34, 4096
    s_xor_b32 s33, s32, 4096
    s_waitcnt vmcnt(31)
    v_mfma_f32_16x16x32_bf16 v[24:27], a[64:67], v[8:11], 0
    v_mfma_f32_16x16x32_bf16 v[24:27], a[68:71], v[12:15], v[24:27]
    buffer_load_dwordx4 v[128:131], v3, s[8:11], s32 offen offset:0
    buffer_load_dwordx4 a[64:67], v2, s[4:7], s32 offen offset:0 nt
    buffer_load_dwordx4 v[132:135], v3, s[8:11], s32 offen offset:1024
    buffer_load_dwordx4 a[68:71], v2, s[4:7], s32 offen offset:1024 nt
    v_mfma_f32_16x16x32_bf16 v[28:31], a[72:75], v[8:11], 0
    v_mfma_f32_16x16x32_bf16 v[28:31], a[76:79], v[12:15], v[28:31]
    buffer_load_dwordx4 v[136:139], v3, s[8:11], s32 offen offset:2048
    buffer_load_dwordx4 a[72:75], v2, s[4:7], s32 offen offset:2048 nt
    buffer_load_dwordx4 v[140:143], v3, s[8:11], s32 offen offset:3072
    buffer_load_dwordx4 a[76:79], v2, s[4:7], s32 offen offset:3072 nt
    v_mfma_f32_16x16x32_bf16 v[32:35], a[80:83], v[8:11], 0
    v_mfma_f32_16x16x32_bf16 v[32:35], a[84:87], v[12:15], v[32:35]
    buffer_load_dwordx4 v[144:147], v3, s[8:11], s33 offen offset:0
    buffer_load_dwordx4 a[80:83], v2, s[4:7], s33 offen offset:0 nt
    buffer_load_dwordx4 v[148:151], v3, s[8:11], s33 offen offset:1024
    buffer_load_dwordx4 a[84:87], v2, s[4:7], s33 offen offset:1024 nt
    v_mfma_f32_16x16x32_bf16 v[36:39], a[88:91], v[8:11], 0
    v_mfma_f32_16x16x32_bf16 v[36:39], a[92:95], v[12:15], v[36:39]
    buffer_load_dwordx4 v[152:155], v3, s[8:11], s33 offen offset:2048
    buffer_load_dwordx4 a[88:91], v2, s[4:7], s33 offen offset:2048 nt
    buffer_load_dwordx4 v[156:159], v3, s[8:11], s33 offen offset:3072
    buffer_load_dwordx4 a[92:95], v2, s[4:7], s33 offen offset:3072 nt
    v_mov_b32_dpp v40, v24 quad_perm:[0,0,0,0] row_mask:0xf bank_mask:0xf
    v_mov_b32_dpp v41, v28 quad_perm:[0,0,0,0] row_mask:0xf bank_mask:0xf
    v_mov_b32_dpp v42, v32 quad_perm:[0,0,0,0] row_mask:0xf bank_mask:0xf
    v_add_f32_dpp v40, v25, v40 quad_perm:[1,1,1,1] row_mask:0xf bank_mask:0xf
    v_add_f32_dpp v41, v29, v41 quad_perm:[1,1,1,1] row_mask:0xf bank_mask:0xf
    v_add_f32_dpp v42, v33, v42 quad_perm:[1,1,1,1] row_mask:0xf bank_mask:0xf
    v_add_f32_dpp v40, v26, v40 quad_perm:[2,2,2,2] row_mask:0xf bank_mask:0xf
    v_add_f32_dpp v41, v30, v41 quad_perm:[2,2,2,2] row_mask:0xf bank_mask:0xf
    v_mov_b32_dpp v43, v36 quad_perm:[0,0,0,0] row_mask:0xf bank_mask:0xf
    v_add_f32_dpp v42, v34, v42 quad_perm:[2,2,2,2] row_mask:0xf bank_mask:0xf
    v_add_f32_dpp v40, v27, v40 quad_perm:[3,3,3,3] row_mask:0xf bank_mask:0xf
    v_add_f32_dpp v43, v37, v43 quad_perm:[1,1,1,1] row_mask:0xf bank_mask:0xf
    v_add_f32_dpp v41, v31, v41 quad_perm:[3,3,3,3] row_mask:0xf bank_mask:0xf
    v_add_f32_dpp v42, v35, v42 quad_perm:[3,3,3,3] row_mask:0xf bank_mask:0xf
    v_add_f32_dpp v43, v38, v43 quad_perm:[2,2,2,2] row_mask:0xf bank_mask:0xf
    v_max3_f32 v44, v40, v41, v20
    s_nop 0
    v_add_f32_dpp v43, v39, v43 quad_perm:[3,3,3,3] row_mask:0xf bank_mask:0xf
    v_max3_f32 v44, v44, v42, v43
    s_nop 1
    v_max_f32_dpp v44, v44, v44 row_half_mirror row_mask:0xf bank_mask:0xf
    v_mov_b32 v45, v44
    s_nop 1
    v_permlane16_swap_b32 v44, v45
    v_max_f32 v44, v44, v45
    v_mov_b32 v45, v44
    s_nop 1
    v_permlane32_swap_b32 v44, v45
    v_max_f32 v44, v44, v45
    v_sub_f32 v45, v20, v44
    v_mul_f32 v45, s30, v45
    v_exp_f32 v45, v45
    v_mov_b32 v20, v44
    v_mul_f32 v22, s30, v44
    v_fma_f32 v40, v40, s30, -v22
    v_fma_f32 v41, v41, s30, -v22
    v_fma_f32 v42, v42, s30, -v22
    v_fma_f32 v43, v43, s30, -v22
    v_exp_f32 v40, v40
    v_exp_f32 v41, v41
    v_exp_f32 v42, v42
    v_exp_f32 v43, v43
    v_mul_f32 v21, v21, v45
    v_mul_f32 v16, v16, v45
    v_mul_f32 v17, v17, v45
    v_mul_f32 v18, v18, v45
    v_mul_f32 v19, v19, v45
    v_add_f32 v46, v40, v41
    v_add_f32 v47, v42, v43
    v_cvt_pk_bf16_f32 v40, v40, v40
    v_cvt_pk_bf16_f32 v41, v41, v41
    v_cvt_pk_bf16_f32 v42, v42, v42
    v_cvt_pk_bf16_f32 v43, v43, v43
    v_add_f32 v46, v46, v47
    v_add_f32 v21, v21, v46
    v_and_b32 v24, v40, v4
    v_and_b32 v25, v40, v5
    v_and_b32_dpp v26, v40, v6 row_shr:4 row_mask:0xf bank_mask:0xf bound_ctrl:1
    v_and_b32_dpp v27, v40, v7 row_shr:4 row_mask:0xf bank_mask:0xf bound_ctrl:1
    v_and_b32_dpp v28, v40, v4 row_shl:4 row_mask:0xf bank_mask:0xf bound_ctrl:1
    v_and_b32_dpp v29, v40, v5 row_shl:4 row_mask:0xf bank_mask:0xf bound_ctrl:1
    v_and_b32 v30, v40, v6
    v_and_b32 v31, v40, v7
    v_mfma_f32_16x16x32_bf16 v[16:19], a[96:99], v[24:27], v[16:19]
    buffer_load_dwordx4 v[160:163], v3, s[8:11], s34 offen offset:0
    buffer_load_dwordx4 a[96:99], v2, s[4:7], s34 offen offset:0 nt
    v_and_b32 v32, v41, v4
    v_and_b32 v33, v41, v5
    v_and_b32_dpp v34, v41, v6 row_shr:4 row_mask:0xf bank_mask:0xf bound_ctrl:1
    v_and_b32_dpp v35, v41, v7 row_shr:4 row_mask:0xf bank_mask:0xf bound_ctrl:1
    v_mfma_f32_16x16x32_bf16 v[16:19], a[100:103], v[28:31], v[16:19]
    buffer_load_dwordx4 v[164:167], v3, s[8:11], s34 offen offset:1024
    buffer_load_dwordx4 a[100:103], v2, s[4:7], s34 offen offset:1024 nt
    v_and_b32_dpp v36, v41, v4 row_shl:4 row_mask:0xf bank_mask:0xf bound_ctrl:1
    v_and_b32_dpp v37, v41, v5 row_shl:4 row_mask:0xf bank_mask:0xf bound_ctrl:1
    v_and_b32 v38, v41, v6
    v_and_b32 v39, v41, v7
    v_mfma_f32_16x16x32_bf16 v[16:19], a[104:107], v[32:35], v[16:19]
    buffer_load_dwordx4 v[168:171], v3, s[8:11], s34 offen offset:2048
    buffer_load_dwordx4 a[104:107], v2, s[4:7], s34 offen offset:2048 nt
    v_and_b32 v24, v42, v4
    v_and_b32 v25, v42, v5
    v_and_b32_dpp v26, v42, v6 row_shr:4 row_mask:0xf bank_mask:0xf bound_ctrl:1
    v_and_b32_dpp v27, v42, v7 row_shr:4 row_mask:0xf bank_mask:0xf bound_ctrl:1
    v_mfma_f32_16x16x32_bf16 v[16:19], a[108:111], v[36:39], v[16:19]
    buffer_load_dwordx4 v[172:175], v3, s[8:11], s34 offen offset:3072
    buffer_load_dwordx4 a[108:111], v2, s[4:7], s34 offen offset:3072 nt
    v_and_b32_dpp v28, v42, v4 row_shl:4 row_mask:0xf bank_mask:0xf bound_ctrl:1
    v_and_b32_dpp v29, v42, v5 row_shl:4 row_mask:0xf bank_mask:0xf bound_ctrl:1
    v_and_b32 v30, v42, v6
    v_and_b32 v31, v42, v7
    v_mfma_f32_16x16x32_bf16 v[16:19], a[112:115], v[24:27], v[16:19]
    buffer_load_dwordx4 v[176:179], v3, s[8:11], s35 offen offset:0
    buffer_load_dwordx4 a[112:115], v2, s[4:7], s35 offen offset:0 nt
    v_and_b32 v32, v43, v4
    v_and_b32 v33, v43, v5
    v_and_b32_dpp v34, v43, v6 row_shr:4 row_mask:0xf bank_mask:0xf bound_ctrl:1
    v_and_b32_dpp v35, v43, v7 row_shr:4 row_mask:0xf bank_mask:0xf bound_ctrl:1
    v_mfma_f32_16x16x32_bf16 v[16:19], a[116:119], v[28:31], v[16:19]
    buffer_load_dwordx4 v[180:183], v3, s[8:11], s35 offen offset:1024
    buffer_load_dwordx4 a[116:119], v2, s[4:7], s35 offen offset:1024 nt
    v_and_b32_dpp v36, v43, v4 row_shl:4 row_mask:0xf bank_mask:0xf bound_ctrl:1
    v_and_b32_dpp v37, v43, v5 row_shl:4 row_mask:0xf bank_mask:0xf bound_ctrl:1
    v_and_b32 v38, v43, v6
    v_and_b32 v39, v43, v7
    v_mfma_f32_16x16x32_bf16 v[16:19], a[120:123], v[32:35], v[16:19]
    buffer_load_dwordx4 v[184:187], v3, s[8:11], s35 offen offset:2048
    buffer_load_dwordx4 a[120:123], v2, s[4:7], s35 offen offset:2048 nt
    v_mfma_f32_16x16x32_bf16 v[16:19], a[124:127], v[36:39], v[16:19]
    buffer_load_dwordx4 v[188:191], v3, s[8:11], s35 offen offset:3072
    buffer_load_dwordx4 a[124:127], v2, s[4:7], s35 offen offset:3072 nt
    s_add_u32 s32, s57, 2097152
    s_add_u32 s34, s57, 2621440
    s_xor_b32 s35, s34, 4096
    s_xor_b32 s33, s32, 4096
    s_waitcnt vmcnt(31)
    v_mfma_f32_16x16x32_bf16 v[24:27], a[128:131], v[8:11], 0
    v_mfma_f32_16x16x32_bf16 v[24:27], a[132:135], v[12:15], v[24:27]
    buffer_load_dwordx4 v[192:195], v3, s[8:11], s32 offen offset:0
    buffer_load_dwordx4 a[128:131], v2, s[4:7], s32 offen offset:0 nt
    buffer_load_dwordx4 v[196:199], v3, s[8:11], s32 offen offset:1024
    buffer_load_dwordx4 a[132:135], v2, s[4:7], s32 offen offset:1024 nt
    v_mfma_f32_16x16x32_bf16 v[28:31], a[136:139], v[8:11], 0
    v_mfma_f32_16x16x32_bf16 v[28:31], a[140:143], v[12:15], v[28:31]
    buffer_load_dwordx4 v[200:203], v3, s[8:11], s32 offen offset:2048
    buffer_load_dwordx4 a[136:139], v2, s[4:7], s32 offen offset:2048 nt
    buffer_load_dwordx4 v[204:207], v3, s[8:11], s32 offen offset:3072
    buffer_load_dwordx4 a[140:143], v2, s[4:7], s32 offen offset:3072 nt
    v_mfma_f32_16x16x32_bf16 v[32:35], a[144:147], v[8:11], 0
    v_mfma_f32_16x16x32_bf16 v[32:35], a[148:151], v[12:15], v[32:35]
    buffer_load_dwordx4 v[208:211], v3, s[8:11], s33 offen offset:0
    buffer_load_dwordx4 a[144:147], v2, s[4:7], s33 offen offset:0 nt
    buffer_load_dwordx4 v[212:215], v3, s[8:11], s33 offen offset:1024
    buffer_load_dwordx4 a[148:151], v2, s[4:7], s33 offen offset:1024 nt
    v_mfma_f32_16x16x32_bf16 v[36:39], a[152:155], v[8:11], 0
    v_mfma_f32_16x16x32_bf16 v[36:39], a[156:159], v[12:15], v[36:39]
    buffer_load_dwordx4 v[216:219], v3, s[8:11], s33 offen offset:2048
    buffer_load_dwordx4 a[152:155], v2, s[4:7], s33 offen offset:2048 nt
    buffer_load_dwordx4 v[220:223], v3, s[8:11], s33 offen offset:3072
    buffer_load_dwordx4 a[156:159], v2, s[4:7], s33 offen offset:3072 nt
    v_mov_b32_dpp v40, v24 quad_perm:[0,0,0,0] row_mask:0xf bank_mask:0xf
    v_mov_b32_dpp v41, v28 quad_perm:[0,0,0,0] row_mask:0xf bank_mask:0xf
    v_mov_b32_dpp v42, v32 quad_perm:[0,0,0,0] row_mask:0xf bank_mask:0xf
    v_add_f32_dpp v40, v25, v40 quad_perm:[1,1,1,1] row_mask:0xf bank_mask:0xf
    v_add_f32_dpp v41, v29, v41 quad_perm:[1,1,1,1] row_mask:0xf bank_mask:0xf
    v_add_f32_dpp v42, v33, v42 quad_perm:[1,1,1,1] row_mask:0xf bank_mask:0xf
    v_add_f32_dpp v40, v26, v40 quad_perm:[2,2,2,2] row_mask:0xf bank_mask:0xf
    v_add_f32_dpp v41, v30, v41 quad_perm:[2,2,2,2] row_mask:0xf bank_mask:0xf
    v_mov_b32_dpp v43, v36 quad_perm:[0,0,0,0] row_mask:0xf bank_mask:0xf
    v_add_f32_dpp v42, v34, v42 quad_perm:[2,2,2,2] row_mask:0xf bank_mask:0xf
    v_add_f32_dpp v40, v27, v40 quad_perm:[3,3,3,3] row_mask:0xf bank_mask:0xf
    v_add_f32_dpp v43, v37, v43 quad_perm:[1,1,1,1] row_mask:0xf bank_mask:0xf
    v_add_f32_dpp v41, v31, v41 quad_perm:[3,3,3,3] row_mask:0xf bank_mask:0xf
    v_add_f32_dpp v42, v35, v42 quad_perm:[3,3,3,3] row_mask:0xf bank_mask:0xf
    v_add_f32_dpp v43, v38, v43 quad_perm:[2,2,2,2] row_mask:0xf bank_mask:0xf
    v_max3_f32 v44, v40, v41, v20
    s_nop 0
    v_add_f32_dpp v43, v39, v43 quad_perm:[3,3,3,3] row_mask:0xf bank_mask:0xf
    v_max3_f32 v44, v44, v42, v43
    s_nop 1
    v_max_f32_dpp v44, v44, v44 row_half_mirror row_mask:0xf bank_mask:0xf
    v_mov_b32 v45, v44
    s_nop 1
    v_permlane16_swap_b32 v44, v45
    v_max_f32 v44, v44, v45
    v_mov_b32 v45, v44
    s_nop 1
    v_permlane32_swap_b32 v44, v45
    v_max_f32 v44, v44, v45
    v_sub_f32 v45, v20, v44
    v_mul_f32 v45, s30, v45
    v_exp_f32 v45, v45
    v_mov_b32 v20, v44
    v_mul_f32 v22, s30, v44
    v_fma_f32 v40, v40, s30, -v22
    v_fma_f32 v41, v41, s30, -v22
    v_fma_f32 v42, v42, s30, -v22
    v_fma_f32 v43, v43, s30, -v22
    v_exp_f32 v40, v40
    v_exp_f32 v41, v41
    v_exp_f32 v42, v42
    v_exp_f32 v43, v43
    v_mul_f32 v21, v21, v45
    v_mul_f32 v16, v16, v45
    v_mul_f32 v17, v17, v45
    v_mul_f32 v18, v18, v45
    v_mul_f32 v19, v19, v45
    v_add_f32 v46, v40, v41
    v_add_f32 v47, v42, v43
    v_cvt_pk_bf16_f32 v40, v40, v40
    v_cvt_pk_bf16_f32 v41, v41, v41
    v_cvt_pk_bf16_f32 v42, v42, v42
    v_cvt_pk_bf16_f32 v43, v43, v43
    v_add_f32 v46, v46, v47
    v_add_f32 v21, v21, v46
    v_and_b32 v24, v40, v4
    v_and_b32 v25, v40, v5
    v_and_b32_dpp v26, v40, v6 row_shr:4 row_mask:0xf bank_mask:0xf bound_ctrl:1
    v_and_b32_dpp v27, v40, v7 row_shr:4 row_mask:0xf bank_mask:0xf bound_ctrl:1
    v_and_b32_dpp v28, v40, v4 row_shl:4 row_mask:0xf bank_mask:0xf bound_ctrl:1
    v_and_b32_dpp v29, v40, v5 row_shl:4 row_mask:0xf bank_mask:0xf bound_ctrl:1
    v_and_b32 v30, v40, v6
    v_and_b32 v31, v40, v7
    v_mfma_f32_16x16x32_bf16 v[16:19], a[160:163], v[24:27], v[16:19]
    buffer_load_dwordx4 v[224:227], v3, s[8:11], s34 offen offset:0
    buffer_load_dwordx4 a[160:163], v2, s[4:7], s34 offen offset:0 nt
    v_and_b32 v32, v41, v4
    v_and_b32 v33, v41, v5
    v_and_b32_dpp v34, v41, v6 row_shr:4 row_mask:0xf bank_mask:0xf bound_ctrl:1
    v_and_b32_dpp v35, v41, v7 row_shr:4 row_mask:0xf bank_mask:0xf bound_ctrl:1
    v_mfma_f32_16x16x32_bf16 v[16:19], a[164:167], v[28:31], v[16:19]
    buffer_load_dwordx4 v[228:231], v3, s[8:11], s34 offen offset:1024
    buffer_load_dwordx4 a[164:167], v2, s[4:7], s34 offen offset:1024 nt
    v_and_b32_dpp v36, v41, v4 row_shl:4 row_mask:0xf bank_mask:0xf bound_ctrl:1
    v_and_b32_dpp v37, v41, v5 row_shl:4 row_mask:0xf bank_mask:0xf bound_ctrl:1
    v_and_b32 v38, v41, v6
    v_and_b32 v39, v41, v7
    v_mfma_f32_16x16x32_bf16 v[16:19], a[168:171], v[32:35], v[16:19]
    buffer_load_dwordx4 v[232:235], v3, s[8:11], s34 offen offset:2048
    buffer_load_dwordx4 a[168:171], v2, s[4:7], s34 offen offset:2048 nt
    v_and_b32 v24, v42, v4
    v_and_b32 v25, v42, v5
    v_and_b32_dpp v26, v42, v6 row_shr:4 row_mask:0xf bank_mask:0xf bound_ctrl:1
    v_and_b32_dpp v27, v42, v7 row_shr:4 row_mask:0xf bank_mask:0xf bound_ctrl:1
    v_mfma_f32_16x16x32_bf16 v[16:19], a[172:175], v[36:39], v[16:19]
    buffer_load_dwordx4 v[236:239], v3, s[8:11], s34 offen offset:3072
    buffer_load_dwordx4 a[172:175], v2, s[4:7], s34 offen offset:3072 nt
    v_and_b32_dpp v28, v42, v4 row_shl:4 row_mask:0xf bank_mask:0xf bound_ctrl:1
    v_and_b32_dpp v29, v42, v5 row_shl:4 row_mask:0xf bank_mask:0xf bound_ctrl:1
    v_and_b32 v30, v42, v6
    v_and_b32 v31, v42, v7
    v_mfma_f32_16x16x32_bf16 v[16:19], a[176:179], v[24:27], v[16:19]
    buffer_load_dwordx4 v[240:243], v3, s[8:11], s35 offen offset:0
    buffer_load_dwordx4 a[176:179], v2, s[4:7], s35 offen offset:0 nt
    v_and_b32 v32, v43, v4
    v_and_b32 v33, v43, v5
    v_and_b32_dpp v34, v43, v6 row_shr:4 row_mask:0xf bank_mask:0xf bound_ctrl:1
    v_and_b32_dpp v35, v43, v7 row_shr:4 row_mask:0xf bank_mask:0xf bound_ctrl:1
    v_mfma_f32_16x16x32_bf16 v[16:19], a[180:183], v[28:31], v[16:19]
    buffer_load_dwordx4 v[244:247], v3, s[8:11], s35 offen offset:1024
    buffer_load_dwordx4 a[180:183], v2, s[4:7], s35 offen offset:1024 nt
    v_and_b32_dpp v36, v43, v4 row_shl:4 row_mask:0xf bank_mask:0xf bound_ctrl:1
    v_and_b32_dpp v37, v43, v5 row_shl:4 row_mask:0xf bank_mask:0xf bound_ctrl:1
    v_and_b32 v38, v43, v6
    v_and_b32 v39, v43, v7
    v_mfma_f32_16x16x32_bf16 v[16:19], a[184:187], v[32:35], v[16:19]
    buffer_load_dwordx4 v[248:251], v3, s[8:11], s35 offen offset:2048
    buffer_load_dwordx4 a[184:187], v2, s[4:7], s35 offen offset:2048 nt
    v_mfma_f32_16x16x32_bf16 v[16:19], a[188:191], v[36:39], v[16:19]
    buffer_load_dwordx4 v[252:255], v3, s[8:11], s35 offen offset:3072
    buffer_load_dwordx4 a[188:191], v2, s[4:7], s35 offen offset:3072 nt
    s_add_u32 s32, s57, 3145728
    s_add_u32 s34, s57, 3670016
    s_xor_b32 s35, s34, 4096
    s_xor_b32 s33, s32, 4096
    s_waitcnt vmcnt(31)
    v_mfma_f32_16x16x32_bf16 v[24:27], a[192:195], v[8:11], 0
    v_mfma_f32_16x16x32_bf16 v[24:27], a[196:199], v[12:15], v[24:27]
    buffer_load_dwordx4 a[192:195], v2, s[4:7], s32 offen offset:0 nt
    buffer_load_dwordx4 a[196:199], v2, s[4:7], s32 offen offset:1024 nt
    v_mfma_f32_16x16x32_bf16 v[28:31], a[200:203], v[8:11], 0
    v_mfma_f32_16x16x32_bf16 v[28:31], a[204:207], v[12:15], v[28:31]
    buffer_load_dwordx4 a[200:203], v2, s[4:7], s32 offen offset:2048 nt
    buffer_load_dwordx4 a[204:207], v2, s[4:7], s32 offen offset:3072 nt
    v_mfma_f32_16x16x32_bf16 v[32:35], a[208:211], v[8:11], 0
    v_mfma_f32_16x16x32_bf16 v[32:35], a[212:215], v[12:15], v[32:35]
    buffer_load_dwordx4 a[208:211], v2, s[4:7], s33 offen offset:0 nt
    buffer_load_dwordx4 a[212:215], v2, s[4:7], s33 offen offset:1024 nt
    v_mfma_f32_16x16x32_bf16 v[36:39], a[216:219], v[8:11], 0
    v_mfma_f32_16x16x32_bf16 v[36:39], a[220:223], v[12:15], v[36:39]
    buffer_load_dwordx4 a[216:219], v2, s[4:7], s33 offen offset:2048 nt
    buffer_load_dwordx4 a[220:223], v2, s[4:7], s33 offen offset:3072 nt
    v_mov_b32_dpp v40, v24 quad_perm:[0,0,0,0] row_mask:0xf bank_mask:0xf
    v_mov_b32_dpp v41, v28 quad_perm:[0,0,0,0] row_mask:0xf bank_mask:0xf
    v_mov_b32_dpp v42, v32 quad_perm:[0,0,0,0] row_mask:0xf bank_mask:0xf
    v_add_f32_dpp v40, v25, v40 quad_perm:[1,1,1,1] row_mask:0xf bank_mask:0xf
    v_add_f32_dpp v41, v29, v41 quad_perm:[1,1,1,1] row_mask:0xf bank_mask:0xf
    v_add_f32_dpp v42, v33, v42 quad_perm:[1,1,1,1] row_mask:0xf bank_mask:0xf
    v_add_f32_dpp v40, v26, v40 quad_perm:[2,2,2,2] row_mask:0xf bank_mask:0xf
    v_add_f32_dpp v41, v30, v41 quad_perm:[2,2,2,2] row_mask:0xf bank_mask:0xf
    v_mov_b32_dpp v43, v36 quad_perm:[0,0,0,0] row_mask:0xf bank_mask:0xf
    v_add_f32_dpp v42, v34, v42 quad_perm:[2,2,2,2] row_mask:0xf bank_mask:0xf
    v_add_f32_dpp v40, v27, v40 quad_perm:[3,3,3,3] row_mask:0xf bank_mask:0xf
    v_add_f32_dpp v43, v37, v43 quad_perm:[1,1,1,1] row_mask:0xf bank_mask:0xf
    v_add_f32_dpp v41, v31, v41 quad_perm:[3,3,3,3] row_mask:0xf bank_mask:0xf
    v_add_f32_dpp v42, v35, v42 quad_perm:[3,3,3,3] row_mask:0xf bank_mask:0xf
    v_add_f32_dpp v43, v38, v43 quad_perm:[2,2,2,2] row_mask:0xf bank_mask:0xf
    v_max3_f32 v44, v40, v41, v20
    s_nop 0
    v_add_f32_dpp v43, v39, v43 quad_perm:[3,3,3,3] row_mask:0xf bank_mask:0xf
    v_max3_f32 v44, v44, v42, v43
    s_nop 1
    v_max_f32_dpp v44, v44, v44 row_half_mirror row_mask:0xf bank_mask:0xf
    v_mov_b32 v45, v44
    s_nop 1
    v_permlane16_swap_b32 v44, v45
    v_max_f32 v44, v44, v45
    v_mov_b32 v45, v44
    s_nop 1
    v_permlane32_swap_b32 v44, v45
    v_max_f32 v44, v44, v45
    v_sub_f32 v45, v20, v44
    v_mul_f32 v45, s30, v45
    v_exp_f32 v45, v45
    v_mov_b32 v20, v44
    v_mul_f32 v22, s30, v44
    v_fma_f32 v40, v40, s30, -v22
    v_fma_f32 v41, v41, s30, -v22
    v_fma_f32 v42, v42, s30, -v22
    v_fma_f32 v43, v43, s30, -v22
    v_exp_f32 v40, v40
    v_exp_f32 v41, v41
    v_exp_f32 v42, v42
    v_exp_f32 v43, v43
    v_mul_f32 v21, v21, v45
    v_mul_f32 v16, v16, v45
    v_mul_f32 v17, v17, v45
    v_mul_f32 v18, v18, v45
    v_mul_f32 v19, v19, v45
    v_add_f32 v46, v40, v41
    v_add_f32 v47, v42, v43
    v_cvt_pk_bf16_f32 v40, v40, v40
    v_cvt_pk_bf16_f32 v41, v41, v41
    v_cvt_pk_bf16_f32 v42, v42, v42
    v_cvt_pk_bf16_f32 v43, v43, v43
    v_add_f32 v46, v46, v47
    v_add_f32 v21, v21, v46
    v_and_b32 v24, v40, v4
    v_and_b32 v25, v40, v5
    v_and_b32_dpp v26, v40, v6 row_shr:4 row_mask:0xf bank_mask:0xf bound_ctrl:1
    v_and_b32_dpp v27, v40, v7 row_shr:4 row_mask:0xf bank_mask:0xf bound_ctrl:1
    v_and_b32_dpp v28, v40, v4 row_shl:4 row_mask:0xf bank_mask:0xf bound_ctrl:1
    v_and_b32_dpp v29, v40, v5 row_shl:4 row_mask:0xf bank_mask:0xf bound_ctrl:1
    v_and_b32 v30, v40, v6
    v_and_b32 v31, v40, v7
    v_mfma_f32_16x16x32_bf16 v[16:19], a[224:227], v[24:27], v[16:19]
    buffer_load_dwordx4 a[224:227], v2, s[4:7], s34 offen offset:0 nt
    v_and_b32 v32, v41, v4
    v_and_b32 v33, v41, v5
    v_and_b32_dpp v34, v41, v6 row_shr:4 row_mask:0xf bank_mask:0xf bound_ctrl:1
    v_and_b32_dpp v35, v41, v7 row_shr:4 row_mask:0xf bank_mask:0xf bound_ctrl:1
    v_mfma_f32_16x16x32_bf16 v[16:19], a[228:231], v[28:31], v[16:19]
    buffer_load_dwordx4 a[228:231], v2, s[4:7], s34 offen offset:1024 nt
    v_and_b32_dpp v36, v41, v4 row_shl:4 row_mask:0xf bank_mask:0xf bound_ctrl:1
    v_and_b32_dpp v37, v41, v5 row_shl:4 row_mask:0xf bank_mask:0xf bound_ctrl:1
    v_and_b32 v38, v41, v6
    v_and_b32 v39, v41, v7
    v_mfma_f32_16x16x32_bf16 v[16:19], a[232:235], v[32:35], v[16:19]
    buffer_load_dwordx4 a[232:235], v2, s[4:7], s34 offen offset:2048 nt
    v_and_b32 v24, v42, v4
    v_and_b32 v25, v42, v5
    v_and_b32_dpp v26, v42, v6 row_shr:4 row_mask:0xf bank_mask:0xf bound_ctrl:1
    v_and_b32_dpp v27, v42, v7 row_shr:4 row_mask:0xf bank_mask:0xf bound_ctrl:1
    v_mfma_f32_16x16x32_bf16 v[16:19], a[236:239], v[36:39], v[16:19]
    buffer_load_dwordx4 a[236:239], v2, s[4:7], s34 offen offset:3072 nt
    v_and_b32_dpp v28, v42, v4 row_shl:4 row_mask:0xf bank_mask:0xf bound_ctrl:1
    v_and_b32_dpp v29, v42, v5 row_shl:4 row_mask:0xf bank_mask:0xf bound_ctrl:1
    v_and_b32 v30, v42, v6
    v_and_b32 v31, v42, v7
    v_mfma_f32_16x16x32_bf16 v[16:19], a[240:243], v[24:27], v[16:19]
    buffer_load_dwordx4 a[240:243], v2, s[4:7], s35 offen offset:0 nt
    v_and_b32 v32, v43, v4
    v_and_b32 v33, v43, v5
    v_and_b32_dpp v34, v43, v6 row_shr:4 row_mask:0xf bank_mask:0xf bound_ctrl:1
    v_and_b32_dpp v35, v43, v7 row_shr:4 row_mask:0xf bank_mask:0xf bound_ctrl:1
    v_mfma_f32_16x16x32_bf16 v[16:19], a[244:247], v[28:31], v[16:19]
    buffer_load_dwordx4 a[244:247], v2, s[4:7], s35 offen offset:1024 nt
    v_and_b32_dpp v36, v43, v4 row_shl:4 row_mask:0xf bank_mask:0xf bound_ctrl:1
    v_and_b32_dpp v37, v43, v5 row_shl:4 row_mask:0xf bank_mask:0xf bound_ctrl:1
    v_and_b32 v38, v43, v6
    v_and_b32 v39, v43, v7
    v_mfma_f32_16x16x32_bf16 v[16:19], a[248:251], v[32:35], v[16:19]
    buffer_load_dwordx4 a[248:251], v2, s[4:7], s35 offen offset:2048 nt
    v_mfma_f32_16x16x32_bf16 v[16:19], a[252:255], v[36:39], v[16:19]
    buffer_load_dwordx4 a[252:255], v2, s[4:7], s35 offen offset:3072 nt
    s_add_u32 s32, s57, 3145728
    s_add_u32 s34, s57, 3670016
    s_xor_b32 s35, s34, 4096
    s_xor_b32 s33, s32, 4096
    s_waitcnt vmcnt(47)
    v_mfma_f32_16x16x32_bf16 v[24:27], a[0:3], v[8:11], 0
    v_mfma_f32_16x16x32_bf16 v[24:27], a[4:7], v[12:15], v[24:27]
    v_mfma_f32_16x16x32_bf16 v[28:31], a[8:11], v[8:11], 0
    v_mfma_f32_16x16x32_bf16 v[28:31], a[12:15], v[12:15], v[28:31]
    v_mfma_f32_16x16x32_bf16 v[32:35], a[16:19], v[8:11], 0
    v_mfma_f32_16x16x32_bf16 v[32:35], a[20:23], v[12:15], v[32:35]
    v_mfma_f32_16x16x32_bf16 v[36:39], a[24:27], v[8:11], 0
    v_mfma_f32_16x16x32_bf16 v[36:39], a[28:31], v[12:15], v[36:39]
    s_nop 1
    v_mov_b32_dpp v40, v24 quad_perm:[0,0,0,0] row_mask:0xf bank_mask:0xf
    s_nop 0
    v_mov_b32_dpp v41, v28 quad_perm:[0,0,0,0] row_mask:0xf bank_mask:0xf
    s_nop 0
    v_mov_b32_dpp v42, v32 quad_perm:[0,0,0,0] row_mask:0xf bank_mask:0xf
    v_add_f32_dpp v40, v25, v40 quad_perm:[1,1,1,1] row_mask:0xf bank_mask:0xf
    v_add_f32_dpp v41, v29, v41 quad_perm:[1,1,1,1] row_mask:0xf bank_mask:0xf
    v_add_f32_dpp v42, v33, v42 quad_perm:[1,1,1,1] row_mask:0xf bank_mask:0xf
    v_add_f32_dpp v40, v26, v40 quad_perm:[2,2,2,2] row_mask:0xf bank_mask:0xf
    v_add_f32_dpp v41, v30, v41 quad_perm:[2,2,2,2] row_mask:0xf bank_mask:0xf
    v_mov_b32_dpp v43, v36 quad_perm:[0,0,0,0] row_mask:0xf bank_mask:0xf
    v_add_f32_dpp v42, v34, v42 quad_perm:[2,2,2,2] row_mask:0xf bank_mask:0xf
    v_add_f32_dpp v40, v27, v40 quad_perm:[3,3,3,3] row_mask:0xf bank_mask:0xf
    v_add_f32_dpp v43, v37, v43 quad_perm:[1,1,1,1] row_mask:0xf bank_mask:0xf
    v_add_f32_dpp v41, v31, v41 quad_perm:[3,3,3,3] row_mask:0xf bank_mask:0xf
    v_add_f32_dpp v42, v35, v42 quad_perm:[3,3,3,3] row_mask:0xf bank_mask:0xf
    v_add_f32_dpp v43, v38, v43 quad_perm:[2,2,2,2] row_mask:0xf bank_mask:0xf
    v_max3_f32 v44, v40, v41, v20
    s_nop 0
    v_add_f32_dpp v43, v39, v43 quad_perm:[3,3,3,3] row_mask:0xf bank_mask:0xf
    v_max3_f32 v44, v44, v42, v43
    s_nop 1
    v_max_f32_dpp v44, v44, v44 row_half_mirror row_mask:0xf bank_mask:0xf
    v_mov_b32 v45, v44
    s_nop 1
    v_permlane16_swap_b32 v44, v45
    v_max_f32 v44, v44, v45
    v_mov_b32 v45, v44
    s_nop 1
    v_permlane32_swap_b32 v44, v45
    v_max_f32 v44, v44, v45
    v_sub_f32 v45, v20, v44
    v_mul_f32 v45, s30, v45
    v_exp_f32 v45, v45
    v_mov_b32 v20, v44
    v_mul_f32 v22, s30, v44
    v_fma_f32 v40, v40, s30, -v22
    v_fma_f32 v41, v41, s30, -v22
    v_fma_f32 v42, v42, s30, -v22
    v_fma_f32 v43, v43, s30, -v22
    v_exp_f32 v40, v40
    v_exp_f32 v41, v41
    v_exp_f32 v42, v42
    v_exp_f32 v43, v43
    v_mul_f32 v21, v21, v45
    v_mul_f32 v16, v16, v45
    v_mul_f32 v17, v17, v45
    v_mul_f32 v18, v18, v45
    v_mul_f32 v19, v19, v45
    v_add_f32 v46, v40, v41
    v_add_f32 v47, v42, v43
    v_cvt_pk_bf16_f32 v40, v40, v40
    v_cvt_pk_bf16_f32 v41, v41, v41
    v_cvt_pk_bf16_f32 v42, v42, v42
    v_cvt_pk_bf16_f32 v43, v43, v43
    v_add_f32 v46, v46, v47
    v_add_f32 v21, v21, v46
    v_and_b32 v24, v40, v4
    v_and_b32 v25, v40, v5
    v_and_b32_dpp v26, v40, v6 row_shr:4 row_mask:0xf bank_mask:0xf bound_ctrl:1
    v_and_b32_dpp v27, v40, v7 row_shr:4 row_mask:0xf bank_mask:0xf bound_ctrl:1
    v_and_b32_dpp v28, v40, v4 row_shl:4 row_mask:0xf bank_mask:0xf bound_ctrl:1
    v_and_b32_dpp v29, v40, v5 row_shl:4 row_mask:0xf bank_mask:0xf bound_ctrl:1
    v_and_b32 v30, v40, v6
    v_and_b32 v31, v40, v7
    v_mfma_f32_16x16x32_bf16 v[16:19], v[64:67], v[24:27], v[16:19]
    buffer_load_dwordx4 v[64:67], v3, s[8:11], s32 offen offset:0
    v_and_b32 v32, v41, v4
    v_and_b32 v33, v41, v5
    v_and_b32_dpp v34, v41, v6 row_shr:4 row_mask:0xf bank_mask:0xf bound_ctrl:1
    v_and_b32_dpp v35, v41, v7 row_shr:4 row_mask:0xf bank_mask:0xf bound_ctrl:1
    v_mfma_f32_16x16x32_bf16 v[16:19], v[68:71], v[28:31], v[16:19]
    buffer_load_dwordx4 v[68:71], v3, s[8:11], s32 offen offset:1024
    v_and_b32_dpp v36, v41, v4 row_shl:4 row_mask:0xf bank_mask:0xf bound_ctrl:1
    v_and_b32_dpp v37, v41, v5 row_shl:4 row_mask:0xf bank_mask:0xf bound_ctrl:1
    v_and_b32 v38, v41, v6
    v_and_b32 v39, v41, v7
    v_mfma_f32_16x16x32_bf16 v[16:19], v[72:75], v[32:35], v[16:19]
    buffer_load_dwordx4 v[72:75], v3, s[8:11], s32 offen offset:2048
    v_and_b32 v24, v42, v4
    v_and_b32 v25, v42, v5
    v_and_b32_dpp v26, v42, v6 row_shr:4 row_mask:0xf bank_mask:0xf bound_ctrl:1
    v_and_b32_dpp v27, v42, v7 row_shr:4 row_mask:0xf bank_mask:0xf bound_ctrl:1
    v_mfma_f32_16x16x32_bf16 v[16:19], v[76:79], v[36:39], v[16:19]
    buffer_load_dwordx4 v[76:79], v3, s[8:11], s32 offen offset:3072
    v_and_b32_dpp v28, v42, v4 row_shl:4 row_mask:0xf bank_mask:0xf bound_ctrl:1
    v_and_b32_dpp v29, v42, v5 row_shl:4 row_mask:0xf bank_mask:0xf bound_ctrl:1
    v_and_b32 v30, v42, v6
    v_and_b32 v31, v42, v7
    v_mfma_f32_16x16x32_bf16 v[16:19], v[80:83], v[24:27], v[16:19]
    buffer_load_dwordx4 v[80:83], v3, s[8:11], s33 offen offset:0
    v_and_b32 v32, v43, v4
    v_and_b32 v33, v43, v5
    v_and_b32_dpp v34, v43, v6 row_shr:4 row_mask:0xf bank_mask:0xf bound_ctrl:1
    v_and_b32_dpp v35, v43, v7 row_shr:4 row_mask:0xf bank_mask:0xf bound_ctrl:1
    v_mfma_f32_16x16x32_bf16 v[16:19], v[84:87], v[28:31], v[16:19]
    buffer_load_dwordx4 v[84:87], v3, s[8:11], s33 offen offset:1024
    v_and_b32_dpp v36, v43, v4 row_shl:4 row_mask:0xf bank_mask:0xf bound_ctrl:1
    v_and_b32_dpp v37, v43, v5 row_shl:4 row_mask:0xf bank_mask:0xf bound_ctrl:1
    v_and_b32 v38, v43, v6
    v_and_b32 v39, v43, v7
    v_mfma_f32_16x16x32_bf16 v[16:19], v[88:91], v[32:35], v[16:19]
    buffer_load_dwordx4 v[88:91], v3, s[8:11], s33 offen offset:2048
    v_mfma_f32_16x16x32_bf16 v[16:19], v[92:95], v[36:39], v[16:19]
    buffer_load_dwordx4 v[92:95], v3, s[8:11], s33 offen offset:3072
    v_mfma_f32_16x16x32_bf16 v[24:27], a[32:35], v[8:11], 0
    v_mfma_f32_16x16x32_bf16 v[24:27], a[36:39], v[12:15], v[24:27]
    v_mfma_f32_16x16x32_bf16 v[28:31], a[40:43], v[8:11], 0
    v_mfma_f32_16x16x32_bf16 v[28:31], a[44:47], v[12:15], v[28:31]
    v_mfma_f32_16x16x32_bf16 v[32:35], a[48:51], v[8:11], 0
    v_mfma_f32_16x16x32_bf16 v[32:35], a[52:55], v[12:15], v[32:35]
    v_mfma_f32_16x16x32_bf16 v[36:39], a[56:59], v[8:11], 0
    v_mfma_f32_16x16x32_bf16 v[36:39], a[60:63], v[12:15], v[36:39]
    s_nop 1
    v_mov_b32_dpp v40, v24 quad_perm:[0,0,0,0] row_mask:0xf bank_mask:0xf
    s_nop 0
    v_mov_b32_dpp v41, v28 quad_perm:[0,0,0,0] row_mask:0xf bank_mask:0xf
    s_nop 0
    v_mov_b32_dpp v42, v32 quad_perm:[0,0,0,0] row_mask:0xf bank_mask:0xf
    v_add_f32_dpp v40, v25, v40 quad_perm:[1,1,1,1] row_mask:0xf bank_mask:0xf
    v_add_f32_dpp v41, v29, v41 quad_perm:[1,1,1,1] row_mask:0xf bank_mask:0xf
    v_add_f32_dpp v42, v33, v42 quad_perm:[1,1,1,1] row_mask:0xf bank_mask:0xf
    v_add_f32_dpp v40, v26, v40 quad_perm:[2,2,2,2] row_mask:0xf bank_mask:0xf
    v_add_f32_dpp v41, v30, v41 quad_perm:[2,2,2,2] row_mask:0xf bank_mask:0xf
    v_mov_b32_dpp v43, v36 quad_perm:[0,0,0,0] row_mask:0xf bank_mask:0xf
    v_add_f32_dpp v42, v34, v42 quad_perm:[2,2,2,2] row_mask:0xf bank_mask:0xf
    v_add_f32_dpp v40, v27, v40 quad_perm:[3,3,3,3] row_mask:0xf bank_mask:0xf
    v_add_f32_dpp v43, v37, v43 quad_perm:[1,1,1,1] row_mask:0xf bank_mask:0xf
    v_add_f32_dpp v41, v31, v41 quad_perm:[3,3,3,3] row_mask:0xf bank_mask:0xf
    v_add_f32_dpp v42, v35, v42 quad_perm:[3,3,3,3] row_mask:0xf bank_mask:0xf
    v_add_f32_dpp v43, v38, v43 quad_perm:[2,2,2,2] row_mask:0xf bank_mask:0xf
    v_max3_f32 v44, v40, v41, v20
    s_nop 0
    v_add_f32_dpp v43, v39, v43 quad_perm:[3,3,3,3] row_mask:0xf bank_mask:0xf
    v_max3_f32 v44, v44, v42, v43
    s_nop 1
    v_max_f32_dpp v44, v44, v44 row_half_mirror row_mask:0xf bank_mask:0xf
    v_mov_b32 v45, v44
    s_nop 1
    v_permlane16_swap_b32 v44, v45
    v_max_f32 v44, v44, v45
    v_mov_b32 v45, v44
    s_nop 1
    v_permlane32_swap_b32 v44, v45
    v_max_f32 v44, v44, v45
    v_sub_f32 v45, v20, v44
    v_mul_f32 v45, s30, v45
    v_exp_f32 v45, v45
    v_mov_b32 v20, v44
    v_mul_f32 v22, s30, v44
    v_fma_f32 v40, v40, s30, -v22
    v_fma_f32 v41, v41, s30, -v22
    v_fma_f32 v42, v42, s30, -v22
    v_fma_f32 v43, v43, s30, -v22
    v_exp_f32 v40, v40
    v_exp_f32 v41, v41
    v_exp_f32 v42, v42
    v_exp_f32 v43, v43
    v_mul_f32 v21, v21, v45
    v_mul_f32 v16, v16, v45
    v_mul_f32 v17, v17, v45
    v_mul_f32 v18, v18, v45
    v_mul_f32 v19, v19, v45
    v_add_f32 v46, v40, v41
    v_add_f32 v47, v42, v43
    v_cvt_pk_bf16_f32 v40, v40, v40
    v_cvt_pk_bf16_f32 v41, v41, v41
    v_cvt_pk_bf16_f32 v42, v42, v42
    v_cvt_pk_bf16_f32 v43, v43, v43
    v_add_f32 v46, v46, v47
    v_add_f32 v21, v21, v46
    v_and_b32 v24, v40, v4
    v_and_b32 v25, v40, v5
    v_and_b32_dpp v26, v40, v6 row_shr:4 row_mask:0xf bank_mask:0xf bound_ctrl:1
    v_and_b32_dpp v27, v40, v7 row_shr:4 row_mask:0xf bank_mask:0xf bound_ctrl:1
    v_and_b32_dpp v28, v40, v4 row_shl:4 row_mask:0xf bank_mask:0xf bound_ctrl:1
    v_and_b32_dpp v29, v40, v5 row_shl:4 row_mask:0xf bank_mask:0xf bound_ctrl:1
    v_and_b32 v30, v40, v6
    v_and_b32 v31, v40, v7
    v_mfma_f32_16x16x32_bf16 v[16:19], v[96:99], v[24:27], v[16:19]
    buffer_load_dwordx4 v[96:99], v3, s[8:11], s34 offen offset:0
    v_and_b32 v32, v41, v4
    v_and_b32 v33, v41, v5
    v_and_b32_dpp v34, v41, v6 row_shr:4 row_mask:0xf bank_mask:0xf bound_ctrl:1
    v_and_b32_dpp v35, v41, v7 row_shr:4 row_mask:0xf bank_mask:0xf bound_ctrl:1
    v_mfma_f32_16x16x32_bf16 v[16:19], v[100:103], v[28:31], v[16:19]
    buffer_load_dwordx4 v[100:103], v3, s[8:11], s34 offen offset:1024
    v_and_b32_dpp v36, v41, v4 row_shl:4 row_mask:0xf bank_mask:0xf bound_ctrl:1
    v_and_b32_dpp v37, v41, v5 row_shl:4 row_mask:0xf bank_mask:0xf bound_ctrl:1
    v_and_b32 v38, v41, v6
    v_and_b32 v39, v41, v7
    v_mfma_f32_16x16x32_bf16 v[16:19], v[104:107], v[32:35], v[16:19]
    buffer_load_dwordx4 v[104:107], v3, s[8:11], s34 offen offset:2048
    v_and_b32 v24, v42, v4
    v_and_b32 v25, v42, v5
    v_and_b32_dpp v26, v42, v6 row_shr:4 row_mask:0xf bank_mask:0xf bound_ctrl:1
    v_and_b32_dpp v27, v42, v7 row_shr:4 row_mask:0xf bank_mask:0xf bound_ctrl:1
    v_mfma_f32_16x16x32_bf16 v[16:19], v[108:111], v[36:39], v[16:19]
    buffer_load_dwordx4 v[108:111], v3, s[8:11], s34 offen offset:3072
    v_and_b32_dpp v28, v42, v4 row_shl:4 row_mask:0xf bank_mask:0xf bound_ctrl:1
    v_and_b32_dpp v29, v42, v5 row_shl:4 row_mask:0xf bank_mask:0xf bound_ctrl:1
    v_and_b32 v30, v42, v6
    v_and_b32 v31, v42, v7
    v_mfma_f32_16x16x32_bf16 v[16:19], v[112:115], v[24:27], v[16:19]
    buffer_load_dwordx4 v[112:115], v3, s[8:11], s35 offen offset:0
    v_and_b32 v32, v43, v4
    v_and_b32 v33, v43, v5
    v_and_b32_dpp v34, v43, v6 row_shr:4 row_mask:0xf bank_mask:0xf bound_ctrl:1
    v_and_b32_dpp v35, v43, v7 row_shr:4 row_mask:0xf bank_mask:0xf bound_ctrl:1
    v_mfma_f32_16x16x32_bf16 v[16:19], v[116:119], v[28:31], v[16:19]
    buffer_load_dwordx4 v[116:119], v3, s[8:11], s35 offen offset:1024
    v_and_b32_dpp v36, v43, v4 row_shl:4 row_mask:0xf bank_mask:0xf bound_ctrl:1
    v_and_b32_dpp v37, v43, v5 row_shl:4 row_mask:0xf bank_mask:0xf bound_ctrl:1
    v_and_b32 v38, v43, v6
    v_and_b32 v39, v43, v7
    v_mfma_f32_16x16x32_bf16 v[16:19], v[120:123], v[32:35], v[16:19]
    buffer_load_dwordx4 v[120:123], v3, s[8:11], s35 offen offset:2048
    v_mfma_f32_16x16x32_bf16 v[16:19], v[124:127], v[36:39], v[16:19]
    buffer_load_dwordx4 v[124:127], v3, s[8:11], s35 offen offset:3072
    s_add_u32 s32, s57, 4194304
    s_xor_b32 s32, s32, 8192
    s_add_u32 s34, s57, 4718592
    s_xor_b32 s34, s34, 8192
    s_xor_b32 s35, s34, 4096
    s_xor_b32 s33, s32, 4096
    s_waitcnt vmcnt(47)
    v_mfma_f32_16x16x32_bf16 v[24:27], a[64:67], v[8:11], 0
    v_mfma_f32_16x16x32_bf16 v[24:27], a[68:71], v[12:15], v[24:27]
    v_mfma_f32_16x16x32_bf16 v[28:31], a[72:75], v[8:11], 0
    v_mfma_f32_16x16x32_bf16 v[28:31], a[76:79], v[12:15], v[28:31]
    v_mfma_f32_16x16x32_bf16 v[32:35], a[80:83], v[8:11], 0
    v_mfma_f32_16x16x32_bf16 v[32:35], a[84:87], v[12:15], v[32:35]
    v_mfma_f32_16x16x32_bf16 v[36:39], a[88:91], v[8:11], 0
    v_mfma_f32_16x16x32_bf16 v[36:39], a[92:95], v[12:15], v[36:39]
    s_nop 1
    v_mov_b32_dpp v40, v24 quad_perm:[0,0,0,0] row_mask:0xf bank_mask:0xf
    s_nop 0
    v_mov_b32_dpp v41, v28 quad_perm:[0,0,0,0] row_mask:0xf bank_mask:0xf
    s_nop 0
    v_mov_b32_dpp v42, v32 quad_perm:[0,0,0,0] row_mask:0xf bank_mask:0xf
    v_add_f32_dpp v40, v25, v40 quad_perm:[1,1,1,1] row_mask:0xf bank_mask:0xf
    v_add_f32_dpp v41, v29, v41 quad_perm:[1,1,1,1] row_mask:0xf bank_mask:0xf
    v_add_f32_dpp v42, v33, v42 quad_perm:[1,1,1,1] row_mask:0xf bank_mask:0xf
    v_add_f32_dpp v40, v26, v40 quad_perm:[2,2,2,2] row_mask:0xf bank_mask:0xf
    v_add_f32_dpp v41, v30, v41 quad_perm:[2,2,2,2] row_mask:0xf bank_mask:0xf
    v_mov_b32_dpp v43, v36 quad_perm:[0,0,0,0] row_mask:0xf bank_mask:0xf
    v_add_f32_dpp v42, v34, v42 quad_perm:[2,2,2,2] row_mask:0xf bank_mask:0xf
    v_add_f32_dpp v40, v27, v40 quad_perm:[3,3,3,3] row_mask:0xf bank_mask:0xf
    v_add_f32_dpp v43, v37, v43 quad_perm:[1,1,1,1] row_mask:0xf bank_mask:0xf
    v_add_f32_dpp v41, v31, v41 quad_perm:[3,3,3,3] row_mask:0xf bank_mask:0xf
    v_add_f32_dpp v42, v35, v42 quad_perm:[3,3,3,3] row_mask:0xf bank_mask:0xf
    v_add_f32_dpp v43, v38, v43 quad_perm:[2,2,2,2] row_mask:0xf bank_mask:0xf
    v_max3_f32 v44, v40, v41, v20
    s_nop 0
    v_add_f32_dpp v43, v39, v43 quad_perm:[3,3,3,3] row_mask:0xf bank_mask:0xf
    v_max3_f32 v44, v44, v42, v43
    s_nop 1
    v_max_f32_dpp v44, v44, v44 row_half_mirror row_mask:0xf bank_mask:0xf
    v_mov_b32 v45, v44
    s_nop 1
    v_permlane16_swap_b32 v44, v45
    v_max_f32 v44, v44, v45
    v_mov_b32 v45, v44
    s_nop 1
    v_permlane32_swap_b32 v44, v45
    v_max_f32 v44, v44, v45
    v_sub_f32 v45, v20, v44
    v_mul_f32 v45, s30, v45
    v_exp_f32 v45, v45
    v_mov_b32 v20, v44
    v_mul_f32 v22, s30, v44
    v_fma_f32 v40, v40, s30, -v22
    v_fma_f32 v41, v41, s30, -v22
    v_fma_f32 v42, v42, s30, -v22
    v_fma_f32 v43, v43, s30, -v22
    v_exp_f32 v40, v40
    v_exp_f32 v41, v41
    v_exp_f32 v42, v42
    v_exp_f32 v43, v43
    v_mul_f32 v21, v21, v45
    v_mul_f32 v16, v16, v45
    v_mul_f32 v17, v17, v45
    v_mul_f32 v18, v18, v45
    v_mul_f32 v19, v19, v45
    v_add_f32 v46, v40, v41
    v_add_f32 v47, v42, v43
    v_cvt_pk_bf16_f32 v40, v40, v40
    v_cvt_pk_bf16_f32 v41, v41, v41
    v_cvt_pk_bf16_f32 v42, v42, v42
    v_cvt_pk_bf16_f32 v43, v43, v43
    v_add_f32 v46, v46, v47
    v_add_f32 v21, v21, v46
    v_and_b32 v24, v40, v4
    v_and_b32 v25, v40, v5
    v_and_b32_dpp v26, v40, v6 row_shr:4 row_mask:0xf bank_mask:0xf bound_ctrl:1
    v_and_b32_dpp v27, v40, v7 row_shr:4 row_mask:0xf bank_mask:0xf bound_ctrl:1
    v_and_b32_dpp v28, v40, v4 row_shl:4 row_mask:0xf bank_mask:0xf bound_ctrl:1
    v_and_b32_dpp v29, v40, v5 row_shl:4 row_mask:0xf bank_mask:0xf bound_ctrl:1
    v_and_b32 v30, v40, v6
    v_and_b32 v31, v40, v7
    v_mfma_f32_16x16x32_bf16 v[16:19], v[128:131], v[24:27], v[16:19]
    buffer_load_dwordx4 v[128:131], v2, s[4:7], s32 offen offset:0 nt
    v_and_b32 v32, v41, v4
    v_and_b32 v33, v41, v5
    v_and_b32_dpp v34, v41, v6 row_shr:4 row_mask:0xf bank_mask:0xf bound_ctrl:1
    v_and_b32_dpp v35, v41, v7 row_shr:4 row_mask:0xf bank_mask:0xf bound_ctrl:1
    v_mfma_f32_16x16x32_bf16 v[16:19], v[132:135], v[28:31], v[16:19]
    buffer_load_dwordx4 v[132:135], v2, s[4:7], s32 offen offset:1024 nt
    v_and_b32_dpp v36, v41, v4 row_shl:4 row_mask:0xf bank_mask:0xf bound_ctrl:1
    v_and_b32_dpp v37, v41, v5 row_shl:4 row_mask:0xf bank_mask:0xf bound_ctrl:1
    v_and_b32 v38, v41, v6
    v_and_b32 v39, v41, v7
    v_mfma_f32_16x16x32_bf16 v[16:19], v[136:139], v[32:35], v[16:19]
    buffer_load_dwordx4 v[136:139], v2, s[4:7], s32 offen offset:2048 nt
    v_and_b32 v24, v42, v4
    v_and_b32 v25, v42, v5
    v_and_b32_dpp v26, v42, v6 row_shr:4 row_mask:0xf bank_mask:0xf bound_ctrl:1
    v_and_b32_dpp v27, v42, v7 row_shr:4 row_mask:0xf bank_mask:0xf bound_ctrl:1
    v_mfma_f32_16x16x32_bf16 v[16:19], v[140:143], v[36:39], v[16:19]
    buffer_load_dwordx4 v[140:143], v2, s[4:7], s32 offen offset:3072 nt
    v_and_b32_dpp v28, v42, v4 row_shl:4 row_mask:0xf bank_mask:0xf bound_ctrl:1
    v_and_b32_dpp v29, v42, v5 row_shl:4 row_mask:0xf bank_mask:0xf bound_ctrl:1
    v_and_b32 v30, v42, v6
    v_and_b32 v31, v42, v7
    v_mfma_f32_16x16x32_bf16 v[16:19], v[144:147], v[24:27], v[16:19]
    buffer_load_dwordx4 v[144:147], v2, s[4:7], s33 offen offset:0 nt
    v_and_b32 v32, v43, v4
    v_and_b32 v33, v43, v5
    v_and_b32_dpp v34, v43, v6 row_shr:4 row_mask:0xf bank_mask:0xf bound_ctrl:1
    v_and_b32_dpp v35, v43, v7 row_shr:4 row_mask:0xf bank_mask:0xf bound_ctrl:1
    v_mfma_f32_16x16x32_bf16 v[16:19], v[148:151], v[28:31], v[16:19]
    buffer_load_dwordx4 v[148:151], v2, s[4:7], s33 offen offset:1024 nt
    v_and_b32_dpp v36, v43, v4 row_shl:4 row_mask:0xf bank_mask:0xf bound_ctrl:1
    v_and_b32_dpp v37, v43, v5 row_shl:4 row_mask:0xf bank_mask:0xf bound_ctrl:1
    v_and_b32 v38, v43, v6
    v_and_b32 v39, v43, v7
    v_mfma_f32_16x16x32_bf16 v[16:19], v[152:155], v[32:35], v[16:19]
    buffer_load_dwordx4 v[152:155], v2, s[4:7], s33 offen offset:2048 nt
    v_mfma_f32_16x16x32_bf16 v[16:19], v[156:159], v[36:39], v[16:19]
    buffer_load_dwordx4 v[156:159], v2, s[4:7], s33 offen offset:3072 nt
    v_mfma_f32_16x16x32_bf16 v[24:27], a[96:99], v[8:11], 0
    v_mfma_f32_16x16x32_bf16 v[24:27], a[100:103], v[12:15], v[24:27]
    v_mfma_f32_16x16x32_bf16 v[28:31], a[104:107], v[8:11], 0
    v_mfma_f32_16x16x32_bf16 v[28:31], a[108:111], v[12:15], v[28:31]
    v_mfma_f32_16x16x32_bf16 v[32:35], a[112:115], v[8:11], 0
    v_mfma_f32_16x16x32_bf16 v[32:35], a[116:119], v[12:15], v[32:35]
    v_mfma_f32_16x16x32_bf16 v[36:39], a[120:123], v[8:11], 0
    v_mfma_f32_16x16x32_bf16 v[36:39], a[124:127], v[12:15], v[36:39]
    s_nop 1
    v_mov_b32_dpp v40, v24 quad_perm:[0,0,0,0] row_mask:0xf bank_mask:0xf
    s_nop 0
    v_mov_b32_dpp v41, v28 quad_perm:[0,0,0,0] row_mask:0xf bank_mask:0xf
    s_nop 0
    v_mov_b32_dpp v42, v32 quad_perm:[0,0,0,0] row_mask:0xf bank_mask:0xf
    v_add_f32_dpp v40, v25, v40 quad_perm:[1,1,1,1] row_mask:0xf bank_mask:0xf
    v_add_f32_dpp v41, v29, v41 quad_perm:[1,1,1,1] row_mask:0xf bank_mask:0xf
    v_add_f32_dpp v42, v33, v42 quad_perm:[1,1,1,1] row_mask:0xf bank_mask:0xf
    v_add_f32_dpp v40, v26, v40 quad_perm:[2,2,2,2] row_mask:0xf bank_mask:0xf
    v_add_f32_dpp v41, v30, v41 quad_perm:[2,2,2,2] row_mask:0xf bank_mask:0xf
    v_mov_b32_dpp v43, v36 quad_perm:[0,0,0,0] row_mask:0xf bank_mask:0xf
    v_add_f32_dpp v42, v34, v42 quad_perm:[2,2,2,2] row_mask:0xf bank_mask:0xf
    v_add_f32_dpp v40, v27, v40 quad_perm:[3,3,3,3] row_mask:0xf bank_mask:0xf
    v_add_f32_dpp v43, v37, v43 quad_perm:[1,1,1,1] row_mask:0xf bank_mask:0xf
    v_add_f32_dpp v41, v31, v41 quad_perm:[3,3,3,3] row_mask:0xf bank_mask:0xf
    v_add_f32_dpp v42, v35, v42 quad_perm:[3,3,3,3] row_mask:0xf bank_mask:0xf
    v_add_f32_dpp v43, v38, v43 quad_perm:[2,2,2,2] row_mask:0xf bank_mask:0xf
    v_max3_f32 v44, v40, v41, v20
    s_nop 0
    v_add_f32_dpp v43, v39, v43 quad_perm:[3,3,3,3] row_mask:0xf bank_mask:0xf
    v_max3_f32 v44, v44, v42, v43
    s_nop 1
    v_max_f32_dpp v44, v44, v44 row_half_mirror row_mask:0xf bank_mask:0xf
    v_mov_b32 v45, v44
    s_nop 1
    v_permlane16_swap_b32 v44, v45
    v_max_f32 v44, v44, v45
    v_mov_b32 v45, v44
    s_nop 1
    v_permlane32_swap_b32 v44, v45
    v_max_f32 v44, v44, v45
    v_sub_f32 v45, v20, v44
    v_mul_f32 v45, s30, v45
    v_exp_f32 v45, v45
    v_mov_b32 v20, v44
    v_mul_f32 v22, s30, v44
    v_fma_f32 v40, v40, s30, -v22
    v_fma_f32 v41, v41, s30, -v22
    v_fma_f32 v42, v42, s30, -v22
    v_fma_f32 v43, v43, s30, -v22
    v_exp_f32 v40, v40
    v_exp_f32 v41, v41
    v_exp_f32 v42, v42
    v_exp_f32 v43, v43
    v_mul_f32 v21, v21, v45
    v_mul_f32 v16, v16, v45
    v_mul_f32 v17, v17, v45
    v_mul_f32 v18, v18, v45
    v_mul_f32 v19, v19, v45
    v_add_f32 v46, v40, v41
    v_add_f32 v47, v42, v43
    v_cvt_pk_bf16_f32 v40, v40, v40
    v_cvt_pk_bf16_f32 v41, v41, v41
    v_cvt_pk_bf16_f32 v42, v42, v42
    v_cvt_pk_bf16_f32 v43, v43, v43
    v_add_f32 v46, v46, v47
    v_add_f32 v21, v21, v46
    v_and_b32 v24, v40, v4
    v_and_b32 v25, v40, v5
    v_and_b32_dpp v26, v40, v6 row_shr:4 row_mask:0xf bank_mask:0xf bound_ctrl:1
    v_and_b32_dpp v27, v40, v7 row_shr:4 row_mask:0xf bank_mask:0xf bound_ctrl:1
    v_and_b32_dpp v28, v40, v4 row_shl:4 row_mask:0xf bank_mask:0xf bound_ctrl:1
    v_and_b32_dpp v29, v40, v5 row_shl:4 row_mask:0xf bank_mask:0xf bound_ctrl:1
    v_and_b32 v30, v40, v6
    v_and_b32 v31, v40, v7
    v_mfma_f32_16x16x32_bf16 v[16:19], v[160:163], v[24:27], v[16:19]
    buffer_load_dwordx4 v[160:163], v2, s[4:7], s34 offen offset:0 nt
    v_and_b32 v32, v41, v4
    v_and_b32 v33, v41, v5
    v_and_b32_dpp v34, v41, v6 row_shr:4 row_mask:0xf bank_mask:0xf bound_ctrl:1
    v_and_b32_dpp v35, v41, v7 row_shr:4 row_mask:0xf bank_mask:0xf bound_ctrl:1
    v_mfma_f32_16x16x32_bf16 v[16:19], v[164:167], v[28:31], v[16:19]
    buffer_load_dwordx4 v[164:167], v2, s[4:7], s34 offen offset:1024 nt
    v_and_b32_dpp v36, v41, v4 row_shl:4 row_mask:0xf bank_mask:0xf bound_ctrl:1
    v_and_b32_dpp v37, v41, v5 row_shl:4 row_mask:0xf bank_mask:0xf bound_ctrl:1
    v_and_b32 v38, v41, v6
    v_and_b32 v39, v41, v7
    v_mfma_f32_16x16x32_bf16 v[16:19], v[168:171], v[32:35], v[16:19]
    buffer_load_dwordx4 v[168:171], v2, s[4:7], s34 offen offset:2048 nt
    v_and_b32 v24, v42, v4
    v_and_b32 v25, v42, v5
    v_and_b32_dpp v26, v42, v6 row_shr:4 row_mask:0xf bank_mask:0xf bound_ctrl:1
    v_and_b32_dpp v27, v42, v7 row_shr:4 row_mask:0xf bank_mask:0xf bound_ctrl:1
    v_mfma_f32_16x16x32_bf16 v[16:19], v[172:175], v[36:39], v[16:19]
    buffer_load_dwordx4 v[172:175], v2, s[4:7], s34 offen offset:3072 nt
    v_and_b32_dpp v28, v42, v4 row_shl:4 row_mask:0xf bank_mask:0xf bound_ctrl:1
    v_and_b32_dpp v29, v42, v5 row_shl:4 row_mask:0xf bank_mask:0xf bound_ctrl:1
    v_and_b32 v30, v42, v6
    v_and_b32 v31, v42, v7
    v_mfma_f32_16x16x32_bf16 v[16:19], v[176:179], v[24:27], v[16:19]
    buffer_load_dwordx4 v[176:179], v2, s[4:7], s35 offen offset:0 nt
    v_and_b32 v32, v43, v4
    v_and_b32 v33, v43, v5
    v_and_b32_dpp v34, v43, v6 row_shr:4 row_mask:0xf bank_mask:0xf bound_ctrl:1
    v_and_b32_dpp v35, v43, v7 row_shr:4 row_mask:0xf bank_mask:0xf bound_ctrl:1
    v_mfma_f32_16x16x32_bf16 v[16:19], v[180:183], v[28:31], v[16:19]
    buffer_load_dwordx4 v[180:183], v2, s[4:7], s35 offen offset:1024 nt
    v_and_b32_dpp v36, v43, v4 row_shl:4 row_mask:0xf bank_mask:0xf bound_ctrl:1
    v_and_b32_dpp v37, v43, v5 row_shl:4 row_mask:0xf bank_mask:0xf bound_ctrl:1
    v_and_b32 v38, v43, v6
    v_and_b32 v39, v43, v7
    v_mfma_f32_16x16x32_bf16 v[16:19], v[184:187], v[32:35], v[16:19]
    buffer_load_dwordx4 v[184:187], v2, s[4:7], s35 offen offset:2048 nt
    v_mfma_f32_16x16x32_bf16 v[16:19], v[188:191], v[36:39], v[16:19]
    buffer_load_dwordx4 v[188:191], v2, s[4:7], s35 offen offset:3072 nt
    s_add_u32 s32, s57, 4194304
    s_xor_b32 s32, s32, 8192
    s_add_u32 s34, s57, 4718592
    s_xor_b32 s34, s34, 8192
    s_xor_b32 s35, s34, 4096
    s_xor_b32 s33, s32, 4096
    s_waitcnt vmcnt(47)
    s_waitcnt vmcnt(46)
    v_mfma_f32_16x16x32_bf16 v[24:27], a[192:195], v[8:11], 0
    v_mfma_f32_16x16x32_bf16 v[24:27], a[196:199], v[12:15], v[24:27]
    s_waitcnt vmcnt(44)
    v_mfma_f32_16x16x32_bf16 v[28:31], a[200:203], v[8:11], 0
    v_mfma_f32_16x16x32_bf16 v[28:31], a[204:207], v[12:15], v[28:31]
    s_waitcnt vmcnt(42)
    v_mfma_f32_16x16x32_bf16 v[32:35], a[208:211], v[8:11], 0
    v_mfma_f32_16x16x32_bf16 v[32:35], a[212:215], v[12:15], v[32:35]
    s_waitcnt vmcnt(40)
    v_mfma_f32_16x16x32_bf16 v[36:39], a[216:219], v[8:11], 0
    v_mfma_f32_16x16x32_bf16 v[36:39], a[220:223], v[12:15], v[36:39]
    v_mov_b32_dpp v40, v24 quad_perm:[0,0,0,0] row_mask:0xf bank_mask:0xf
    s_nop 0
    v_mov_b32_dpp v41, v28 quad_perm:[0,0,0,0] row_mask:0xf bank_mask:0xf
    s_nop 1
    v_mov_b32_dpp v42, v32 quad_perm:[0,0,0,0] row_mask:0xf bank_mask:0xf
    v_add_f32_dpp v40, v25, v40 quad_perm:[1,1,1,1] row_mask:0xf bank_mask:0xf
    v_add_f32_dpp v41, v29, v41 quad_perm:[1,1,1,1] row_mask:0xf bank_mask:0xf
    v_add_f32_dpp v42, v33, v42 quad_perm:[1,1,1,1] row_mask:0xf bank_mask:0xf
    v_add_f32_dpp v40, v26, v40 quad_perm:[2,2,2,2] row_mask:0xf bank_mask:0xf
    v_add_f32_dpp v41, v30, v41 quad_perm:[2,2,2,2] row_mask:0xf bank_mask:0xf
    v_mov_b32_dpp v43, v36 quad_perm:[0,0,0,0] row_mask:0xf bank_mask:0xf
    v_add_f32_dpp v42, v34, v42 quad_perm:[2,2,2,2] row_mask:0xf bank_mask:0xf
    v_add_f32_dpp v40, v27, v40 quad_perm:[3,3,3,3] row_mask:0xf bank_mask:0xf
    v_add_f32_dpp v43, v37, v43 quad_perm:[1,1,1,1] row_mask:0xf bank_mask:0xf
    v_add_f32_dpp v41, v31, v41 quad_perm:[3,3,3,3] row_mask:0xf bank_mask:0xf
    v_add_f32_dpp v42, v35, v42 quad_perm:[3,3,3,3] row_mask:0xf bank_mask:0xf
    v_add_f32_dpp v43, v38, v43 quad_perm:[2,2,2,2] row_mask:0xf bank_mask:0xf
    v_max3_f32 v44, v40, v41, v20
    s_nop 0
    v_add_f32_dpp v43, v39, v43 quad_perm:[3,3,3,3] row_mask:0xf bank_mask:0xf
    v_max3_f32 v44, v44, v42, v43
    s_nop 1
    v_max_f32_dpp v44, v44, v44 row_half_mirror row_mask:0xf bank_mask:0xf
    v_mov_b32 v45, v44
    s_nop 1
    v_permlane16_swap_b32 v44, v45
    v_max_f32 v44, v44, v45
    v_mov_b32 v45, v44
    s_nop 1
    v_permlane32_swap_b32 v44, v45
    v_max_f32 v44, v44, v45
    v_sub_f32 v45, v20, v44
    v_mul_f32 v45, s30, v45
    v_exp_f32 v45, v45
    v_mov_b32 v20, v44
    v_mul_f32 v22, s30, v44
    v_fma_f32 v40, v40, s30, -v22
    v_fma_f32 v41, v41, s30, -v22
    v_fma_f32 v42, v42, s30, -v22
    v_fma_f32 v43, v43, s30, -v22
    v_exp_f32 v40, v40
    v_exp_f32 v41, v41
    v_exp_f32 v42, v42
    v_exp_f32 v43, v43
    v_mul_f32 v21, v21, v45
    v_mul_f32 v16, v16, v45
    v_mul_f32 v17, v17, v45
    v_mul_f32 v18, v18, v45
    v_mul_f32 v19, v19, v45
    v_add_f32 v46, v40, v41
    v_add_f32 v47, v42, v43
    v_cvt_pk_bf16_f32 v40, v40, v40
    v_cvt_pk_bf16_f32 v41, v41, v41
    v_cvt_pk_bf16_f32 v42, v42, v42
    v_cvt_pk_bf16_f32 v43, v43, v43
    v_add_f32 v46, v46, v47
    v_add_f32 v21, v21, v46
    v_and_b32 v24, v40, v4
    v_and_b32 v25, v40, v5
    v_and_b32_dpp v26, v40, v6 row_shr:4 row_mask:0xf bank_mask:0xf bound_ctrl:1
    v_and_b32_dpp v27, v40, v7 row_shr:4 row_mask:0xf bank_mask:0xf bound_ctrl:1
    v_and_b32_dpp v28, v40, v4 row_shl:4 row_mask:0xf bank_mask:0xf bound_ctrl:1
    v_and_b32_dpp v29, v40, v5 row_shl:4 row_mask:0xf bank_mask:0xf bound_ctrl:1
    v_and_b32 v30, v40, v6
    v_and_b32 v31, v40, v7
    s_waitcnt vmcnt(31)
    v_mfma_f32_16x16x32_bf16 v[16:19], v[64:67], v[24:27], v[16:19]
    buffer_load_dwordx4 v[64:67], v3, s[8:11], s32 offen offset:0
    v_and_b32 v32, v41, v4
    v_and_b32 v33, v41, v5
    v_and_b32_dpp v34, v41, v6 row_shr:4 row_mask:0xf bank_mask:0xf bound_ctrl:1
    v_and_b32_dpp v35, v41, v7 row_shr:4 row_mask:0xf bank_mask:0xf bound_ctrl:1
    s_waitcnt vmcnt(31)
    v_mfma_f32_16x16x32_bf16 v[16:19], v[68:71], v[28:31], v[16:19]
    buffer_load_dwordx4 v[68:71], v3, s[8:11], s32 offen offset:1024
    v_and_b32_dpp v36, v41, v4 row_shl:4 row_mask:0xf bank_mask:0xf bound_ctrl:1
    v_and_b32_dpp v37, v41, v5 row_shl:4 row_mask:0xf bank_mask:0xf bound_ctrl:1
    v_and_b32 v38, v41, v6
    v_and_b32 v39, v41, v7
    s_waitcnt vmcnt(31)
    v_mfma_f32_16x16x32_bf16 v[16:19], v[72:75], v[32:35], v[16:19]
    buffer_load_dwordx4 v[72:75], v3, s[8:11], s32 offen offset:2048
    v_and_b32 v24, v42, v4
    v_and_b32 v25, v42, v5
    v_and_b32_dpp v26, v42, v6 row_shr:4 row_mask:0xf bank_mask:0xf bound_ctrl:1
    v_and_b32_dpp v27, v42, v7 row_shr:4 row_mask:0xf bank_mask:0xf bound_ctrl:1
    s_waitcnt vmcnt(31)
    v_mfma_f32_16x16x32_bf16 v[16:19], v[76:79], v[36:39], v[16:19]
    buffer_load_dwordx4 v[76:79], v3, s[8:11], s32 offen offset:3072
    v_and_b32_dpp v28, v42, v4 row_shl:4 row_mask:0xf bank_mask:0xf bound_ctrl:1
    v_and_b32_dpp v29, v42, v5 row_shl:4 row_mask:0xf bank_mask:0xf bound_ctrl:1
    v_and_b32 v30, v42, v6
    v_and_b32 v31, v42, v7
    s_waitcnt vmcnt(31)
    v_mfma_f32_16x16x32_bf16 v[16:19], v[80:83], v[24:27], v[16:19]
    buffer_load_dwordx4 v[80:83], v3, s[8:11], s33 offen offset:0
    v_and_b32 v32, v43, v4
    v_and_b32 v33, v43, v5
    v_and_b32_dpp v34, v43, v6 row_shr:4 row_mask:0xf bank_mask:0xf bound_ctrl:1
    v_and_b32_dpp v35, v43, v7 row_shr:4 row_mask:0xf bank_mask:0xf bound_ctrl:1
    s_waitcnt vmcnt(31)
    v_mfma_f32_16x16x32_bf16 v[16:19], v[84:87], v[28:31], v[16:19]
    buffer_load_dwordx4 v[84:87], v3, s[8:11], s33 offen offset:1024
    v_and_b32_dpp v36, v43, v4 row_shl:4 row_mask:0xf bank_mask:0xf bound_ctrl:1
    v_and_b32_dpp v37, v43, v5 row_shl:4 row_mask:0xf bank_mask:0xf bound_ctrl:1
    v_and_b32 v38, v43, v6
    v_and_b32 v39, v43, v7
    s_waitcnt vmcnt(31)
    v_mfma_f32_16x16x32_bf16 v[16:19], v[88:91], v[32:35], v[16:19]
    buffer_load_dwordx4 v[88:91], v3, s[8:11], s33 offen offset:2048
    s_waitcnt vmcnt(31)
    v_mfma_f32_16x16x32_bf16 v[16:19], v[92:95], v[36:39], v[16:19]
    buffer_load_dwordx4 v[92:95], v3, s[8:11], s33 offen offset:3072
    v_mfma_f32_16x16x32_bf16 v[24:27], a[224:227], v[8:11], 0
    v_mfma_f32_16x16x32_bf16 v[24:27], a[228:231], v[12:15], v[24:27]
    v_mfma_f32_16x16x32_bf16 v[28:31], a[232:235], v[8:11], 0
    v_mfma_f32_16x16x32_bf16 v[28:31], a[236:239], v[12:15], v[28:31]
    v_mfma_f32_16x16x32_bf16 v[32:35], a[240:243], v[8:11], 0
    v_mfma_f32_16x16x32_bf16 v[32:35], a[244:247], v[12:15], v[32:35]
    v_mfma_f32_16x16x32_bf16 v[36:39], a[248:251], v[8:11], 0
    v_mfma_f32_16x16x32_bf16 v[36:39], a[252:255], v[12:15], v[36:39]
    s_nop 1
    v_mov_b32_dpp v40, v24 quad_perm:[0,0,0,0] row_mask:0xf bank_mask:0xf
    s_nop 0
    v_mov_b32_dpp v41, v28 quad_perm:[0,0,0,0] row_mask:0xf bank_mask:0xf
    s_nop 0
    v_mov_b32_dpp v42, v32 quad_perm:[0,0,0,0] row_mask:0xf bank_mask:0xf
    v_add_f32_dpp v40, v25, v40 quad_perm:[1,1,1,1] row_mask:0xf bank_mask:0xf
    v_add_f32_dpp v41, v29, v41 quad_perm:[1,1,1,1] row_mask:0xf bank_mask:0xf
    v_add_f32_dpp v42, v33, v42 quad_perm:[1,1,1,1] row_mask:0xf bank_mask:0xf
    v_add_f32_dpp v40, v26, v40 quad_perm:[2,2,2,2] row_mask:0xf bank_mask:0xf
    v_add_f32_dpp v41, v30, v41 quad_perm:[2,2,2,2] row_mask:0xf bank_mask:0xf
    v_mov_b32_dpp v43, v36 quad_perm:[0,0,0,0] row_mask:0xf bank_mask:0xf
    v_add_f32_dpp v42, v34, v42 quad_perm:[2,2,2,2] row_mask:0xf bank_mask:0xf
    v_add_f32_dpp v40, v27, v40 quad_perm:[3,3,3,3] row_mask:0xf bank_mask:0xf
    v_add_f32_dpp v43, v37, v43 quad_perm:[1,1,1,1] row_mask:0xf bank_mask:0xf
    v_add_f32_dpp v41, v31, v41 quad_perm:[3,3,3,3] row_mask:0xf bank_mask:0xf
    v_add_f32_dpp v42, v35, v42 quad_perm:[3,3,3,3] row_mask:0xf bank_mask:0xf
    v_add_f32_dpp v43, v38, v43 quad_perm:[2,2,2,2] row_mask:0xf bank_mask:0xf
    v_max3_f32 v44, v40, v41, v20
    s_nop 0
    v_add_f32_dpp v43, v39, v43 quad_perm:[3,3,3,3] row_mask:0xf bank_mask:0xf
    v_max3_f32 v44, v44, v42, v43
    s_nop 1
    v_max_f32_dpp v44, v44, v44 row_half_mirror row_mask:0xf bank_mask:0xf
    v_mov_b32 v45, v44
    s_nop 1
    v_permlane16_swap_b32 v44, v45
    v_max_f32 v44, v44, v45
    v_mov_b32 v45, v44
    s_nop 1
    v_permlane32_swap_b32 v44, v45
    v_max_f32 v44, v44, v45
    v_sub_f32 v45, v20, v44
    v_mul_f32 v45, s30, v45
    v_exp_f32 v45, v45
    v_mov_b32 v20, v44
    v_mul_f32 v22, s30, v44
    v_fma_f32 v40, v40, s30, -v22
    v_fma_f32 v41, v41, s30, -v22
    v_fma_f32 v42, v42, s30, -v22
    v_fma_f32 v43, v43, s30, -v22
    v_exp_f32 v40, v40
    v_exp_f32 v41, v41
    v_exp_f32 v42, v42
    v_exp_f32 v43, v43
    v_mul_f32 v21, v21, v45
    v_mul_f32 v16, v16, v45
    v_mul_f32 v17, v17, v45
    v_mul_f32 v18, v18, v45
    v_mul_f32 v19, v19, v45
    v_add_f32 v46, v40, v41
    v_add_f32 v47, v42, v43
    v_cvt_pk_bf16_f32 v40, v40, v40
    v_cvt_pk_bf16_f32 v41, v41, v41
    v_cvt_pk_bf16_f32 v42, v42, v42
    v_cvt_pk_bf16_f32 v43, v43, v43
    v_add_f32 v46, v46, v47
    v_add_f32 v21, v21, v46
    v_and_b32 v24, v40, v4
    v_and_b32 v25, v40, v5
    v_and_b32_dpp v26, v40, v6 row_shr:4 row_mask:0xf bank_mask:0xf bound_ctrl:1
    v_and_b32_dpp v27, v40, v7 row_shr:4 row_mask:0xf bank_mask:0xf bound_ctrl:1
    v_and_b32_dpp v28, v40, v4 row_shl:4 row_mask:0xf bank_mask:0xf bound_ctrl:1
    v_and_b32_dpp v29, v40, v5 row_shl:4 row_mask:0xf bank_mask:0xf bound_ctrl:1
    v_and_b32 v30, v40, v6
    v_and_b32 v31, v40, v7
    s_waitcnt vmcnt(31)
    v_mfma_f32_16x16x32_bf16 v[16:19], v[96:99], v[24:27], v[16:19]
    buffer_load_dwordx4 v[96:99], v3, s[8:11], s34 offen offset:0
    v_and_b32 v32, v41, v4
    v_and_b32 v33, v41, v5
    v_and_b32_dpp v34, v41, v6 row_shr:4 row_mask:0xf bank_mask:0xf bound_ctrl:1
    v_and_b32_dpp v35, v41, v7 row_shr:4 row_mask:0xf bank_mask:0xf bound_ctrl:1
    s_waitcnt vmcnt(31)
    v_mfma_f32_16x16x32_bf16 v[16:19], v[100:103], v[28:31], v[16:19]
    buffer_load_dwordx4 v[100:103], v3, s[8:11], s34 offen offset:1024
    v_and_b32_dpp v36, v41, v4 row_shl:4 row_mask:0xf bank_mask:0xf bound_ctrl:1
    v_and_b32_dpp v37, v41, v5 row_shl:4 row_mask:0xf bank_mask:0xf bound_ctrl:1
    v_and_b32 v38, v41, v6
    v_and_b32 v39, v41, v7
    s_waitcnt vmcnt(31)
    v_mfma_f32_16x16x32_bf16 v[16:19], v[104:107], v[32:35], v[16:19]
    buffer_load_dwordx4 v[104:107], v3, s[8:11], s34 offen offset:2048
    v_and_b32 v24, v42, v4
    v_and_b32 v25, v42, v5
    v_and_b32_dpp v26, v42, v6 row_shr:4 row_mask:0xf bank_mask:0xf bound_ctrl:1
    v_and_b32_dpp v27, v42, v7 row_shr:4 row_mask:0xf bank_mask:0xf bound_ctrl:1
    s_waitcnt vmcnt(31)
    v_mfma_f32_16x16x32_bf16 v[16:19], v[108:111], v[36:39], v[16:19]
    buffer_load_dwordx4 v[108:111], v3, s[8:11], s34 offen offset:3072
    v_and_b32_dpp v28, v42, v4 row_shl:4 row_mask:0xf bank_mask:0xf bound_ctrl:1
    v_and_b32_dpp v29, v42, v5 row_shl:4 row_mask:0xf bank_mask:0xf bound_ctrl:1
    v_and_b32 v30, v42, v6
    v_and_b32 v31, v42, v7
    s_waitcnt vmcnt(31)
    v_mfma_f32_16x16x32_bf16 v[16:19], v[112:115], v[24:27], v[16:19]
    buffer_load_dwordx4 v[112:115], v3, s[8:11], s35 offen offset:0
    v_and_b32 v32, v43, v4
    v_and_b32 v33, v43, v5
    v_and_b32_dpp v34, v43, v6 row_shr:4 row_mask:0xf bank_mask:0xf bound_ctrl:1
    v_and_b32_dpp v35, v43, v7 row_shr:4 row_mask:0xf bank_mask:0xf bound_ctrl:1
    s_waitcnt vmcnt(31)
    v_mfma_f32_16x16x32_bf16 v[16:19], v[116:119], v[28:31], v[16:19]
    buffer_load_dwordx4 v[116:119], v3, s[8:11], s35 offen offset:1024
    v_and_b32_dpp v36, v43, v4 row_shl:4 row_mask:0xf bank_mask:0xf bound_ctrl:1
    v_and_b32_dpp v37, v43, v5 row_shl:4 row_mask:0xf bank_mask:0xf bound_ctrl:1
    v_and_b32 v38, v43, v6
    v_and_b32 v39, v43, v7
    s_waitcnt vmcnt(31)
    v_mfma_f32_16x16x32_bf16 v[16:19], v[120:123], v[32:35], v[16:19]
    buffer_load_dwordx4 v[120:123], v3, s[8:11], s35 offen offset:2048
    s_waitcnt vmcnt(31)
    v_mfma_f32_16x16x32_bf16 v[16:19], v[124:127], v[36:39], v[16:19]
    buffer_load_dwordx4 v[124:127], v3, s[8:11], s35 offen offset:3072
    s_add_u32 s32, s57, 5242880
    s_xor_b32 s32, s32, 8192
    s_add_u32 s34, s57, 5767168
    s_xor_b32 s34, s34, 8192
    s_xor_b32 s35, s34, 4096
    s_xor_b32 s33, s32, 4096
    s_waitcnt vmcnt(47)
    v_mfma_f32_16x16x32_bf16 v[24:27], a[128:131], v[8:11], 0
    v_mfma_f32_16x16x32_bf16 v[24:27], a[132:135], v[12:15], v[24:27]
    v_mfma_f32_16x16x32_bf16 v[28:31], a[136:139], v[8:11], 0
    v_mfma_f32_16x16x32_bf16 v[28:31], a[140:143], v[12:15], v[28:31]
    v_mfma_f32_16x16x32_bf16 v[32:35], a[144:147], v[8:11], 0
    v_mfma_f32_16x16x32_bf16 v[32:35], a[148:151], v[12:15], v[32:35]
    v_mfma_f32_16x16x32_bf16 v[36:39], a[152:155], v[8:11], 0
    v_mfma_f32_16x16x32_bf16 v[36:39], a[156:159], v[12:15], v[36:39]
    s_nop 1
    v_mov_b32_dpp v40, v24 quad_perm:[0,0,0,0] row_mask:0xf bank_mask:0xf
    s_nop 0
    v_mov_b32_dpp v41, v28 quad_perm:[0,0,0,0] row_mask:0xf bank_mask:0xf
    s_nop 0
    v_mov_b32_dpp v42, v32 quad_perm:[0,0,0,0] row_mask:0xf bank_mask:0xf
    v_add_f32_dpp v40, v25, v40 quad_perm:[1,1,1,1] row_mask:0xf bank_mask:0xf
    v_add_f32_dpp v41, v29, v41 quad_perm:[1,1,1,1] row_mask:0xf bank_mask:0xf
    v_add_f32_dpp v42, v33, v42 quad_perm:[1,1,1,1] row_mask:0xf bank_mask:0xf
    v_add_f32_dpp v40, v26, v40 quad_perm:[2,2,2,2] row_mask:0xf bank_mask:0xf
    v_add_f32_dpp v41, v30, v41 quad_perm:[2,2,2,2] row_mask:0xf bank_mask:0xf
    v_mov_b32_dpp v43, v36 quad_perm:[0,0,0,0] row_mask:0xf bank_mask:0xf
    v_add_f32_dpp v42, v34, v42 quad_perm:[2,2,2,2] row_mask:0xf bank_mask:0xf
    v_add_f32_dpp v40, v27, v40 quad_perm:[3,3,3,3] row_mask:0xf bank_mask:0xf
    v_add_f32_dpp v43, v37, v43 quad_perm:[1,1,1,1] row_mask:0xf bank_mask:0xf
    v_add_f32_dpp v41, v31, v41 quad_perm:[3,3,3,3] row_mask:0xf bank_mask:0xf
    v_add_f32_dpp v42, v35, v42 quad_perm:[3,3,3,3] row_mask:0xf bank_mask:0xf
    v_add_f32_dpp v43, v38, v43 quad_perm:[2,2,2,2] row_mask:0xf bank_mask:0xf
    v_max3_f32 v44, v40, v41, v20
    s_nop 0
    v_add_f32_dpp v43, v39, v43 quad_perm:[3,3,3,3] row_mask:0xf bank_mask:0xf
    v_max3_f32 v44, v44, v42, v43
    s_nop 1
    v_max_f32_dpp v44, v44, v44 row_half_mirror row_mask:0xf bank_mask:0xf
    v_mov_b32 v45, v44
    s_nop 1
    v_permlane16_swap_b32 v44, v45
    v_max_f32 v44, v44, v45
    v_mov_b32 v45, v44
    s_nop 1
    v_permlane32_swap_b32 v44, v45
    v_max_f32 v44, v44, v45
    v_sub_f32 v45, v20, v44
    v_mul_f32 v45, s30, v45
    v_exp_f32 v45, v45
    v_mov_b32 v20, v44
    v_mul_f32 v22, s30, v44
    v_fma_f32 v40, v40, s30, -v22
    v_fma_f32 v41, v41, s30, -v22
    v_fma_f32 v42, v42, s30, -v22
    v_fma_f32 v43, v43, s30, -v22
    v_exp_f32 v40, v40
    v_exp_f32 v41, v41
    v_exp_f32 v42, v42
    v_exp_f32 v43, v43
    v_mul_f32 v21, v21, v45
    v_mul_f32 v16, v16, v45
    v_mul_f32 v17, v17, v45
    v_mul_f32 v18, v18, v45
    v_mul_f32 v19, v19, v45
    v_add_f32 v46, v40, v41
    v_add_f32 v47, v42, v43
    v_cvt_pk_bf16_f32 v40, v40, v40
    v_cvt_pk_bf16_f32 v41, v41, v41
    v_cvt_pk_bf16_f32 v42, v42, v42
    v_cvt_pk_bf16_f32 v43, v43, v43
    v_add_f32 v46, v46, v47
    v_add_f32 v21, v21, v46
    v_and_b32 v24, v40, v4
    v_and_b32 v25, v40, v5
    v_and_b32_dpp v26, v40, v6 row_shr:4 row_mask:0xf bank_mask:0xf bound_ctrl:1
    v_and_b32_dpp v27, v40, v7 row_shr:4 row_mask:0xf bank_mask:0xf bound_ctrl:1
    v_and_b32_dpp v28, v40, v4 row_shl:4 row_mask:0xf bank_mask:0xf bound_ctrl:1
    v_and_b32_dpp v29, v40, v5 row_shl:4 row_mask:0xf bank_mask:0xf bound_ctrl:1
    v_and_b32 v30, v40, v6
    v_and_b32 v31, v40, v7
    v_mfma_f32_16x16x32_bf16 v[16:19], v[192:195], v[24:27], v[16:19]
    buffer_load_dwordx4 v[192:195], v2, s[4:7], s32 offen offset:0 nt
    v_and_b32 v32, v41, v4
    v_and_b32 v33, v41, v5
    v_and_b32_dpp v34, v41, v6 row_shr:4 row_mask:0xf bank_mask:0xf bound_ctrl:1
    v_and_b32_dpp v35, v41, v7 row_shr:4 row_mask:0xf bank_mask:0xf bound_ctrl:1
    v_mfma_f32_16x16x32_bf16 v[16:19], v[196:199], v[28:31], v[16:19]
    buffer_load_dwordx4 v[196:199], v2, s[4:7], s32 offen offset:1024 nt
    v_and_b32_dpp v36, v41, v4 row_shl:4 row_mask:0xf bank_mask:0xf bound_ctrl:1
    v_and_b32_dpp v37, v41, v5 row_shl:4 row_mask:0xf bank_mask:0xf bound_ctrl:1
    v_and_b32 v38, v41, v6
    v_and_b32 v39, v41, v7
    v_mfma_f32_16x16x32_bf16 v[16:19], v[200:203], v[32:35], v[16:19]
    buffer_load_dwordx4 v[200:203], v2, s[4:7], s32 offen offset:2048 nt
    v_and_b32 v24, v42, v4
    v_and_b32 v25, v42, v5
    v_and_b32_dpp v26, v42, v6 row_shr:4 row_mask:0xf bank_mask:0xf bound_ctrl:1
    v_and_b32_dpp v27, v42, v7 row_shr:4 row_mask:0xf bank_mask:0xf bound_ctrl:1
    v_mfma_f32_16x16x32_bf16 v[16:19], v[204:207], v[36:39], v[16:19]
    buffer_load_dwordx4 v[204:207], v2, s[4:7], s32 offen offset:3072 nt
    v_and_b32_dpp v28, v42, v4 row_shl:4 row_mask:0xf bank_mask:0xf bound_ctrl:1
    v_and_b32_dpp v29, v42, v5 row_shl:4 row_mask:0xf bank_mask:0xf bound_ctrl:1
    v_and_b32 v30, v42, v6
    v_and_b32 v31, v42, v7
    v_mfma_f32_16x16x32_bf16 v[16:19], v[208:211], v[24:27], v[16:19]
    buffer_load_dwordx4 v[208:211], v2, s[4:7], s33 offen offset:0 nt
    v_and_b32 v32, v43, v4
    v_and_b32 v33, v43, v5
    v_and_b32_dpp v34, v43, v6 row_shr:4 row_mask:0xf bank_mask:0xf bound_ctrl:1
    v_and_b32_dpp v35, v43, v7 row_shr:4 row_mask:0xf bank_mask:0xf bound_ctrl:1
    v_mfma_f32_16x16x32_bf16 v[16:19], v[212:215], v[28:31], v[16:19]
    buffer_load_dwordx4 v[212:215], v2, s[4:7], s33 offen offset:1024 nt
    v_and_b32_dpp v36, v43, v4 row_shl:4 row_mask:0xf bank_mask:0xf bound_ctrl:1
    v_and_b32_dpp v37, v43, v5 row_shl:4 row_mask:0xf bank_mask:0xf bound_ctrl:1
    v_and_b32 v38, v43, v6
    v_and_b32 v39, v43, v7
    v_mfma_f32_16x16x32_bf16 v[16:19], v[216:219], v[32:35], v[16:19]
    buffer_load_dwordx4 v[216:219], v2, s[4:7], s33 offen offset:2048 nt
    v_mfma_f32_16x16x32_bf16 v[16:19], v[220:223], v[36:39], v[16:19]
    buffer_load_dwordx4 v[220:223], v2, s[4:7], s33 offen offset:3072 nt
    v_mfma_f32_16x16x32_bf16 v[24:27], a[160:163], v[8:11], 0
    v_mfma_f32_16x16x32_bf16 v[24:27], a[164:167], v[12:15], v[24:27]
    v_mfma_f32_16x16x32_bf16 v[28:31], a[168:171], v[8:11], 0
    v_mfma_f32_16x16x32_bf16 v[28:31], a[172:175], v[12:15], v[28:31]
    v_mfma_f32_16x16x32_bf16 v[32:35], a[176:179], v[8:11], 0
    v_mfma_f32_16x16x32_bf16 v[32:35], a[180:183], v[12:15], v[32:35]
    v_mfma_f32_16x16x32_bf16 v[36:39], a[184:187], v[8:11], 0
    v_mfma_f32_16x16x32_bf16 v[36:39], a[188:191], v[12:15], v[36:39]
    s_nop 1
    v_mov_b32_dpp v40, v24 quad_perm:[0,0,0,0] row_mask:0xf bank_mask:0xf
    s_nop 0
    v_mov_b32_dpp v41, v28 quad_perm:[0,0,0,0] row_mask:0xf bank_mask:0xf
    s_nop 0
    v_mov_b32_dpp v42, v32 quad_perm:[0,0,0,0] row_mask:0xf bank_mask:0xf
    v_add_f32_dpp v40, v25, v40 quad_perm:[1,1,1,1] row_mask:0xf bank_mask:0xf
    v_add_f32_dpp v41, v29, v41 quad_perm:[1,1,1,1] row_mask:0xf bank_mask:0xf
    v_add_f32_dpp v42, v33, v42 quad_perm:[1,1,1,1] row_mask:0xf bank_mask:0xf
    v_add_f32_dpp v40, v26, v40 quad_perm:[2,2,2,2] row_mask:0xf bank_mask:0xf
    v_add_f32_dpp v41, v30, v41 quad_perm:[2,2,2,2] row_mask:0xf bank_mask:0xf
    v_mov_b32_dpp v43, v36 quad_perm:[0,0,0,0] row_mask:0xf bank_mask:0xf
    v_add_f32_dpp v42, v34, v42 quad_perm:[2,2,2,2] row_mask:0xf bank_mask:0xf
    v_add_f32_dpp v40, v27, v40 quad_perm:[3,3,3,3] row_mask:0xf bank_mask:0xf
    v_add_f32_dpp v43, v37, v43 quad_perm:[1,1,1,1] row_mask:0xf bank_mask:0xf
    v_add_f32_dpp v41, v31, v41 quad_perm:[3,3,3,3] row_mask:0xf bank_mask:0xf
    v_add_f32_dpp v42, v35, v42 quad_perm:[3,3,3,3] row_mask:0xf bank_mask:0xf
    v_add_f32_dpp v43, v38, v43 quad_perm:[2,2,2,2] row_mask:0xf bank_mask:0xf
    v_max3_f32 v44, v40, v41, v20
    s_nop 0
    v_add_f32_dpp v43, v39, v43 quad_perm:[3,3,3,3] row_mask:0xf bank_mask:0xf
    v_max3_f32 v44, v44, v42, v43
    s_nop 1
    v_max_f32_dpp v44, v44, v44 row_half_mirror row_mask:0xf bank_mask:0xf
    v_mov_b32 v45, v44
    s_nop 1
    v_permlane16_swap_b32 v44, v45
    v_max_f32 v44, v44, v45
    v_mov_b32 v45, v44
    s_nop 1
    v_permlane32_swap_b32 v44, v45
    v_max_f32 v44, v44, v45
    v_sub_f32 v45, v20, v44
    v_mul_f32 v45, s30, v45
    v_exp_f32 v45, v45
    v_mov_b32 v20, v44
    v_mul_f32 v22, s30, v44
    v_fma_f32 v40, v40, s30, -v22
    v_fma_f32 v41, v41, s30, -v22
    v_fma_f32 v42, v42, s30, -v22
    v_fma_f32 v43, v43, s30, -v22
    v_exp_f32 v40, v40
    v_exp_f32 v41, v41
    v_exp_f32 v42, v42
    v_exp_f32 v43, v43
    v_mul_f32 v21, v21, v45
    v_mul_f32 v16, v16, v45
    v_mul_f32 v17, v17, v45
    v_mul_f32 v18, v18, v45
    v_mul_f32 v19, v19, v45
    v_add_f32 v46, v40, v41
    v_add_f32 v47, v42, v43
    v_cvt_pk_bf16_f32 v40, v40, v40
    v_cvt_pk_bf16_f32 v41, v41, v41
    v_cvt_pk_bf16_f32 v42, v42, v42
    v_cvt_pk_bf16_f32 v43, v43, v43
    v_add_f32 v46, v46, v47
    v_add_f32 v21, v21, v46
    v_and_b32 v24, v40, v4
    v_and_b32 v25, v40, v5
    v_and_b32_dpp v26, v40, v6 row_shr:4 row_mask:0xf bank_mask:0xf bound_ctrl:1
    v_and_b32_dpp v27, v40, v7 row_shr:4 row_mask:0xf bank_mask:0xf bound_ctrl:1
    v_and_b32_dpp v28, v40, v4 row_shl:4 row_mask:0xf bank_mask:0xf bound_ctrl:1
    v_and_b32_dpp v29, v40, v5 row_shl:4 row_mask:0xf bank_mask:0xf bound_ctrl:1
    v_and_b32 v30, v40, v6
    v_and_b32 v31, v40, v7
    v_mfma_f32_16x16x32_bf16 v[16:19], v[224:227], v[24:27], v[16:19]
    buffer_load_dwordx4 v[224:227], v2, s[4:7], s34 offen offset:0 nt
    v_and_b32 v32, v41, v4
    v_and_b32 v33, v41, v5
    v_and_b32_dpp v34, v41, v6 row_shr:4 row_mask:0xf bank_mask:0xf bound_ctrl:1
    v_and_b32_dpp v35, v41, v7 row_shr:4 row_mask:0xf bank_mask:0xf bound_ctrl:1
    v_mfma_f32_16x16x32_bf16 v[16:19], v[228:231], v[28:31], v[16:19]
    buffer_load_dwordx4 v[228:231], v2, s[4:7], s34 offen offset:1024 nt
    v_and_b32_dpp v36, v41, v4 row_shl:4 row_mask:0xf bank_mask:0xf bound_ctrl:1
    v_and_b32_dpp v37, v41, v5 row_shl:4 row_mask:0xf bank_mask:0xf bound_ctrl:1
    v_and_b32 v38, v41, v6
    v_and_b32 v39, v41, v7
    v_mfma_f32_16x16x32_bf16 v[16:19], v[232:235], v[32:35], v[16:19]
    buffer_load_dwordx4 v[232:235], v2, s[4:7], s34 offen offset:2048 nt
    v_and_b32 v24, v42, v4
    v_and_b32 v25, v42, v5
    v_and_b32_dpp v26, v42, v6 row_shr:4 row_mask:0xf bank_mask:0xf bound_ctrl:1
    v_and_b32_dpp v27, v42, v7 row_shr:4 row_mask:0xf bank_mask:0xf bound_ctrl:1
    v_mfma_f32_16x16x32_bf16 v[16:19], v[236:239], v[36:39], v[16:19]
    buffer_load_dwordx4 v[236:239], v2, s[4:7], s34 offen offset:3072 nt
    v_and_b32_dpp v28, v42, v4 row_shl:4 row_mask:0xf bank_mask:0xf bound_ctrl:1
    v_and_b32_dpp v29, v42, v5 row_shl:4 row_mask:0xf bank_mask:0xf bound_ctrl:1
    v_and_b32 v30, v42, v6
    v_and_b32 v31, v42, v7
    v_mfma_f32_16x16x32_bf16 v[16:19], v[240:243], v[24:27], v[16:19]
    buffer_load_dwordx4 v[240:243], v2, s[4:7], s35 offen offset:0 nt
    v_and_b32 v32, v43, v4
    v_and_b32 v33, v43, v5
    v_and_b32_dpp v34, v43, v6 row_shr:4 row_mask:0xf bank_mask:0xf bound_ctrl:1
    v_and_b32_dpp v35, v43, v7 row_shr:4 row_mask:0xf bank_mask:0xf bound_ctrl:1
    v_mfma_f32_16x16x32_bf16 v[16:19], v[244:247], v[28:31], v[16:19]
    buffer_load_dwordx4 v[244:247], v2, s[4:7], s35 offen offset:1024 nt
    v_and_b32_dpp v36, v43, v4 row_shl:4 row_mask:0xf bank_mask:0xf bound_ctrl:1
    v_and_b32_dpp v37, v43, v5 row_shl:4 row_mask:0xf bank_mask:0xf bound_ctrl:1
    v_and_b32 v38, v43, v6
    v_and_b32 v39, v43, v7
    v_mfma_f32_16x16x32_bf16 v[16:19], v[248:251], v[32:35], v[16:19]
    buffer_load_dwordx4 v[248:251], v2, s[4:7], s35 offen offset:2048 nt
    v_mfma_f32_16x16x32_bf16 v[16:19], v[252:255], v[36:39], v[16:19]
    buffer_load_dwordx4 v[252:255], v2, s[4:7], s35 offen offset:3072 nt
    s_add_u32 s32, s57, 5242880
    s_xor_b32 s32, s32, 8192
    s_add_u32 s34, s57, 5767168
    s_xor_b32 s34, s34, 8192
    s_xor_b32 s35, s34, 4096
    s_xor_b32 s33, s32, 4096
    s_waitcnt vmcnt(47)
    s_waitcnt vmcnt(46)
    v_mfma_f32_16x16x32_bf16 v[24:27], v[128:131], v[8:11], 0
    v_mfma_f32_16x16x32_bf16 v[24:27], v[132:135], v[12:15], v[24:27]
    s_waitcnt vmcnt(44)
    v_mfma_f32_16x16x32_bf16 v[28:31], v[136:139], v[8:11], 0
    v_mfma_f32_16x16x32_bf16 v[28:31], v[140:143], v[12:15], v[28:31]
    s_waitcnt vmcnt(42)
    v_mfma_f32_16x16x32_bf16 v[32:35], v[144:147], v[8:11], 0
    v_mfma_f32_16x16x32_bf16 v[32:35], v[148:151], v[12:15], v[32:35]
    s_waitcnt vmcnt(40)
    v_mfma_f32_16x16x32_bf16 v[36:39], v[152:155], v[8:11], 0
    v_mfma_f32_16x16x32_bf16 v[36:39], v[156:159], v[12:15], v[36:39]
    v_mov_b32_dpp v40, v24 quad_perm:[0,0,0,0] row_mask:0xf bank_mask:0xf
    s_nop 0
    v_mov_b32_dpp v41, v28 quad_perm:[0,0,0,0] row_mask:0xf bank_mask:0xf
    s_nop 1
    v_mov_b32_dpp v42, v32 quad_perm:[0,0,0,0] row_mask:0xf bank_mask:0xf
    v_add_f32_dpp v40, v25, v40 quad_perm:[1,1,1,1] row_mask:0xf bank_mask:0xf
    v_add_f32_dpp v41, v29, v41 quad_perm:[1,1,1,1] row_mask:0xf bank_mask:0xf
    v_add_f32_dpp v42, v33, v42 quad_perm:[1,1,1,1] row_mask:0xf bank_mask:0xf
    v_add_f32_dpp v40, v26, v40 quad_perm:[2,2,2,2] row_mask:0xf bank_mask:0xf
    v_add_f32_dpp v41, v30, v41 quad_perm:[2,2,2,2] row_mask:0xf bank_mask:0xf
    v_mov_b32_dpp v43, v36 quad_perm:[0,0,0,0] row_mask:0xf bank_mask:0xf
    v_add_f32_dpp v42, v34, v42 quad_perm:[2,2,2,2] row_mask:0xf bank_mask:0xf
    v_add_f32_dpp v40, v27, v40 quad_perm:[3,3,3,3] row_mask:0xf bank_mask:0xf
    v_add_f32_dpp v43, v37, v43 quad_perm:[1,1,1,1] row_mask:0xf bank_mask:0xf
    v_add_f32_dpp v41, v31, v41 quad_perm:[3,3,3,3] row_mask:0xf bank_mask:0xf
    v_add_f32_dpp v42, v35, v42 quad_perm:[3,3,3,3] row_mask:0xf bank_mask:0xf
    v_add_f32_dpp v43, v38, v43 quad_perm:[2,2,2,2] row_mask:0xf bank_mask:0xf
    v_max3_f32 v44, v40, v41, v20
    s_nop 0
    v_add_f32_dpp v43, v39, v43 quad_perm:[3,3,3,3] row_mask:0xf bank_mask:0xf
    v_max3_f32 v44, v44, v42, v43
    s_nop 1
    v_max_f32_dpp v44, v44, v44 row_half_mirror row_mask:0xf bank_mask:0xf
    v_mov_b32 v45, v44
    s_nop 1
    v_permlane16_swap_b32 v44, v45
    v_max_f32 v44, v44, v45
    v_mov_b32 v45, v44
    s_nop 1
    v_permlane32_swap_b32 v44, v45
    v_max_f32 v44, v44, v45
    v_sub_f32 v45, v20, v44
    v_mul_f32 v45, s30, v45
    v_exp_f32 v45, v45
    v_mov_b32 v20, v44
    v_mul_f32 v22, s30, v44
    v_fma_f32 v40, v40, s30, -v22
    v_fma_f32 v41, v41, s30, -v22
    v_fma_f32 v42, v42, s30, -v22
    v_fma_f32 v43, v43, s30, -v22
    v_exp_f32 v40, v40
    v_exp_f32 v41, v41
    v_exp_f32 v42, v42
    v_exp_f32 v43, v43
    v_mul_f32 v21, v21, v45
    v_mul_f32 v16, v16, v45
    v_mul_f32 v17, v17, v45
    v_mul_f32 v18, v18, v45
    v_mul_f32 v19, v19, v45
    v_add_f32 v46, v40, v41
    v_add_f32 v47, v42, v43
    v_cvt_pk_bf16_f32 v40, v40, v40
    v_cvt_pk_bf16_f32 v41, v41, v41
    v_cvt_pk_bf16_f32 v42, v42, v42
    v_cvt_pk_bf16_f32 v43, v43, v43
    v_add_f32 v46, v46, v47
    v_add_f32 v21, v21, v46
    v_and_b32 v24, v40, v4
    v_and_b32 v25, v40, v5
    v_and_b32_dpp v26, v40, v6 row_shr:4 row_mask:0xf bank_mask:0xf bound_ctrl:1
    v_and_b32_dpp v27, v40, v7 row_shr:4 row_mask:0xf bank_mask:0xf bound_ctrl:1
    v_and_b32_dpp v28, v40, v4 row_shl:4 row_mask:0xf bank_mask:0xf bound_ctrl:1
    v_and_b32_dpp v29, v40, v5 row_shl:4 row_mask:0xf bank_mask:0xf bound_ctrl:1
    v_and_b32 v30, v40, v6
    v_and_b32 v31, v40, v7
    s_waitcnt vmcnt(31)
    v_mfma_f32_16x16x32_bf16 v[16:19], v[64:67], v[24:27], v[16:19]
    buffer_load_dwordx4 v[64:67], v3, s[8:11], s32 offen offset:0
    v_and_b32 v32, v41, v4
    v_and_b32 v33, v41, v5
    v_and_b32_dpp v34, v41, v6 row_shr:4 row_mask:0xf bank_mask:0xf bound_ctrl:1
    v_and_b32_dpp v35, v41, v7 row_shr:4 row_mask:0xf bank_mask:0xf bound_ctrl:1
    s_waitcnt vmcnt(31)
    v_mfma_f32_16x16x32_bf16 v[16:19], v[68:71], v[28:31], v[16:19]
    buffer_load_dwordx4 v[68:71], v3, s[8:11], s32 offen offset:1024
    v_and_b32_dpp v36, v41, v4 row_shl:4 row_mask:0xf bank_mask:0xf bound_ctrl:1
    v_and_b32_dpp v37, v41, v5 row_shl:4 row_mask:0xf bank_mask:0xf bound_ctrl:1
    v_and_b32 v38, v41, v6
    v_and_b32 v39, v41, v7
    s_waitcnt vmcnt(31)
    v_mfma_f32_16x16x32_bf16 v[16:19], v[72:75], v[32:35], v[16:19]
    buffer_load_dwordx4 v[72:75], v3, s[8:11], s32 offen offset:2048
    v_and_b32 v24, v42, v4
    v_and_b32 v25, v42, v5
    v_and_b32_dpp v26, v42, v6 row_shr:4 row_mask:0xf bank_mask:0xf bound_ctrl:1
    v_and_b32_dpp v27, v42, v7 row_shr:4 row_mask:0xf bank_mask:0xf bound_ctrl:1
    s_waitcnt vmcnt(31)
    v_mfma_f32_16x16x32_bf16 v[16:19], v[76:79], v[36:39], v[16:19]
    buffer_load_dwordx4 v[76:79], v3, s[8:11], s32 offen offset:3072
    v_and_b32_dpp v28, v42, v4 row_shl:4 row_mask:0xf bank_mask:0xf bound_ctrl:1
    v_and_b32_dpp v29, v42, v5 row_shl:4 row_mask:0xf bank_mask:0xf bound_ctrl:1
    v_and_b32 v30, v42, v6
    v_and_b32 v31, v42, v7
    s_waitcnt vmcnt(31)
    v_mfma_f32_16x16x32_bf16 v[16:19], v[80:83], v[24:27], v[16:19]
    buffer_load_dwordx4 v[80:83], v3, s[8:11], s33 offen offset:0
    v_and_b32 v32, v43, v4
    v_and_b32 v33, v43, v5
    v_and_b32_dpp v34, v43, v6 row_shr:4 row_mask:0xf bank_mask:0xf bound_ctrl:1
    v_and_b32_dpp v35, v43, v7 row_shr:4 row_mask:0xf bank_mask:0xf bound_ctrl:1
    s_waitcnt vmcnt(31)
    v_mfma_f32_16x16x32_bf16 v[16:19], v[84:87], v[28:31], v[16:19]
    buffer_load_dwordx4 v[84:87], v3, s[8:11], s33 offen offset:1024
    v_and_b32_dpp v36, v43, v4 row_shl:4 row_mask:0xf bank_mask:0xf bound_ctrl:1
    v_and_b32_dpp v37, v43, v5 row_shl:4 row_mask:0xf bank_mask:0xf bound_ctrl:1
    v_and_b32 v38, v43, v6
    v_and_b32 v39, v43, v7
    s_waitcnt vmcnt(31)
    v_mfma_f32_16x16x32_bf16 v[16:19], v[88:91], v[32:35], v[16:19]
    buffer_load_dwordx4 v[88:91], v3, s[8:11], s33 offen offset:2048
    s_waitcnt vmcnt(31)
    v_mfma_f32_16x16x32_bf16 v[16:19], v[92:95], v[36:39], v[16:19]
    buffer_load_dwordx4 v[92:95], v3, s[8:11], s33 offen offset:3072
    v_mfma_f32_16x16x32_bf16 v[24:27], v[160:163], v[8:11], 0
    v_mfma_f32_16x16x32_bf16 v[24:27], v[164:167], v[12:15], v[24:27]
    v_mfma_f32_16x16x32_bf16 v[28:31], v[168:171], v[8:11], 0
    v_mfma_f32_16x16x32_bf16 v[28:31], v[172:175], v[12:15], v[28:31]
    v_mfma_f32_16x16x32_bf16 v[32:35], v[176:179], v[8:11], 0
    v_mfma_f32_16x16x32_bf16 v[32:35], v[180:183], v[12:15], v[32:35]
    v_mfma_f32_16x16x32_bf16 v[36:39], v[184:187], v[8:11], 0
    v_mfma_f32_16x16x32_bf16 v[36:39], v[188:191], v[12:15], v[36:39]
    s_nop 1
    v_mov_b32_dpp v40, v24 quad_perm:[0,0,0,0] row_mask:0xf bank_mask:0xf
    s_nop 0
    v_mov_b32_dpp v41, v28 quad_perm:[0,0,0,0] row_mask:0xf bank_mask:0xf
    s_nop 0
    v_mov_b32_dpp v42, v32 quad_perm:[0,0,0,0] row_mask:0xf bank_mask:0xf
    v_add_f32_dpp v40, v25, v40 quad_perm:[1,1,1,1] row_mask:0xf bank_mask:0xf
    v_add_f32_dpp v41, v29, v41 quad_perm:[1,1,1,1] row_mask:0xf bank_mask:0xf
    v_add_f32_dpp v42, v33, v42 quad_perm:[1,1,1,1] row_mask:0xf bank_mask:0xf
    v_add_f32_dpp v40, v26, v40 quad_perm:[2,2,2,2] row_mask:0xf bank_mask:0xf
    v_add_f32_dpp v41, v30, v41 quad_perm:[2,2,2,2] row_mask:0xf bank_mask:0xf
    v_mov_b32_dpp v43, v36 quad_perm:[0,0,0,0] row_mask:0xf bank_mask:0xf
    v_add_f32_dpp v42, v34, v42 quad_perm:[2,2,2,2] row_mask:0xf bank_mask:0xf
    v_add_f32_dpp v40, v27, v40 quad_perm:[3,3,3,3] row_mask:0xf bank_mask:0xf
    v_add_f32_dpp v43, v37, v43 quad_perm:[1,1,1,1] row_mask:0xf bank_mask:0xf
    v_add_f32_dpp v41, v31, v41 quad_perm:[3,3,3,3] row_mask:0xf bank_mask:0xf
    v_add_f32_dpp v42, v35, v42 quad_perm:[3,3,3,3] row_mask:0xf bank_mask:0xf
    v_add_f32_dpp v43, v38, v43 quad_perm:[2,2,2,2] row_mask:0xf bank_mask:0xf
    v_max3_f32 v44, v40, v41, v20
    s_nop 0
    v_add_f32_dpp v43, v39, v43 quad_perm:[3,3,3,3] row_mask:0xf bank_mask:0xf
    v_max3_f32 v44, v44, v42, v43
    s_nop 1
    v_max_f32_dpp v44, v44, v44 row_half_mirror row_mask:0xf bank_mask:0xf
    v_mov_b32 v45, v44
    s_nop 1
    v_permlane16_swap_b32 v44, v45
    v_max_f32 v44, v44, v45
    v_mov_b32 v45, v44
    s_nop 1
    v_permlane32_swap_b32 v44, v45
    v_max_f32 v44, v44, v45
    v_sub_f32 v45, v20, v44
    v_mul_f32 v45, s30, v45
    v_exp_f32 v45, v45
    v_mov_b32 v20, v44
    v_mul_f32 v22, s30, v44
    v_fma_f32 v40, v40, s30, -v22
    v_fma_f32 v41, v41, s30, -v22
    v_fma_f32 v42, v42, s30, -v22
    v_fma_f32 v43, v43, s30, -v22
    v_exp_f32 v40, v40
    v_exp_f32 v41, v41
    v_exp_f32 v42, v42
    v_exp_f32 v43, v43
    v_mul_f32 v21, v21, v45
    v_mul_f32 v16, v16, v45
    v_mul_f32 v17, v17, v45
    v_mul_f32 v18, v18, v45
    v_mul_f32 v19, v19, v45
    v_add_f32 v46, v40, v41
    v_add_f32 v47, v42, v43
    v_cvt_pk_bf16_f32 v40, v40, v40
    v_cvt_pk_bf16_f32 v41, v41, v41
    v_cvt_pk_bf16_f32 v42, v42, v42
    v_cvt_pk_bf16_f32 v43, v43, v43
    v_add_f32 v46, v46, v47
    v_add_f32 v21, v21, v46
    v_and_b32 v24, v40, v4
    v_and_b32 v25, v40, v5
    v_and_b32_dpp v26, v40, v6 row_shr:4 row_mask:0xf bank_mask:0xf bound_ctrl:1
    v_and_b32_dpp v27, v40, v7 row_shr:4 row_mask:0xf bank_mask:0xf bound_ctrl:1
    v_and_b32_dpp v28, v40, v4 row_shl:4 row_mask:0xf bank_mask:0xf bound_ctrl:1
    v_and_b32_dpp v29, v40, v5 row_shl:4 row_mask:0xf bank_mask:0xf bound_ctrl:1
    v_and_b32 v30, v40, v6
    v_and_b32 v31, v40, v7
    s_waitcnt vmcnt(31)
    v_mfma_f32_16x16x32_bf16 v[16:19], v[96:99], v[24:27], v[16:19]
    buffer_load_dwordx4 v[96:99], v3, s[8:11], s34 offen offset:0
    v_and_b32 v32, v41, v4
    v_and_b32 v33, v41, v5
    v_and_b32_dpp v34, v41, v6 row_shr:4 row_mask:0xf bank_mask:0xf bound_ctrl:1
    v_and_b32_dpp v35, v41, v7 row_shr:4 row_mask:0xf bank_mask:0xf bound_ctrl:1
    s_waitcnt vmcnt(31)
    v_mfma_f32_16x16x32_bf16 v[16:19], v[100:103], v[28:31], v[16:19]
    buffer_load_dwordx4 v[100:103], v3, s[8:11], s34 offen offset:1024
    v_and_b32_dpp v36, v41, v4 row_shl:4 row_mask:0xf bank_mask:0xf bound_ctrl:1
    v_and_b32_dpp v37, v41, v5 row_shl:4 row_mask:0xf bank_mask:0xf bound_ctrl:1
    v_and_b32 v38, v41, v6
    v_and_b32 v39, v41, v7
    s_waitcnt vmcnt(31)
    v_mfma_f32_16x16x32_bf16 v[16:19], v[104:107], v[32:35], v[16:19]
    buffer_load_dwordx4 v[104:107], v3, s[8:11], s34 offen offset:2048
    v_and_b32 v24, v42, v4
    v_and_b32 v25, v42, v5
    v_and_b32_dpp v26, v42, v6 row_shr:4 row_mask:0xf bank_mask:0xf bound_ctrl:1
    v_and_b32_dpp v27, v42, v7 row_shr:4 row_mask:0xf bank_mask:0xf bound_ctrl:1
    s_waitcnt vmcnt(31)
    v_mfma_f32_16x16x32_bf16 v[16:19], v[108:111], v[36:39], v[16:19]
    buffer_load_dwordx4 v[108:111], v3, s[8:11], s34 offen offset:3072
    v_and_b32_dpp v28, v42, v4 row_shl:4 row_mask:0xf bank_mask:0xf bound_ctrl:1
    v_and_b32_dpp v29, v42, v5 row_shl:4 row_mask:0xf bank_mask:0xf bound_ctrl:1
    v_and_b32 v30, v42, v6
    v_and_b32 v31, v42, v7
    s_waitcnt vmcnt(31)
    v_mfma_f32_16x16x32_bf16 v[16:19], v[112:115], v[24:27], v[16:19]
    buffer_load_dwordx4 v[112:115], v3, s[8:11], s35 offen offset:0
    v_and_b32 v32, v43, v4
    v_and_b32 v33, v43, v5
    v_and_b32_dpp v34, v43, v6 row_shr:4 row_mask:0xf bank_mask:0xf bound_ctrl:1
    v_and_b32_dpp v35, v43, v7 row_shr:4 row_mask:0xf bank_mask:0xf bound_ctrl:1
    s_waitcnt vmcnt(31)
    v_mfma_f32_16x16x32_bf16 v[16:19], v[116:119], v[28:31], v[16:19]
    buffer_load_dwordx4 v[116:119], v3, s[8:11], s35 offen offset:1024
    v_and_b32_dpp v36, v43, v4 row_shl:4 row_mask:0xf bank_mask:0xf bound_ctrl:1
    v_and_b32_dpp v37, v43, v5 row_shl:4 row_mask:0xf bank_mask:0xf bound_ctrl:1
    v_and_b32 v38, v43, v6
    v_and_b32 v39, v43, v7
    s_waitcnt vmcnt(31)
    v_mfma_f32_16x16x32_bf16 v[16:19], v[120:123], v[32:35], v[16:19]
    buffer_load_dwordx4 v[120:123], v3, s[8:11], s35 offen offset:2048
    s_waitcnt vmcnt(31)
    v_mfma_f32_16x16x32_bf16 v[16:19], v[124:127], v[36:39], v[16:19]
    buffer_load_dwordx4 v[124:127], v3, s[8:11], s35 offen offset:3072
    s_add_u32 s32, s57, 6291456
    s_mov_b32 s34, s32
    s_xor_b32 s35, s34, 4096
    s_xor_b32 s33, s32, 4096
    s_waitcnt vmcnt(47)
    s_waitcnt vmcnt(30)
    v_mfma_f32_16x16x32_bf16 v[24:27], v[192:195], v[8:11], 0
    v_mfma_f32_16x16x32_bf16 v[24:27], v[196:199], v[12:15], v[24:27]
    s_waitcnt vmcnt(28)
    v_mfma_f32_16x16x32_bf16 v[28:31], v[200:203], v[8:11], 0
    v_mfma_f32_16x16x32_bf16 v[28:31], v[204:207], v[12:15], v[28:31]
    s_waitcnt vmcnt(26)
    v_mfma_f32_16x16x32_bf16 v[32:35], v[208:211], v[8:11], 0
    v_mfma_f32_16x16x32_bf16 v[32:35], v[212:215], v[12:15], v[32:35]
    s_waitcnt vmcnt(24)
    v_mfma_f32_16x16x32_bf16 v[36:39], v[216:219], v[8:11], 0
    v_mfma_f32_16x16x32_bf16 v[36:39], v[220:223], v[12:15], v[36:39]
    v_mov_b32_dpp v40, v24 quad_perm:[0,0,0,0] row_mask:0xf bank_mask:0xf
    s_nop 0
    v_mov_b32_dpp v41, v28 quad_perm:[0,0,0,0] row_mask:0xf bank_mask:0xf
    s_nop 1
    v_mov_b32_dpp v42, v32 quad_perm:[0,0,0,0] row_mask:0xf bank_mask:0xf
    v_add_f32_dpp v40, v25, v40 quad_perm:[1,1,1,1] row_mask:0xf bank_mask:0xf
    v_add_f32_dpp v41, v29, v41 quad_perm:[1,1,1,1] row_mask:0xf bank_mask:0xf
    v_add_f32_dpp v42, v33, v42 quad_perm:[1,1,1,1] row_mask:0xf bank_mask:0xf
    v_add_f32_dpp v40, v26, v40 quad_perm:[2,2,2,2] row_mask:0xf bank_mask:0xf
    v_add_f32_dpp v41, v30, v41 quad_perm:[2,2,2,2] row_mask:0xf bank_mask:0xf
    v_mov_b32_dpp v43, v36 quad_perm:[0,0,0,0] row_mask:0xf bank_mask:0xf
    v_add_f32_dpp v42, v34, v42 quad_perm:[2,2,2,2] row_mask:0xf bank_mask:0xf
    v_add_f32_dpp v40, v27, v40 quad_perm:[3,3,3,3] row_mask:0xf bank_mask:0xf
    v_add_f32_dpp v43, v37, v43 quad_perm:[1,1,1,1] row_mask:0xf bank_mask:0xf
    v_add_f32_dpp v41, v31, v41 quad_perm:[3,3,3,3] row_mask:0xf bank_mask:0xf
    v_add_f32_dpp v42, v35, v42 quad_perm:[3,3,3,3] row_mask:0xf bank_mask:0xf
    v_add_f32_dpp v43, v38, v43 quad_perm:[2,2,2,2] row_mask:0xf bank_mask:0xf
    v_max3_f32 v44, v40, v41, v20
    s_nop 0
    v_add_f32_dpp v43, v39, v43 quad_perm:[3,3,3,3] row_mask:0xf bank_mask:0xf
    v_max3_f32 v44, v44, v42, v43
    s_nop 1
    v_max_f32_dpp v44, v44, v44 row_half_mirror row_mask:0xf bank_mask:0xf
    v_mov_b32 v45, v44
    s_nop 1
    v_permlane16_swap_b32 v44, v45
    v_max_f32 v44, v44, v45
    v_mov_b32 v45, v44
    s_nop 1
    v_permlane32_swap_b32 v44, v45
    v_max_f32 v44, v44, v45
    v_sub_f32 v45, v20, v44
    v_mul_f32 v45, s30, v45
    v_exp_f32 v45, v45
    v_mov_b32 v20, v44
    v_mul_f32 v22, s30, v44
    v_fma_f32 v40, v40, s30, -v22
    v_fma_f32 v41, v41, s30, -v22
    v_fma_f32 v42, v42, s30, -v22
    v_fma_f32 v43, v43, s30, -v22
    v_exp_f32 v40, v40
    v_exp_f32 v41, v41
    v_exp_f32 v42, v42
    v_exp_f32 v43, v43
    v_mul_f32 v21, v21, v45
    v_mul_f32 v16, v16, v45
    v_mul_f32 v17, v17, v45
    v_mul_f32 v18, v18, v45
    v_mul_f32 v19, v19, v45
    v_add_f32 v46, v40, v41
    v_add_f32 v47, v42, v43
    v_cvt_pk_bf16_f32 v40, v40, v40
    v_cvt_pk_bf16_f32 v41, v41, v41
    v_cvt_pk_bf16_f32 v42, v42, v42
    v_cvt_pk_bf16_f32 v43, v43, v43
    v_add_f32 v46, v46, v47
    v_add_f32 v21, v21, v46
    v_and_b32 v24, v40, v4
    v_and_b32 v25, v40, v5
    v_and_b32_dpp v26, v40, v6 row_shr:4 row_mask:0xf bank_mask:0xf bound_ctrl:1
    v_and_b32_dpp v27, v40, v7 row_shr:4 row_mask:0xf bank_mask:0xf bound_ctrl:1
    v_and_b32_dpp v28, v40, v4 row_shl:4 row_mask:0xf bank_mask:0xf bound_ctrl:1
    v_and_b32_dpp v29, v40, v5 row_shl:4 row_mask:0xf bank_mask:0xf bound_ctrl:1
    v_and_b32 v30, v40, v6
    v_and_b32 v31, v40, v7
    s_waitcnt vmcnt(15)
    v_mfma_f32_16x16x32_bf16 v[16:19], v[64:67], v[24:27], v[16:19]
    buffer_load_dwordx4 v[64:67], v2, s[4:7], s32 offen offset:0 nt
    v_and_b32 v32, v41, v4
    v_and_b32 v33, v41, v5
    v_and_b32_dpp v34, v41, v6 row_shr:4 row_mask:0xf bank_mask:0xf bound_ctrl:1
    v_and_b32_dpp v35, v41, v7 row_shr:4 row_mask:0xf bank_mask:0xf bound_ctrl:1
    s_waitcnt vmcnt(15)
    v_mfma_f32_16x16x32_bf16 v[16:19], v[68:71], v[28:31], v[16:19]
    buffer_load_dwordx4 v[68:71], v2, s[4:7], s32 offen offset:1024 nt
    v_and_b32_dpp v36, v41, v4 row_shl:4 row_mask:0xf bank_mask:0xf bound_ctrl:1
    v_and_b32_dpp v37, v41, v5 row_shl:4 row_mask:0xf bank_mask:0xf bound_ctrl:1
    v_and_b32 v38, v41, v6
    v_and_b32 v39, v41, v7
    s_waitcnt vmcnt(15)
    v_mfma_f32_16x16x32_bf16 v[16:19], v[72:75], v[32:35], v[16:19]
    buffer_load_dwordx4 v[72:75], v2, s[4:7], s32 offen offset:2048 nt
    v_and_b32 v24, v42, v4
    v_and_b32 v25, v42, v5
    v_and_b32_dpp v26, v42, v6 row_shr:4 row_mask:0xf bank_mask:0xf bound_ctrl:1
    v_and_b32_dpp v27, v42, v7 row_shr:4 row_mask:0xf bank_mask:0xf bound_ctrl:1
    s_waitcnt vmcnt(15)
    v_mfma_f32_16x16x32_bf16 v[16:19], v[76:79], v[36:39], v[16:19]
    buffer_load_dwordx4 v[76:79], v2, s[4:7], s32 offen offset:3072 nt
    v_and_b32_dpp v28, v42, v4 row_shl:4 row_mask:0xf bank_mask:0xf bound_ctrl:1
    v_and_b32_dpp v29, v42, v5 row_shl:4 row_mask:0xf bank_mask:0xf bound_ctrl:1
    v_and_b32 v30, v42, v6
    v_and_b32 v31, v42, v7
    s_waitcnt vmcnt(15)
    v_mfma_f32_16x16x32_bf16 v[16:19], v[80:83], v[24:27], v[16:19]
    buffer_load_dwordx4 v[80:83], v2, s[4:7], s33 offen offset:0 nt
    v_and_b32 v32, v43, v4
    v_and_b32 v33, v43, v5
    v_and_b32_dpp v34, v43, v6 row_shr:4 row_mask:0xf bank_mask:0xf bound_ctrl:1
    v_and_b32_dpp v35, v43, v7 row_shr:4 row_mask:0xf bank_mask:0xf bound_ctrl:1
    s_waitcnt vmcnt(15)
    v_mfma_f32_16x16x32_bf16 v[16:19], v[84:87], v[28:31], v[16:19]
    buffer_load_dwordx4 v[84:87], v2, s[4:7], s33 offen offset:1024 nt
    v_and_b32_dpp v36, v43, v4 row_shl:4 row_mask:0xf bank_mask:0xf bound_ctrl:1
    v_and_b32_dpp v37, v43, v5 row_shl:4 row_mask:0xf bank_mask:0xf bound_ctrl:1
    v_and_b32 v38, v43, v6
    v_and_b32 v39, v43, v7
    s_waitcnt vmcnt(15)
    v_mfma_f32_16x16x32_bf16 v[16:19], v[88:91], v[32:35], v[16:19]
    buffer_load_dwordx4 v[88:91], v2, s[4:7], s33 offen offset:2048 nt
    s_waitcnt vmcnt(15)
    v_mfma_f32_16x16x32_bf16 v[16:19], v[92:95], v[36:39], v[16:19]
    buffer_load_dwordx4 v[92:95], v2, s[4:7], s33 offen offset:3072 nt
    v_mfma_f32_16x16x32_bf16 v[24:27], v[224:227], v[8:11], 0
    v_mfma_f32_16x16x32_bf16 v[24:27], v[228:231], v[12:15], v[24:27]
    v_mfma_f32_16x16x32_bf16 v[28:31], v[232:235], v[8:11], 0
    v_mfma_f32_16x16x32_bf16 v[28:31], v[236:239], v[12:15], v[28:31]
    v_mfma_f32_16x16x32_bf16 v[32:35], v[240:243], v[8:11], 0
    v_mfma_f32_16x16x32_bf16 v[32:35], v[244:247], v[12:15], v[32:35]
    v_mfma_f32_16x16x32_bf16 v[36:39], v[248:251], v[8:11], 0
    v_mfma_f32_16x16x32_bf16 v[36:39], v[252:255], v[12:15], v[36:39]
    s_nop 1
    v_mov_b32_dpp v40, v24 quad_perm:[0,0,0,0] row_mask:0xf bank_mask:0xf
    s_nop 0
    v_mov_b32_dpp v41, v28 quad_perm:[0,0,0,0] row_mask:0xf bank_mask:0xf
    s_nop 0
    v_mov_b32_dpp v42, v32 quad_perm:[0,0,0,0] row_mask:0xf bank_mask:0xf
    v_add_f32_dpp v40, v25, v40 quad_perm:[1,1,1,1] row_mask:0xf bank_mask:0xf
    v_add_f32_dpp v41, v29, v41 quad_perm:[1,1,1,1] row_mask:0xf bank_mask:0xf
    v_add_f32_dpp v42, v33, v42 quad_perm:[1,1,1,1] row_mask:0xf bank_mask:0xf
    v_add_f32_dpp v40, v26, v40 quad_perm:[2,2,2,2] row_mask:0xf bank_mask:0xf
    v_add_f32_dpp v41, v30, v41 quad_perm:[2,2,2,2] row_mask:0xf bank_mask:0xf
    v_mov_b32_dpp v43, v36 quad_perm:[0,0,0,0] row_mask:0xf bank_mask:0xf
    v_add_f32_dpp v42, v34, v42 quad_perm:[2,2,2,2] row_mask:0xf bank_mask:0xf
    v_add_f32_dpp v40, v27, v40 quad_perm:[3,3,3,3] row_mask:0xf bank_mask:0xf
    v_add_f32_dpp v43, v37, v43 quad_perm:[1,1,1,1] row_mask:0xf bank_mask:0xf
    v_add_f32_dpp v41, v31, v41 quad_perm:[3,3,3,3] row_mask:0xf bank_mask:0xf
    v_add_f32_dpp v42, v35, v42 quad_perm:[3,3,3,3] row_mask:0xf bank_mask:0xf
    v_add_f32_dpp v43, v38, v43 quad_perm:[2,2,2,2] row_mask:0xf bank_mask:0xf
    v_max3_f32 v44, v40, v41, v20
    s_nop 0
    v_add_f32_dpp v43, v39, v43 quad_perm:[3,3,3,3] row_mask:0xf bank_mask:0xf
    v_max3_f32 v44, v44, v42, v43
    s_nop 1
    v_max_f32_dpp v44, v44, v44 row_half_mirror row_mask:0xf bank_mask:0xf
    v_mov_b32 v45, v44
    s_nop 1
    v_permlane16_swap_b32 v44, v45
    v_max_f32 v44, v44, v45
    v_mov_b32 v45, v44
    s_nop 1
    v_permlane32_swap_b32 v44, v45
    v_max_f32 v44, v44, v45
    v_sub_f32 v45, v20, v44
    v_mul_f32 v45, s30, v45
    v_exp_f32 v45, v45
    v_mov_b32 v20, v44
    v_mul_f32 v22, s30, v44
    v_fma_f32 v40, v40, s30, -v22
    v_fma_f32 v41, v41, s30, -v22
    v_fma_f32 v42, v42, s30, -v22
    v_fma_f32 v43, v43, s30, -v22
    v_exp_f32 v40, v40
    v_exp_f32 v41, v41
    v_exp_f32 v42, v42
    v_exp_f32 v43, v43
    v_mul_f32 v21, v21, v45
    v_mul_f32 v16, v16, v45
    v_mul_f32 v17, v17, v45
    v_mul_f32 v18, v18, v45
    v_mul_f32 v19, v19, v45
    v_add_f32 v46, v40, v41
    v_add_f32 v47, v42, v43
    v_cvt_pk_bf16_f32 v40, v40, v40
    v_cvt_pk_bf16_f32 v41, v41, v41
    v_cvt_pk_bf16_f32 v42, v42, v42
    v_cvt_pk_bf16_f32 v43, v43, v43
    v_add_f32 v46, v46, v47
    v_add_f32 v21, v21, v46
    v_and_b32 v24, v40, v4
    v_and_b32 v25, v40, v5
    v_and_b32_dpp v26, v40, v6 row_shr:4 row_mask:0xf bank_mask:0xf bound_ctrl:1
    v_and_b32_dpp v27, v40, v7 row_shr:4 row_mask:0xf bank_mask:0xf bound_ctrl:1
    v_and_b32_dpp v28, v40, v4 row_shl:4 row_mask:0xf bank_mask:0xf bound_ctrl:1
    v_and_b32_dpp v29, v40, v5 row_shl:4 row_mask:0xf bank_mask:0xf bound_ctrl:1
    v_and_b32 v30, v40, v6
    v_and_b32 v31, v40, v7
    s_waitcnt vmcnt(15)
    v_mfma_f32_16x16x32_bf16 v[16:19], v[96:99], v[24:27], v[16:19]
    buffer_load_dwordx4 v[96:99], v3, s[8:11], s34 offen offset:0
    v_and_b32 v32, v41, v4
    v_and_b32 v33, v41, v5
    v_and_b32_dpp v34, v41, v6 row_shr:4 row_mask:0xf bank_mask:0xf bound_ctrl:1
    v_and_b32_dpp v35, v41, v7 row_shr:4 row_mask:0xf bank_mask:0xf bound_ctrl:1
    s_waitcnt vmcnt(15)
    v_mfma_f32_16x16x32_bf16 v[16:19], v[100:103], v[28:31], v[16:19]
    buffer_load_dwordx4 v[100:103], v3, s[8:11], s34 offen offset:1024
    v_and_b32_dpp v36, v41, v4 row_shl:4 row_mask:0xf bank_mask:0xf bound_ctrl:1
    v_and_b32_dpp v37, v41, v5 row_shl:4 row_mask:0xf bank_mask:0xf bound_ctrl:1
    v_and_b32 v38, v41, v6
    v_and_b32 v39, v41, v7
    s_waitcnt vmcnt(15)
    v_mfma_f32_16x16x32_bf16 v[16:19], v[104:107], v[32:35], v[16:19]
    buffer_load_dwordx4 v[104:107], v3, s[8:11], s34 offen offset:2048
    v_and_b32 v24, v42, v4
    v_and_b32 v25, v42, v5
    v_and_b32_dpp v26, v42, v6 row_shr:4 row_mask:0xf bank_mask:0xf bound_ctrl:1
    v_and_b32_dpp v27, v42, v7 row_shr:4 row_mask:0xf bank_mask:0xf bound_ctrl:1
    s_waitcnt vmcnt(15)
    v_mfma_f32_16x16x32_bf16 v[16:19], v[108:111], v[36:39], v[16:19]
    buffer_load_dwordx4 v[108:111], v3, s[8:11], s34 offen offset:3072
    v_and_b32_dpp v28, v42, v4 row_shl:4 row_mask:0xf bank_mask:0xf bound_ctrl:1
    v_and_b32_dpp v29, v42, v5 row_shl:4 row_mask:0xf bank_mask:0xf bound_ctrl:1
    v_and_b32 v30, v42, v6
    v_and_b32 v31, v42, v7
    s_waitcnt vmcnt(15)
    v_mfma_f32_16x16x32_bf16 v[16:19], v[112:115], v[24:27], v[16:19]
    buffer_load_dwordx4 v[112:115], v3, s[8:11], s35 offen offset:0
    v_and_b32 v32, v43, v4
    v_and_b32 v33, v43, v5
    v_and_b32_dpp v34, v43, v6 row_shr:4 row_mask:0xf bank_mask:0xf bound_ctrl:1
    v_and_b32_dpp v35, v43, v7 row_shr:4 row_mask:0xf bank_mask:0xf bound_ctrl:1
    s_waitcnt vmcnt(15)
    v_mfma_f32_16x16x32_bf16 v[16:19], v[116:119], v[28:31], v[16:19]
    buffer_load_dwordx4 v[116:119], v3, s[8:11], s35 offen offset:1024
    v_and_b32_dpp v36, v43, v4 row_shl:4 row_mask:0xf bank_mask:0xf bound_ctrl:1
    v_and_b32_dpp v37, v43, v5 row_shl:4 row_mask:0xf bank_mask:0xf bound_ctrl:1
    v_and_b32 v38, v43, v6
    v_and_b32 v39, v43, v7
    s_waitcnt vmcnt(15)
    v_mfma_f32_16x16x32_bf16 v[16:19], v[120:123], v[32:35], v[16:19]
    buffer_load_dwordx4 v[120:123], v3, s[8:11], s35 offen offset:2048
    s_waitcnt vmcnt(15)
    v_mfma_f32_16x16x32_bf16 v[16:19], v[124:127], v[36:39], v[16:19]
    buffer_load_dwordx4 v[124:127], v3, s[8:11], s35 offen offset:3072
    s_lshl_b32 s44, s24, 13
    s_add_u32 s44, s44, 130304
    v_add_u32 v40, s44, v3
    s_lshl_b32 s44, s26, 2
    s_add_u32 s44, s44, s24
    s_lshl_b32 s44, s44, 14
    s_getreg_b32 s47, hwreg(HW_REG_XCC_ID)
    s_bfe_u32 s47, s47, 0x10002
    s_waitcnt lgkmcnt(0)
    s_add_u32 s50, s44, 15740288
    s_memtime s[52:53]
    s_waitcnt lgkmcnt(0)
    s_buffer_load_dword s51, s[4:7], s50
    s_waitcnt lgkmcnt(0)
    s_memtime s[50:51]
    s_waitcnt lgkmcnt(0)
    s_sub_u32 s45, s50, s52
    s_add_u32 s50, s44, 15733248
    s_memtime s[52:53]
    s_waitcnt lgkmcnt(0)
    s_buffer_load_dword s51, s[4:7], s50
    s_waitcnt lgkmcnt(0)
    s_memtime s[50:51]
    s_waitcnt lgkmcnt(0)
    s_sub_u32 s46, s50, s52
    s_add_u32 s50, s44, 15742592
    s_memtime s[52:53]
    s_waitcnt lgkmcnt(0)
    s_buffer_load_dword s51, s[4:7], s50
    s_waitcnt lgkmcnt(0)
    s_memtime s[50:51]
    s_waitcnt lgkmcnt(0)
    s_sub_u32 s45, s50, s52
    s_sub_i32 s48, s45, s46
    s_min_i32 s48, s48, 300
    s_max_i32 s48, s48, -300
    s_sub_i32 s45, 0, s48
    s_cmp_eq_u32 s47, 0
    s_cselect_b32 s48, s48, s45
    s_atomic_add s48, s[88:89], 20
    s_mov_b32 s90, 1
    s_atomic_add s90, s[88:89], 0 glc
    s_waitcnt vmcnt(8)
    ds_write_b128 v40, v[64:67] offset:0
    ds_write_b128 v40, v[68:71] offset:1024
    ds_write_b128 v40, v[72:75] offset:2048
    ds_write_b128 v40, v[76:79] offset:3072
    ds_write_b128 v40, v[80:83] offset:4096
    ds_write_b128 v40, v[84:87] offset:5120
    ds_write_b128 v40, v[88:91] offset:6144
    ds_write_b128 v40, v[92:95] offset:7168
    s_branch LRING0
LP2:
    s_mov_b32 s3, 0
    s_mov_b32 s56, 416
    s_mov_b32 s60, 128
    s_mov_b32 s41, 0
    s_mov_b32 s54, -1
    s_mov_b32 s101, 0
    s_mov_b32 s36, 0
    s_mov_b32 s37, 1
    s_and_b32 s3, s3, s36
    s_mov_b32 s55, 32
    s_add_u32 s36, s36, 1
    s_branch LRINGGO
LRET1:
    s_add_u32 s34, s57, 0
    s_xor_b32 s34, s34, 8192
    s_xor_b32 s35, s34, 4096
    s_waitcnt vmcnt(55)
    v_mfma_f32_16x16x32_bf16 v[24:27], a[0:3], v[8:11], 0
    v_mfma_f32_16x16x32_bf16 v[24:27], a[4:7], v[12:15], v[24:27]
    buffer_load_dwordx4 a[0:3], v3, s[8:11], s34 offen offset:0
    buffer_load_dwordx4 a[4:7], v3, s[8:11], s34 offen offset:1024
    v_mfma_f32_16x16x32_bf16 v[28:31], a[8:11], v[8:11], 0
    v_mfma_f32_16x16x32_bf16 v[28:31], a[12:15], v[12:15], v[28:31]
    buffer_load_dwordx4 a[8:11], v3, s[8:11], s34 offen offset:2048
    buffer_load_dwordx4 a[12:15], v3, s[8:11], s34 offen offset:3072
    v_mfma_f32_16x16x32_bf16 v[32:35], a[16:19], v[8:11], 0
    v_mfma_f32_16x16x32_bf16 v[32:35], a[20:23], v[12:15], v[32:35]
    buffer_load_dwordx4 a[16:19], v3, s[8:11], s35 offen offset:0
    buffer_load_dwordx4 a[20:23], v3, s[8:11], s35 offen offset:1024
    v_mfma_f32_16x16x32_bf16 v[36:39], a[24:27], v[8:11], 0
    v_mfma_f32_16x16x32_bf16 v[36:39], a[28:31], v[12:15], v[36:39]
    buffer_load_dwordx4 a[24:27], v3, s[8:11], s35 offen offset:2048
    buffer_load_dwordx4 a[28:31], v3, s[8:11], s35 offen offset:3072
    v_mov_b32_dpp v52, v24 quad_perm:[0,0,0,0] row_mask:0xf bank_mask:0xf
    v_mov_b32_dpp v53, v28 quad_perm:[0,0,0,0] row_mask:0xf bank_mask:0xf
    v_mov_b32_dpp v54, v32 quad_perm:[0,0,0,0] row_mask:0xf bank_mask:0xf
    v_add_f32_dpp v52, v25, v52 quad_perm:[1,1,1,1] row_mask:0xf bank_mask:0xf
    v_add_f32_dpp v53, v29, v53 quad_perm:[1,1,1,1] row_mask:0xf bank_mask:0xf
    v_add_f32_dpp v54, v33, v54 quad_perm:[1,1,1,1] row_mask:0xf bank_mask:0xf
    v_add_f32_dpp v52, v26, v52 quad_perm:[2,2,2,2] row_mask:0xf bank_mask:0xf
    v_add_f32_dpp v53, v30, v53 quad_perm:[2,2,2,2] row_mask:0xf bank_mask:0xf
    v_mov_b32_dpp v55, v36 quad_perm:[0,0,0,0] row_mask:0xf bank_mask:0xf
    v_add_f32_dpp v54, v34, v54 quad_perm:[2,2,2,2] row_mask:0xf bank_mask:0xf
    v_add_f32_dpp v52, v27, v52 quad_perm:[3,3,3,3] row_mask:0xf bank_mask:0xf
    v_add_f32_dpp v55, v37, v55 quad_perm:[1,1,1,1] row_mask:0xf bank_mask:0xf
    v_add_f32_dpp v53, v31, v53 quad_perm:[3,3,3,3] row_mask:0xf bank_mask:0xf
    v_add_f32_dpp v54, v35, v54 quad_perm:[3,3,3,3] row_mask:0xf bank_mask:0xf
    v_add_f32_dpp v55, v38, v55 quad_perm:[2,2,2,2] row_mask:0xf bank_mask:0xf
    s_nop 1
    v_add_f32_dpp v55, v39, v55 quad_perm:[3,3,3,3] row_mask:0xf bank_mask:0xf
    s_mov_b32 s101, 0
    s_mov_b32 s55, 61
    s_add_u32 s36, s36, 1
    s_branch LRINGGO
LRET2:
    v_max3_f32 v44, v52, v53, v20
    v_max3_f32 v44, v44, v54, v55
    s_nop 1
    v_max_f32_dpp v44, v44, v44 row_half_mirror row_mask:0xf bank_mask:0xf
    v_mov_b32 v45, v44
    s_nop 1
    v_permlane16_swap_b32 v44, v45
    v_max_f32 v44, v44, v45
    v_mov_b32 v45, v44
    s_nop 1
    v_permlane32_swap_b32 v44, v45
    v_max_f32 v44, v44, v45
    v_sub_f32 v45, v20, v44
    v_mul_f32 v45, s30, v45
    v_exp_f32 v45, v45
    v_mov_b32 v20, v44
    v_mul_f32 v22, s30, v44
    v_fma_f32 v52, v52, s30, -v22
    v_fma_f32 v53, v53, s30, -v22
    v_fma_f32 v54, v54, s30, -v22
    v_fma_f32 v55, v55, s30, -v22
    v_exp_f32 v52, v52
    v_exp_f32 v53, v53
    v_exp_f32 v54, v54
    v_exp_f32 v55, v55
    v_mul_f32 v21, v21, v45
    v_mul_f32 v16, v16, v45
    v_mul_f32 v17, v17, v45
    v_mul_f32 v18, v18, v45
    v_mul_f32 v19, v19, v45
    v_add_f32 v46, v52, v53
    v_add_f32 v47, v54, v55
    v_cvt_pk_bf16_f32 v52, v52, v52
    v_cvt_pk_bf16_f32 v53, v53, v53
    v_cvt_pk_bf16_f32 v54, v54, v54
    v_cvt_pk_bf16_f32 v55, v55, v55
    v_add_f32 v46, v46, v47
    v_add_f32 v21, v21, v46
    v_and_b32 v24, v52, v4
    v_and_b32 v25, v52, v5
    v_and_b32_dpp v26, v52, v6 row_shr:4 row_mask:0xf bank_mask:0xf bound_ctrl:1
    v_and_b32_dpp v27, v52, v7 row_shr:4 row_mask:0xf bank_mask:0xf bound_ctrl:1
    s_cmp_ge_u32 s101, 2
    s_nop 0
    s_cbranch_scc1 Lsw_1
    s_cmp_eq_u32 s101, 1
    s_cbranch_scc1 Lsw_2
    s_waitcnt vmcnt(0)
Lsw_2:
    s_waitcnt vmcnt(16)
Lsw_1:
    s_waitcnt vmcnt(32)
    v_and_b32_dpp v28, v52, v4 row_shl:4 row_mask:0xf bank_mask:0xf bound_ctrl:1
    v_and_b32_dpp v29, v52, v5 row_shl:4 row_mask:0xf bank_mask:0xf bound_ctrl:1
    v_and_b32 v30, v52, v6
    v_and_b32 v31, v52, v7
    v_mfma_f32_16x16x32_bf16 v[16:19], a[0:3], v[24:27], v[16:19]
    v_and_b32 v32, v53, v4
    v_and_b32 v33, v53, v5
    v_and_b32_dpp v34, v53, v6 row_shr:4 row_mask:0xf bank_mask:0xf bound_ctrl:1
    v_and_b32_dpp v35, v53, v7 row_shr:4 row_mask:0xf bank_mask:0xf bound_ctrl:1
    v_mfma_f32_16x16x32_bf16 v[16:19], a[4:7], v[28:31], v[16:19]
    v_and_b32_dpp v36, v53, v4 row_shl:4 row_mask:0xf bank_mask:0xf bound_ctrl:1
    v_and_b32_dpp v37, v53, v5 row_shl:4 row_mask:0xf bank_mask:0xf bound_ctrl:1
    v_and_b32 v38, v53, v6
    v_and_b32 v39, v53, v7
    v_mfma_f32_16x16x32_bf16 v[16:19], a[8:11], v[32:35], v[16:19]
    v_and_b32 v24, v54, v4
    v_and_b32 v25, v54, v5
    v_and_b32_dpp v26, v54, v6 row_shr:4 row_mask:0xf bank_mask:0xf bound_ctrl:1
    v_and_b32_dpp v27, v54, v7 row_shr:4 row_mask:0xf bank_mask:0xf bound_ctrl:1
    v_mfma_f32_16x16x32_bf16 v[16:19], a[12:15], v[36:39], v[16:19]
    v_and_b32_dpp v28, v54, v4 row_shl:4 row_mask:0xf bank_mask:0xf bound_ctrl:1
    v_and_b32_dpp v29, v54, v5 row_shl:4 row_mask:0xf bank_mask:0xf bound_ctrl:1
    v_and_b32 v30, v54, v6
    v_and_b32 v31, v54, v7
    v_mfma_f32_16x16x32_bf16 v[16:19], a[16:19], v[24:27], v[16:19]
    v_and_b32 v32, v55, v4
    v_and_b32 v33, v55, v5
    v_and_b32_dpp v34, v55, v6 row_shr:4 row_mask:0xf bank_mask:0xf bound_ctrl:1
    v_and_b32_dpp v35, v55, v7 row_shr:4 row_mask:0xf bank_mask:0xf bound_ctrl:1
    v_mfma_f32_16x16x32_bf16 v[16:19], a[20:23], v[28:31], v[16:19]
    v_and_b32_dpp v36, v55, v4 row_shl:4 row_mask:0xf bank_mask:0xf bound_ctrl:1
    v_and_b32_dpp v37, v55, v5 row_shl:4 row_mask:0xf bank_mask:0xf bound_ctrl:1
    v_and_b32 v38, v55, v6
    v_and_b32 v39, v55, v7
    v_mfma_f32_16x16x32_bf16 v[16:19], a[24:27], v[32:35], v[16:19]
    s_nop 0
    v_mfma_f32_16x16x32_bf16 v[16:19], a[28:31], v[36:39], v[16:19]
    s_add_u32 s34, s57, 524288
    s_xor_b32 s34, s34, 8192
    s_xor_b32 s35, s34, 4096
    s_waitcnt vmcnt(55)
    v_mfma_f32_16x16x32_bf16 v[24:27], a[32:35], v[8:11], 0
    v_mfma_f32_16x16x32_bf16 v[24:27], a[36:39], v[12:15], v[24:27]
    buffer_load_dwordx4 a[32:35], v3, s[8:11], s34 offen offset:0
    buffer_load_dwordx4 a[36:39], v3, s[8:11], s34 offen offset:1024
    v_mfma_f32_16x16x32_bf16 v[28:31], a[40:43], v[8:11], 0
    v_mfma_f32_16x16x32_bf16 v[28:31], a[44:47], v[12:15], v[28:31]
    buffer_load_dwordx4 a[40:43], v3, s[8:11], s34 offen offset:2048
    buffer_load_dwordx4 a[44:47], v3, s[8:11], s34 offen offset:3072
    v_mfma_f32_16x16x32_bf16 v[32:35], a[48:51], v[8:11], 0
    v_mfma_f32_16x16x32_bf16 v[32:35], a[52:55], v[12:15], v[32:35]
    buffer_load_dwordx4 a[48:51], v3, s[8:11], s35 offen offset:0
    buffer_load_dwordx4 a[52:55], v3, s[8:11], s35 offen offset:1024
    v_mfma_f32_16x16x32_bf16 v[36:39], a[56:59], v[8:11], 0
    v_mfma_f32_16x16x32_bf16 v[36:39], a[60:63], v[12:15], v[36:39]
    buffer_load_dwordx4 a[56:59], v3, s[8:11], s35 offen offset:2048
    buffer_load_dwordx4 a[60:63], v3, s[8:11], s35 offen offset:3072
    v_mov_b32_dpp v52, v24 quad_perm:[0,0,0,0] row_mask:0xf bank_mask:0xf
    v_mov_b32_dpp v53, v28 quad_perm:[0,0,0,0] row_mask:0xf bank_mask:0xf
    v_mov_b32_dpp v54, v32 quad_perm:[0,0,0,0] row_mask:0xf bank_mask:0xf
    v_add_f32_dpp v52, v25, v52 quad_perm:[1,1,1,1] row_mask:0xf bank_mask:0xf
    v_add_f32_dpp v53, v29, v53 quad_perm:[1,1,1,1] row_mask:0xf bank_mask:0xf
    v_add_f32_dpp v54, v33, v54 quad_perm:[1,1,1,1] row_mask:0xf bank_mask:0xf
    v_add_f32_dpp v52, v26, v52 quad_perm:[2,2,2,2] row_mask:0xf bank_mask:0xf
    v_add_f32_dpp v53, v30, v53 quad_perm:[2,2,2,2] row_mask:0xf bank_mask:0xf
    v_mov_b32_dpp v55, v36 quad_perm:[0,0,0,0] row_mask:0xf bank_mask:0xf
    v_add_f32_dpp v54, v34, v54 quad_perm:[2,2,2,2] row_mask:0xf bank_mask:0xf
    v_add_f32_dpp v52, v27, v52 quad_perm:[3,3,3,3] row_mask:0xf bank_mask:0xf
    v_add_f32_dpp v55, v37, v55 quad_perm:[1,1,1,1] row_mask:0xf bank_mask:0xf
    v_add_f32_dpp v53, v31, v53 quad_perm:[3,3,3,3] row_mask:0xf bank_mask:0xf
    v_add_f32_dpp v54, v35, v54 quad_perm:[3,3,3,3] row_mask:0xf bank_mask:0xf
    v_add_f32_dpp v55, v38, v55 quad_perm:[2,2,2,2] row_mask:0xf bank_mask:0xf
    s_nop 1
    v_add_f32_dpp v55, v39, v55 quad_perm:[3,3,3,3] row_mask:0xf bank_mask:0xf
    s_mov_b32 s101, 0
    s_mov_b32 s55, 90
    s_add_u32 s36, s36, 1
    s_branch LRINGGO
LRET3:
    v_max3_f32 v44, v52, v53, v20
    v_max3_f32 v44, v44, v54, v55
    s_nop 1
    v_max_f32_dpp v44, v44, v44 row_half_mirror row_mask:0xf bank_mask:0xf
    v_mov_b32 v45, v44
    s_nop 1
    v_permlane16_swap_b32 v44, v45
    v_max_f32 v44, v44, v45
    v_mov_b32 v45, v44
    s_nop 1
    v_permlane32_swap_b32 v44, v45
    v_max_f32 v44, v44, v45
    v_sub_f32 v45, v20, v44
    v_mul_f32 v45, s30, v45
    v_exp_f32 v45, v45
    v_mov_b32 v20, v44
    v_mul_f32 v22, s30, v44
    v_fma_f32 v52, v52, s30, -v22
    v_fma_f32 v53, v53, s30, -v22
    v_fma_f32 v54, v54, s30, -v22
    v_fma_f32 v55, v55, s30, -v22
    v_exp_f32 v52, v52
    v_exp_f32 v53, v53
    v_exp_f32 v54, v54
    v_exp_f32 v55, v55
    v_mul_f32 v21, v21, v45
    v_mul_f32 v16, v16, v45
    v_mul_f32 v17, v17, v45
    v_mul_f32 v18, v18, v45
    v_mul_f32 v19, v19, v45
    v_add_f32 v46, v52, v53
    v_add_f32 v47, v54, v55
    v_cvt_pk_bf16_f32 v52, v52, v52
    v_cvt_pk_bf16_f32 v53, v53, v53
    v_cvt_pk_bf16_f32 v54, v54, v54
    v_cvt_pk_bf16_f32 v55, v55, v55
    v_add_f32 v46, v46, v47
    v_add_f32 v21, v21, v46
    v_and_b32 v24, v52, v4
    v_and_b32 v25, v52, v5
    v_and_b32_dpp v26, v52, v6 row_shr:4 row_mask:0xf bank_mask:0xf bound_ctrl:1
    v_and_b32_dpp v27, v52, v7 row_shr:4 row_mask:0xf bank_mask:0xf bound_ctrl:1
    s_cmp_ge_u32 s101, 2
    s_nop 0
    s_cbranch_scc1 Lsw_3
    s_cmp_eq_u32 s101, 1
    s_cbranch_scc1 Lsw_4
    s_waitcnt vmcnt(0)
Lsw_4:
    s_waitcnt vmcnt(16)
Lsw_3:
    s_waitcnt vmcnt(32)
    v_and_b32_dpp v28, v52, v4 row_shl:4 row_mask:0xf bank_mask:0xf bound_ctrl:1
    v_and_b32_dpp v29, v52, v5 row_shl:4 row_mask:0xf bank_mask:0xf bound_ctrl:1
    v_and_b32 v30, v52, v6
    v_and_b32 v31, v52, v7
    v_mfma_f32_16x16x32_bf16 v[16:19], a[32:35], v[24:27], v[16:19]
    v_and_b32 v32, v53, v4
    v_and_b32 v33, v53, v5
    v_and_b32_dpp v34, v53, v6 row_shr:4 row_mask:0xf bank_mask:0xf bound_ctrl:1
    v_and_b32_dpp v35, v53, v7 row_shr:4 row_mask:0xf bank_mask:0xf bound_ctrl:1
    v_mfma_f32_16x16x32_bf16 v[16:19], a[36:39], v[28:31], v[16:19]
    v_and_b32_dpp v36, v53, v4 row_shl:4 row_mask:0xf bank_mask:0xf bound_ctrl:1
    v_and_b32_dpp v37, v53, v5 row_shl:4 row_mask:0xf bank_mask:0xf bound_ctrl:1
    v_and_b32 v38, v53, v6
    v_and_b32 v39, v53, v7
    v_mfma_f32_16x16x32_bf16 v[16:19], a[40:43], v[32:35], v[16:19]
    v_and_b32 v24, v54, v4
    v_and_b32 v25, v54, v5
    v_and_b32_dpp v26, v54, v6 row_shr:4 row_mask:0xf bank_mask:0xf bound_ctrl:1
    v_and_b32_dpp v27, v54, v7 row_shr:4 row_mask:0xf bank_mask:0xf bound_ctrl:1
    v_mfma_f32_16x16x32_bf16 v[16:19], a[44:47], v[36:39], v[16:19]
    v_and_b32_dpp v28, v54, v4 row_shl:4 row_mask:0xf bank_mask:0xf bound_ctrl:1
    v_and_b32_dpp v29, v54, v5 row_shl:4 row_mask:0xf bank_mask:0xf bound_ctrl:1
    v_and_b32 v30, v54, v6
    v_and_b32 v31, v54, v7
    v_mfma_f32_16x16x32_bf16 v[16:19], a[48:51], v[24:27], v[16:19]
    v_and_b32 v32, v55, v4
    v_and_b32 v33, v55, v5
    v_and_b32_dpp v34, v55, v6 row_shr:4 row_mask:0xf bank_mask:0xf bound_ctrl:1
    v_and_b32_dpp v35, v55, v7 row_shr:4 row_mask:0xf bank_mask:0xf bound_ctrl:1
    v_mfma_f32_16x16x32_bf16 v[16:19], a[52:55], v[28:31], v[16:19]
    v_and_b32_dpp v36, v55, v4 row_shl:4 row_mask:0xf bank_mask:0xf bound_ctrl:1
    v_and_b32_dpp v37, v55, v5 row_shl:4 row_mask:0xf bank_mask:0xf bound_ctrl:1
    v_and_b32 v38, v55, v6
    v_and_b32 v39, v55, v7
    v_mfma_f32_16x16x32_bf16 v[16:19], a[56:59], v[32:35], v[16:19]
    s_nop 0
    v_mfma_f32_16x16x32_bf16 v[16:19], a[60:63], v[36:39], v[16:19]
    s_add_u32 s34, s57, 1048576
    s_xor_b32 s34, s34, 8192
    s_xor_b32 s35, s34, 4096
    s_waitcnt vmcnt(55)
    v_mfma_f32_16x16x32_bf16 v[24:27], a[64:67], v[8:11], 0
    v_mfma_f32_16x16x32_bf16 v[24:27], a[68:71], v[12:15], v[24:27]
    buffer_load_dwordx4 a[64:67], v3, s[8:11], s34 offen offset:0
    buffer_load_dwordx4 a[68:71], v3, s[8:11], s34 offen offset:1024
    v_mfma_f32_16x16x32_bf16 v[28:31], a[72:75], v[8:11], 0
    v_mfma_f32_16x16x32_bf16 v[28:31], a[76:79], v[12:15], v[28:31]
    buffer_load_dwordx4 a[72:75], v3, s[8:11], s34 offen offset:2048
    buffer_load_dwordx4 a[76:79], v3, s[8:11], s34 offen offset:3072
    v_mfma_f32_16x16x32_bf16 v[32:35], a[80:83], v[8:11], 0
    v_mfma_f32_16x16x32_bf16 v[32:35], a[84:87], v[12:15], v[32:35]
    buffer_load_dwordx4 a[80:83], v3, s[8:11], s35 offen offset:0
    buffer_load_dwordx4 a[84:87], v3, s[8:11], s35 offen offset:1024
    v_mfma_f32_16x16x32_bf16 v[36:39], a[88:91], v[8:11], 0
    v_mfma_f32_16x16x32_bf16 v[36:39], a[92:95], v[12:15], v[36:39]
    buffer_load_dwordx4 a[88:91], v3, s[8:11], s35 offen offset:2048
    buffer_load_dwordx4 a[92:95], v3, s[8:11], s35 offen offset:3072
    v_mov_b32_dpp v52, v24 quad_perm:[0,0,0,0] row_mask:0xf bank_mask:0xf
    v_mov_b32_dpp v53, v28 quad_perm:[0,0,0,0] row_mask:0xf bank_mask:0xf
    v_mov_b32_dpp v54, v32 quad_perm:[0,0,0,0] row_mask:0xf bank_mask:0xf
    v_add_f32_dpp v52, v25, v52 quad_perm:[1,1,1,1] row_mask:0xf bank_mask:0xf
    v_add_f32_dpp v53, v29, v53 quad_perm:[1,1,1,1] row_mask:0xf bank_mask:0xf
    v_add_f32_dpp v54, v33, v54 quad_perm:[1,1,1,1] row_mask:0xf bank_mask:0xf
    v_add_f32_dpp v52, v26, v52 quad_perm:[2,2,2,2] row_mask:0xf bank_mask:0xf
    v_add_f32_dpp v53, v30, v53 quad_perm:[2,2,2,2] row_mask:0xf bank_mask:0xf
    v_mov_b32_dpp v55, v36 quad_perm:[0,0,0,0] row_mask:0xf bank_mask:0xf
    v_add_f32_dpp v54, v34, v54 quad_perm:[2,2,2,2] row_mask:0xf bank_mask:0xf
    v_add_f32_dpp v52, v27, v52 quad_perm:[3,3,3,3] row_mask:0xf bank_mask:0xf
    v_add_f32_dpp v55, v37, v55 quad_perm:[1,1,1,1] row_mask:0xf bank_mask:0xf
    v_add_f32_dpp v53, v31, v53 quad_perm:[3,3,3,3] row_mask:0xf bank_mask:0xf
    v_add_f32_dpp v54, v35, v54 quad_perm:[3,3,3,3] row_mask:0xf bank_mask:0xf
    v_add_f32_dpp v55, v38, v55 quad_perm:[2,2,2,2] row_mask:0xf bank_mask:0xf
    s_nop 1
    v_add_f32_dpp v55, v39, v55 quad_perm:[3,3,3,3] row_mask:0xf bank_mask:0xf
    s_mov_b32 s101, 0
    s_mov_b32 s55, 119
    s_add_u32 s36, s36, 1
    s_branch LRINGGO
LRET4:
    v_max3_f32 v44, v52, v53, v20
    v_max3_f32 v44, v44, v54, v55
    s_nop 1
    v_max_f32_dpp v44, v44, v44 row_half_mirror row_mask:0xf bank_mask:0xf
    v_mov_b32 v45, v44
    s_nop 1
    v_permlane16_swap_b32 v44, v45
    v_max_f32 v44, v44, v45
    v_mov_b32 v45, v44
    s_nop 1
    v_permlane32_swap_b32 v44, v45
    v_max_f32 v44, v44, v45
    v_sub_f32 v45, v20, v44
    v_mul_f32 v45, s30, v45
    v_exp_f32 v45, v45
    v_mov_b32 v20, v44
    v_mul_f32 v22, s30, v44
    v_fma_f32 v52, v52, s30, -v22
    v_fma_f32 v53, v53, s30, -v22
    v_fma_f32 v54, v54, s30, -v22
    v_fma_f32 v55, v55, s30, -v22
    v_exp_f32 v52, v52
    v_exp_f32 v53, v53
    v_exp_f32 v54, v54
    v_exp_f32 v55, v55
    v_mul_f32 v21, v21, v45
    v_mul_f32 v16, v16, v45
    v_mul_f32 v17, v17, v45
    v_mul_f32 v18, v18, v45
    v_mul_f32 v19, v19, v45
    v_add_f32 v46, v52, v53
    v_add_f32 v47, v54, v55
    v_cvt_pk_bf16_f32 v52, v52, v52
    v_cvt_pk_bf16_f32 v53, v53, v53
    v_cvt_pk_bf16_f32 v54, v54, v54
    v_cvt_pk_bf16_f32 v55, v55, v55
    v_add_f32 v46, v46, v47
    v_add_f32 v21, v21, v46
    v_and_b32 v24, v52, v4
    v_and_b32 v25, v52, v5
    v_and_b32_dpp v26, v52, v6 row_shr:4 row_mask:0xf bank_mask:0xf bound_ctrl:1
    v_and_b32_dpp v27, v52, v7 row_shr:4 row_mask:0xf bank_mask:0xf bound_ctrl:1
    s_cmp_ge_u32 s101, 2
    s_nop 0
    s_cbranch_scc1 Lsw_5
    s_cmp_eq_u32 s101, 1
    s_cbranch_scc1 Lsw_6
    s_waitcnt vmcnt(0)
Lsw_6:
    s_waitcnt vmcnt(16)
Lsw_5:
    s_waitcnt vmcnt(32)
    v_and_b32_dpp v28, v52, v4 row_shl:4 row_mask:0xf bank_mask:0xf bound_ctrl:1
    v_and_b32_dpp v29, v52, v5 row_shl:4 row_mask:0xf bank_mask:0xf bound_ctrl:1
    v_and_b32 v30, v52, v6
    v_and_b32 v31, v52, v7
    v_mfma_f32_16x16x32_bf16 v[16:19], a[64:67], v[24:27], v[16:19]
    v_and_b32 v32, v53, v4
    v_and_b32 v33, v53, v5
    v_and_b32_dpp v34, v53, v6 row_shr:4 row_mask:0xf bank_mask:0xf bound_ctrl:1
    v_and_b32_dpp v35, v53, v7 row_shr:4 row_mask:0xf bank_mask:0xf bound_ctrl:1
    v_mfma_f32_16x16x32_bf16 v[16:19], a[68:71], v[28:31], v[16:19]
    v_and_b32_dpp v36, v53, v4 row_shl:4 row_mask:0xf bank_mask:0xf bound_ctrl:1
    v_and_b32_dpp v37, v53, v5 row_shl:4 row_mask:0xf bank_mask:0xf bound_ctrl:1
    v_and_b32 v38, v53, v6
    v_and_b32 v39, v53, v7
    v_mfma_f32_16x16x32_bf16 v[16:19], a[72:75], v[32:35], v[16:19]
    v_and_b32 v24, v54, v4
    v_and_b32 v25, v54, v5
    v_and_b32_dpp v26, v54, v6 row_shr:4 row_mask:0xf bank_mask:0xf bound_ctrl:1
    v_and_b32_dpp v27, v54, v7 row_shr:4 row_mask:0xf bank_mask:0xf bound_ctrl:1
    v_mfma_f32_16x16x32_bf16 v[16:19], a[76:79], v[36:39], v[16:19]
    v_and_b32_dpp v28, v54, v4 row_shl:4 row_mask:0xf bank_mask:0xf bound_ctrl:1
    v_and_b32_dpp v29, v54, v5 row_shl:4 row_mask:0xf bank_mask:0xf bound_ctrl:1
    v_and_b32 v30, v54, v6
    v_and_b32 v31, v54, v7
    v_mfma_f32_16x16x32_bf16 v[16:19], a[80:83], v[24:27], v[16:19]
    v_and_b32 v32, v55, v4
    v_and_b32 v33, v55, v5
    v_and_b32_dpp v34, v55, v6 row_shr:4 row_mask:0xf bank_mask:0xf bound_ctrl:1
    v_and_b32_dpp v35, v55, v7 row_shr:4 row_mask:0xf bank_mask:0xf bound_ctrl:1
    v_mfma_f32_16x16x32_bf16 v[16:19], a[84:87], v[28:31], v[16:19]
    v_and_b32_dpp v36, v55, v4 row_shl:4 row_mask:0xf bank_mask:0xf bound_ctrl:1
    v_and_b32_dpp v37, v55, v5 row_shl:4 row_mask:0xf bank_mask:0xf bound_ctrl:1
    v_and_b32 v38, v55, v6
    v_and_b32 v39, v55, v7
    v_mfma_f32_16x16x32_bf16 v[16:19], a[88:91], v[32:35], v[16:19]
    s_nop 0
    v_mfma_f32_16x16x32_bf16 v[16:19], a[92:95], v[36:39], v[16:19]
    s_add_u32 s34, s57, 1572864
    s_xor_b32 s34, s34, 8192
    s_xor_b32 s35, s34, 4096
    s_waitcnt vmcnt(55)
    v_mfma_f32_16x16x32_bf16 v[24:27], a[96:99], v[8:11], 0
    v_mfma_f32_16x16x32_bf16 v[24:27], a[100:103], v[12:15], v[24:27]
    buffer_load_dwordx4 a[96:99], v3, s[8:11], s34 offen offset:0
    buffer_load_dwordx4 a[100:103], v3, s[8:11], s34 offen offset:1024
    v_mfma_f32_16x16x32_bf16 v[28:31], a[104:107], v[8:11], 0
    v_mfma_f32_16x16x32_bf16 v[28:31], a[108:111], v[12:15], v[28:31]
    buffer_load_dwordx4 a[104:107], v3, s[8:11], s34 offen offset:2048
    buffer_load_dwordx4 a[108:111], v3, s[8:11], s34 offen offset:3072
    v_mfma_f32_16x16x32_bf16 v[32:35], a[112:115], v[8:11], 0
    v_mfma_f32_16x16x32_bf16 v[32:35], a[116:119], v[12:15], v[32:35]
    buffer_load_dwordx4 a[112:115], v3, s[8:11], s35 offen offset:0
    buffer_load_dwordx4 a[116:119], v3, s[8:11], s35 offen offset:1024
    v_mfma_f32_16x16x32_bf16 v[36:39], a[120:123], v[8:11], 0
    v_mfma_f32_16x16x32_bf16 v[36:39], a[124:127], v[12:15], v[36:39]
    buffer_load_dwordx4 a[120:123], v3, s[8:11], s35 offen offset:2048
    buffer_load_dwordx4 a[124:127], v3, s[8:11], s35 offen offset:3072
    v_mov_b32_dpp v52, v24 quad_perm:[0,0,0,0] row_mask:0xf bank_mask:0xf
    v_mov_b32_dpp v53, v28 quad_perm:[0,0,0,0] row_mask:0xf bank_mask:0xf
    v_mov_b32_dpp v54, v32 quad_perm:[0,0,0,0] row_mask:0xf bank_mask:0xf
    v_add_f32_dpp v52, v25, v52 quad_perm:[1,1,1,1] row_mask:0xf bank_mask:0xf
    v_add_f32_dpp v53, v29, v53 quad_perm:[1,1,1,1] row_mask:0xf bank_mask:0xf
    v_add_f32_dpp v54, v33, v54 quad_perm:[1,1,1,1] row_mask:0xf bank_mask:0xf
    v_add_f32_dpp v52, v26, v52 quad_perm:[2,2,2,2] row_mask:0xf bank_mask:0xf
    v_add_f32_dpp v53, v30, v53 quad_perm:[2,2,2,2] row_mask:0xf bank_mask:0xf
    v_mov_b32_dpp v55, v36 quad_perm:[0,0,0,0] row_mask:0xf bank_mask:0xf
    v_add_f32_dpp v54, v34, v54 quad_perm:[2,2,2,2] row_mask:0xf bank_mask:0xf
    v_add_f32_dpp v52, v27, v52 quad_perm:[3,3,3,3] row_mask:0xf bank_mask:0xf
    v_add_f32_dpp v55, v37, v55 quad_perm:[1,1,1,1] row_mask:0xf bank_mask:0xf
    v_add_f32_dpp v53, v31, v53 quad_perm:[3,3,3,3] row_mask:0xf bank_mask:0xf
    v_add_f32_dpp v54, v35, v54 quad_perm:[3,3,3,3] row_mask:0xf bank_mask:0xf
    v_add_f32_dpp v55, v38, v55 quad_perm:[2,2,2,2] row_mask:0xf bank_mask:0xf
    s_nop 1
    v_add_f32_dpp v55, v39, v55 quad_perm:[3,3,3,3] row_mask:0xf bank_mask:0xf
    s_mov_b32 s101, 0
    s_mov_b32 s55, 148
    s_add_u32 s36, s36, 1
    s_branch LRINGGO
LRET5:
    v_max3_f32 v44, v52, v53, v20
    v_max3_f32 v44, v44, v54, v55
    s_nop 1
    v_max_f32_dpp v44, v44, v44 row_half_mirror row_mask:0xf bank_mask:0xf
    v_mov_b32 v45, v44
    s_nop 1
    v_permlane16_swap_b32 v44, v45
    v_max_f32 v44, v44, v45
    v_mov_b32 v45, v44
    s_nop 1
    v_permlane32_swap_b32 v44, v45
    v_max_f32 v44, v44, v45
    v_sub_f32 v45, v20, v44
    v_mul_f32 v45, s30, v45
    v_exp_f32 v45, v45
    v_mov_b32 v20, v44
    v_mul_f32 v22, s30, v44
    v_fma_f32 v52, v52, s30, -v22
    v_fma_f32 v53, v53, s30, -v22
    v_fma_f32 v54, v54, s30, -v22
    v_fma_f32 v55, v55, s30, -v22
    v_exp_f32 v52, v52
    v_exp_f32 v53, v53
    v_exp_f32 v54, v54
    v_exp_f32 v55, v55
    v_mul_f32 v21, v21, v45
    v_mul_f32 v16, v16, v45
    v_mul_f32 v17, v17, v45
    v_mul_f32 v18, v18, v45
    v_mul_f32 v19, v19, v45
    v_add_f32 v46, v52, v53
    v_add_f32 v47, v54, v55
    v_cvt_pk_bf16_f32 v52, v52, v52
    v_cvt_pk_bf16_f32 v53, v53, v53
    v_cvt_pk_bf16_f32 v54, v54, v54
    v_cvt_pk_bf16_f32 v55, v55, v55
    v_add_f32 v46, v46, v47
    v_add_f32 v21, v21, v46
    v_and_b32 v24, v52, v4
    v_and_b32 v25, v52, v5
    v_and_b32_dpp v26, v52, v6 row_shr:4 row_mask:0xf bank_mask:0xf bound_ctrl:1
    v_and_b32_dpp v27, v52, v7 row_shr:4 row_mask:0xf bank_mask:0xf bound_ctrl:1
    s_cmp_ge_u32 s101, 2
    s_nop 0
    s_cbranch_scc1 Lsw_7
    s_cmp_eq_u32 s101, 1
    s_cbranch_scc1 Lsw_8
    s_waitcnt vmcnt(0)
Lsw_8:
    s_waitcnt vmcnt(16)
Lsw_7:
    s_waitcnt vmcnt(32)
    v_and_b32_dpp v28, v52, v4 row_shl:4 row_mask:0xf bank_mask:0xf bound_ctrl:1
    v_and_b32_dpp v29, v52, v5 row_shl:4 row_mask:0xf bank_mask:0xf bound_ctrl:1
    v_and_b32 v30, v52, v6
    v_and_b32 v31, v52, v7
    v_mfma_f32_16x16x32_bf16 v[16:19], a[96:99], v[24:27], v[16:19]
    v_and_b32 v32, v53, v4
    v_and_b32 v33, v53, v5
    v_and_b32_dpp v34, v53, v6 row_shr:4 row_mask:0xf bank_mask:0xf bound_ctrl:1
    v_and_b32_dpp v35, v53, v7 row_shr:4 row_mask:0xf bank_mask:0xf bound_ctrl:1
    v_mfma_f32_16x16x32_bf16 v[16:19], a[100:103], v[28:31], v[16:19]
    v_and_b32_dpp v36, v53, v4 row_shl:4 row_mask:0xf bank_mask:0xf bound_ctrl:1
    v_and_b32_dpp v37, v53, v5 row_shl:4 row_mask:0xf bank_mask:0xf bound_ctrl:1
    v_and_b32 v38, v53, v6
    v_and_b32 v39, v53, v7
    v_mfma_f32_16x16x32_bf16 v[16:19], a[104:107], v[32:35], v[16:19]
    v_and_b32 v24, v54, v4
    v_and_b32 v25, v54, v5
    v_and_b32_dpp v26, v54, v6 row_shr:4 row_mask:0xf bank_mask:0xf bound_ctrl:1
    v_and_b32_dpp v27, v54, v7 row_shr:4 row_mask:0xf bank_mask:0xf bound_ctrl:1
    v_mfma_f32_16x16x32_bf16 v[16:19], a[108:111], v[36:39], v[16:19]
    v_and_b32_dpp v28, v54, v4 row_shl:4 row_mask:0xf bank_mask:0xf bound_ctrl:1
    v_and_b32_dpp v29, v54, v5 row_shl:4 row_mask:0xf bank_mask:0xf bound_ctrl:1
    v_and_b32 v30, v54, v6
    v_and_b32 v31, v54, v7
    v_mfma_f32_16x16x32_bf16 v[16:19], a[112:115], v[24:27], v[16:19]
    v_and_b32 v32, v55, v4
    v_and_b32 v33, v55, v5
    v_and_b32_dpp v34, v55, v6 row_shr:4 row_mask:0xf bank_mask:0xf bound_ctrl:1
    v_and_b32_dpp v35, v55, v7 row_shr:4 row_mask:0xf bank_mask:0xf bound_ctrl:1
    v_mfma_f32_16x16x32_bf16 v[16:19], a[116:119], v[28:31], v[16:19]
    v_and_b32_dpp v36, v55, v4 row_shl:4 row_mask:0xf bank_mask:0xf bound_ctrl:1
    v_and_b32_dpp v37, v55, v5 row_shl:4 row_mask:0xf bank_mask:0xf bound_ctrl:1
    v_and_b32 v38, v55, v6
    v_and_b32 v39, v55, v7
    v_mfma_f32_16x16x32_bf16 v[16:19], a[120:123], v[32:35], v[16:19]
    s_nop 0
    v_mfma_f32_16x16x32_bf16 v[16:19], a[124:127], v[36:39], v[16:19]
    s_add_u32 s34, s57, 2097152
    s_xor_b32 s35, s34, 4096
    s_waitcnt vmcnt(55)
    v_mfma_f32_16x16x32_bf16 v[24:27], a[128:131], v[8:11], 0
    v_mfma_f32_16x16x32_bf16 v[24:27], a[132:135], v[12:15], v[24:27]
    buffer_load_dwordx4 a[128:131], v3, s[8:11], s34 offen offset:0
    buffer_load_dwordx4 a[132:135], v3, s[8:11], s34 offen offset:1024
    v_mfma_f32_16x16x32_bf16 v[28:31], a[136:139], v[8:11], 0
    v_mfma_f32_16x16x32_bf16 v[28:31], a[140:143], v[12:15], v[28:31]
    buffer_load_dwordx4 a[136:139], v3, s[8:11], s34 offen offset:2048
    buffer_load_dwordx4 a[140:143], v3, s[8:11], s34 offen offset:3072
    v_mfma_f32_16x16x32_bf16 v[32:35], a[144:147], v[8:11], 0
    v_mfma_f32_16x16x32_bf16 v[32:35], a[148:151], v[12:15], v[32:35]
    buffer_load_dwordx4 a[144:147], v3, s[8:11], s35 offen offset:0
    buffer_load_dwordx4 a[148:151], v3, s[8:11], s35 offen offset:1024
    v_mfma_f32_16x16x32_bf16 v[36:39], a[152:155], v[8:11], 0
    v_mfma_f32_16x16x32_bf16 v[36:39], a[156:159], v[12:15], v[36:39]
    buffer_load_dwordx4 a[152:155], v3, s[8:11], s35 offen offset:2048
    buffer_load_dwordx4 a[156:159], v3, s[8:11], s35 offen offset:3072
    v_mov_b32_dpp v52, v24 quad_perm:[0,0,0,0] row_mask:0xf bank_mask:0xf
    v_mov_b32_dpp v53, v28 quad_perm:[0,0,0,0] row_mask:0xf bank_mask:0xf
    v_mov_b32_dpp v54, v32 quad_perm:[0,0,0,0] row_mask:0xf bank_mask:0xf
    v_add_f32_dpp v52, v25, v52 quad_perm:[1,1,1,1] row_mask:0xf bank_mask:0xf
    v_add_f32_dpp v53, v29, v53 quad_perm:[1,1,1,1] row_mask:0xf bank_mask:0xf
    v_add_f32_dpp v54, v33, v54 quad_perm:[1,1,1,1] row_mask:0xf bank_mask:0xf
    v_add_f32_dpp v52, v26, v52 quad_perm:[2,2,2,2] row_mask:0xf bank_mask:0xf
    v_add_f32_dpp v53, v30, v53 quad_perm:[2,2,2,2] row_mask:0xf bank_mask:0xf
    v_mov_b32_dpp v55, v36 quad_perm:[0,0,0,0] row_mask:0xf bank_mask:0xf
    v_add_f32_dpp v54, v34, v54 quad_perm:[2,2,2,2] row_mask:0xf bank_mask:0xf
    v_add_f32_dpp v52, v27, v52 quad_perm:[3,3,3,3] row_mask:0xf bank_mask:0xf
    v_add_f32_dpp v55, v37, v55 quad_perm:[1,1,1,1] row_mask:0xf bank_mask:0xf
    v_add_f32_dpp v53, v31, v53 quad_perm:[3,3,3,3] row_mask:0xf bank_mask:0xf
    v_add_f32_dpp v54, v35, v54 quad_perm:[3,3,3,3] row_mask:0xf bank_mask:0xf
    v_add_f32_dpp v55, v38, v55 quad_perm:[2,2,2,2] row_mask:0xf bank_mask:0xf
    s_nop 1
    v_add_f32_dpp v55, v39, v55 quad_perm:[3,3,3,3] row_mask:0xf bank_mask:0xf
    s_mov_b32 s101, 0
    s_mov_b32 s55, 177
    s_add_u32 s36, s36, 1
    s_branch LRINGGO
LRET6:
    v_max3_f32 v44, v52, v53, v20
    v_max3_f32 v44, v44, v54, v55
    s_nop 1
    v_max_f32_dpp v44, v44, v44 row_half_mirror row_mask:0xf bank_mask:0xf
    v_mov_b32 v45, v44
    s_nop 1
    v_permlane16_swap_b32 v44, v45
    v_max_f32 v44, v44, v45
    v_mov_b32 v45, v44
    s_nop 1
    v_permlane32_swap_b32 v44, v45
    v_max_f32 v44, v44, v45
    v_sub_f32 v45, v20, v44
    v_mul_f32 v45, s30, v45
    v_exp_f32 v45, v45
    v_mov_b32 v20, v44
    v_mul_f32 v22, s30, v44
    v_fma_f32 v52, v52, s30, -v22
    v_fma_f32 v53, v53, s30, -v22
    v_fma_f32 v54, v54, s30, -v22
    v_fma_f32 v55, v55, s30, -v22
    v_exp_f32 v52, v52
    v_exp_f32 v53, v53
    v_exp_f32 v54, v54
    v_exp_f32 v55, v55
    v_mul_f32 v21, v21, v45
    v_mul_f32 v16, v16, v45
    v_mul_f32 v17, v17, v45
    v_mul_f32 v18, v18, v45
    v_mul_f32 v19, v19, v45
    v_add_f32 v46, v52, v53
    v_add_f32 v47, v54, v55
    v_cvt_pk_bf16_f32 v52, v52, v52
    v_cvt_pk_bf16_f32 v53, v53, v53
    v_cvt_pk_bf16_f32 v54, v54, v54
    v_cvt_pk_bf16_f32 v55, v55, v55
    v_add_f32 v46, v46, v47
    v_add_f32 v21, v21, v46
    v_and_b32 v24, v52, v4
    v_and_b32 v25, v52, v5
    v_and_b32_dpp v26, v52, v6 row_shr:4 row_mask:0xf bank_mask:0xf bound_ctrl:1
    v_and_b32_dpp v27, v52, v7 row_shr:4 row_mask:0xf bank_mask:0xf bound_ctrl:1
    s_cmp_ge_u32 s101, 2
    s_nop 0
    s_cbranch_scc1 Lsw_9
    s_cmp_eq_u32 s101, 1
    s_cbranch_scc1 Lsw_10
    s_waitcnt vmcnt(0)
Lsw_10:
    s_waitcnt vmcnt(16)
Lsw_9:
    s_waitcnt vmcnt(32)
    v_and_b32_dpp v28, v52, v4 row_shl:4 row_mask:0xf bank_mask:0xf bound_ctrl:1
    v_and_b32_dpp v29, v52, v5 row_shl:4 row_mask:0xf bank_mask:0xf bound_ctrl:1
    v_and_b32 v30, v52, v6
    v_and_b32 v31, v52, v7
    v_mfma_f32_16x16x32_bf16 v[16:19], a[128:131], v[24:27], v[16:19]
    v_and_b32 v32, v53, v4
    v_and_b32 v33, v53, v5
    v_and_b32_dpp v34, v53, v6 row_shr:4 row_mask:0xf bank_mask:0xf bound_ctrl:1
    v_and_b32_dpp v35, v53, v7 row_shr:4 row_mask:0xf bank_mask:0xf bound_ctrl:1
    v_mfma_f32_16x16x32_bf16 v[16:19], a[132:135], v[28:31], v[16:19]
    v_and_b32_dpp v36, v53, v4 row_shl:4 row_mask:0xf bank_mask:0xf bound_ctrl:1
    v_and_b32_dpp v37, v53, v5 row_shl:4 row_mask:0xf bank_mask:0xf bound_ctrl:1
    v_and_b32 v38, v53, v6
    v_and_b32 v39, v53, v7
    v_mfma_f32_16x16x32_bf16 v[16:19], a[136:139], v[32:35], v[16:19]
    v_and_b32 v24, v54, v4
    v_and_b32 v25, v54, v5
    v_and_b32_dpp v26, v54, v6 row_shr:4 row_mask:0xf bank_mask:0xf bound_ctrl:1
    v_and_b32_dpp v27, v54, v7 row_shr:4 row_mask:0xf bank_mask:0xf bound_ctrl:1
    v_mfma_f32_16x16x32_bf16 v[16:19], a[140:143], v[36:39], v[16:19]
    v_and_b32_dpp v28, v54, v4 row_shl:4 row_mask:0xf bank_mask:0xf bound_ctrl:1
    v_and_b32_dpp v29, v54, v5 row_shl:4 row_mask:0xf bank_mask:0xf bound_ctrl:1
    v_and_b32 v30, v54, v6
    v_and_b32 v31, v54, v7
    v_mfma_f32_16x16x32_bf16 v[16:19], a[144:147], v[24:27], v[16:19]
    v_and_b32 v32, v55, v4
    v_and_b32 v33, v55, v5
    v_and_b32_dpp v34, v55, v6 row_shr:4 row_mask:0xf bank_mask:0xf bound_ctrl:1
    v_and_b32_dpp v35, v55, v7 row_shr:4 row_mask:0xf bank_mask:0xf bound_ctrl:1
    v_mfma_f32_16x16x32_bf16 v[16:19], a[148:151], v[28:31], v[16:19]
    v_and_b32_dpp v36, v55, v4 row_shl:4 row_mask:0xf bank_mask:0xf bound_ctrl:1
    v_and_b32_dpp v37, v55, v5 row_shl:4 row_mask:0xf bank_mask:0xf bound_ctrl:1
    v_and_b32 v38, v55, v6
    v_and_b32 v39, v55, v7
    v_mfma_f32_16x16x32_bf16 v[16:19], a[152:155], v[32:35], v[16:19]
    s_nop 0
    v_mfma_f32_16x16x32_bf16 v[16:19], a[156:159], v[36:39], v[16:19]
    s_add_u32 s34, s57, 2621440
    s_xor_b32 s35, s34, 4096
    s_waitcnt vmcnt(55)
    v_mfma_f32_16x16x32_bf16 v[24:27], a[160:163], v[8:11], 0
    v_mfma_f32_16x16x32_bf16 v[24:27], a[164:167], v[12:15], v[24:27]
    buffer_load_dwordx4 a[160:163], v3, s[8:11], s34 offen offset:0
    buffer_load_dwordx4 a[164:167], v3, s[8:11], s34 offen offset:1024
    v_mfma_f32_16x16x32_bf16 v[28:31], a[168:171], v[8:11], 0
    v_mfma_f32_16x16x32_bf16 v[28:31], a[172:175], v[12:15], v[28:31]
    buffer_load_dwordx4 a[168:171], v3, s[8:11], s34 offen offset:2048
    buffer_load_dwordx4 a[172:175], v3, s[8:11], s34 offen offset:3072
    v_mfma_f32_16x16x32_bf16 v[32:35], a[176:179], v[8:11], 0
    v_mfma_f32_16x16x32_bf16 v[32:35], a[180:183], v[12:15], v[32:35]
    buffer_load_dwordx4 a[176:179], v3, s[8:11], s35 offen offset:0
    buffer_load_dwordx4 a[180:183], v3, s[8:11], s35 offen offset:1024
    v_mfma_f32_16x16x32_bf16 v[36:39], a[184:187], v[8:11], 0
    v_mfma_f32_16x16x32_bf16 v[36:39], a[188:191], v[12:15], v[36:39]
    buffer_load_dwordx4 a[184:187], v3, s[8:11], s35 offen offset:2048
    buffer_load_dwordx4 a[188:191], v3, s[8:11], s35 offen offset:3072
    v_mov_b32_dpp v52, v24 quad_perm:[0,0,0,0] row_mask:0xf bank_mask:0xf
    v_mov_b32_dpp v53, v28 quad_perm:[0,0,0,0] row_mask:0xf bank_mask:0xf
    v_mov_b32_dpp v54, v32 quad_perm:[0,0,0,0] row_mask:0xf bank_mask:0xf
    v_add_f32_dpp v52, v25, v52 quad_perm:[1,1,1,1] row_mask:0xf bank_mask:0xf
    v_add_f32_dpp v53, v29, v53 quad_perm:[1,1,1,1] row_mask:0xf bank_mask:0xf
    v_add_f32_dpp v54, v33, v54 quad_perm:[1,1,1,1] row_mask:0xf bank_mask:0xf
    v_add_f32_dpp v52, v26, v52 quad_perm:[2,2,2,2] row_mask:0xf bank_mask:0xf
    v_add_f32_dpp v53, v30, v53 quad_perm:[2,2,2,2] row_mask:0xf bank_mask:0xf
    v_mov_b32_dpp v55, v36 quad_perm:[0,0,0,0] row_mask:0xf bank_mask:0xf
    v_add_f32_dpp v54, v34, v54 quad_perm:[2,2,2,2] row_mask:0xf bank_mask:0xf
    v_add_f32_dpp v52, v27, v52 quad_perm:[3,3,3,3] row_mask:0xf bank_mask:0xf
    v_add_f32_dpp v55, v37, v55 quad_perm:[1,1,1,1] row_mask:0xf bank_mask:0xf
    v_add_f32_dpp v53, v31, v53 quad_perm:[3,3,3,3] row_mask:0xf bank_mask:0xf
    v_add_f32_dpp v54, v35, v54 quad_perm:[3,3,3,3] row_mask:0xf bank_mask:0xf
    v_add_f32_dpp v55, v38, v55 quad_perm:[2,2,2,2] row_mask:0xf bank_mask:0xf
    s_nop 1
    v_add_f32_dpp v55, v39, v55 quad_perm:[3,3,3,3] row_mask:0xf bank_mask:0xf
    s_mov_b32 s101, 0
    s_mov_b32 s55, 206
    s_add_u32 s36, s36, 1
    s_branch LRINGGO
LRET7:
    v_max3_f32 v44, v52, v53, v20
    v_max3_f32 v44, v44, v54, v55
    s_nop 1
    v_max_f32_dpp v44, v44, v44 row_half_mirror row_mask:0xf bank_mask:0xf
    v_mov_b32 v45, v44
    s_nop 1
    v_permlane16_swap_b32 v44, v45
    v_max_f32 v44, v44, v45
    v_mov_b32 v45, v44
    s_nop 1
    v_permlane32_swap_b32 v44, v45
    v_max_f32 v44, v44, v45
    v_sub_f32 v45, v20, v44
    v_mul_f32 v45, s30, v45
    v_exp_f32 v45, v45
    v_mov_b32 v20, v44
    v_mul_f32 v22, s30, v44
    v_fma_f32 v52, v52, s30, -v22
    v_fma_f32 v53, v53, s30, -v22
    v_fma_f32 v54, v54, s30, -v22
    v_fma_f32 v55, v55, s30, -v22
    v_exp_f32 v52, v52
    v_exp_f32 v53, v53
    v_exp_f32 v54, v54
    v_exp_f32 v55, v55
    v_mul_f32 v21, v21, v45
    v_mul_f32 v16, v16, v45
    v_mul_f32 v17, v17, v45
    v_mul_f32 v18, v18, v45
    v_mul_f32 v19, v19, v45
    v_add_f32 v46, v52, v53
    v_add_f32 v47, v54, v55
    v_cvt_pk_bf16_f32 v52, v52, v52
    v_cvt_pk_bf16_f32 v53, v53, v53
    v_cvt_pk_bf16_f32 v54, v54, v54
    v_cvt_pk_bf16_f32 v55, v55, v55
    v_add_f32 v46, v46, v47
    v_add_f32 v21, v21, v46
    v_and_b32 v24, v52, v4
    v_and_b32 v25, v52, v5
    v_and_b32_dpp v26, v52, v6 row_shr:4 row_mask:0xf bank_mask:0xf bound_ctrl:1
    v_and_b32_dpp v27, v52, v7 row_shr:4 row_mask:0xf bank_mask:0xf bound_ctrl:1
    s_cmp_ge_u32 s101, 2
    s_nop 0
    s_cbranch_scc1 Lsw_11
    s_cmp_eq_u32 s101, 1
    s_cbranch_scc1 Lsw_12
    s_waitcnt vmcnt(0)
Lsw_12:
    s_waitcnt vmcnt(16)
Lsw_11:
    s_waitcnt vmcnt(32)
    v_and_b32_dpp v28, v52, v4 row_shl:4 row_mask:0xf bank_mask:0xf bound_ctrl:1
    v_and_b32_dpp v29, v52, v5 row_shl:4 row_mask:0xf bank_mask:0xf bound_ctrl:1
    v_and_b32 v30, v52, v6
    v_and_b32 v31, v52, v7
    v_mfma_f32_16x16x32_bf16 v[16:19], a[160:163], v[24:27], v[16:19]
    v_and_b32 v32, v53, v4
    v_and_b32 v33, v53, v5
    v_and_b32_dpp v34, v53, v6 row_shr:4 row_mask:0xf bank_mask:0xf bound_ctrl:1
    v_and_b32_dpp v35, v53, v7 row_shr:4 row_mask:0xf bank_mask:0xf bound_ctrl:1
    v_mfma_f32_16x16x32_bf16 v[16:19], a[164:167], v[28:31], v[16:19]
    v_and_b32_dpp v36, v53, v4 row_shl:4 row_mask:0xf bank_mask:0xf bound_ctrl:1
    v_and_b32_dpp v37, v53, v5 row_shl:4 row_mask:0xf bank_mask:0xf bound_ctrl:1
    v_and_b32 v38, v53, v6
    v_and_b32 v39, v53, v7
    v_mfma_f32_16x16x32_bf16 v[16:19], a[168:171], v[32:35], v[16:19]
    v_and_b32 v24, v54, v4
    v_and_b32 v25, v54, v5
    v_and_b32_dpp v26, v54, v6 row_shr:4 row_mask:0xf bank_mask:0xf bound_ctrl:1
    v_and_b32_dpp v27, v54, v7 row_shr:4 row_mask:0xf bank_mask:0xf bound_ctrl:1
    v_mfma_f32_16x16x32_bf16 v[16:19], a[172:175], v[36:39], v[16:19]
    v_and_b32_dpp v28, v54, v4 row_shl:4 row_mask:0xf bank_mask:0xf bound_ctrl:1
    v_and_b32_dpp v29, v54, v5 row_shl:4 row_mask:0xf bank_mask:0xf bound_ctrl:1
    v_and_b32 v30, v54, v6
    v_and_b32 v31, v54, v7
    v_mfma_f32_16x16x32_bf16 v[16:19], a[176:179], v[24:27], v[16:19]
    v_and_b32 v32, v55, v4
    v_and_b32 v33, v55, v5
    v_and_b32_dpp v34, v55, v6 row_shr:4 row_mask:0xf bank_mask:0xf bound_ctrl:1
    v_and_b32_dpp v35, v55, v7 row_shr:4 row_mask:0xf bank_mask:0xf bound_ctrl:1
    v_mfma_f32_16x16x32_bf16 v[16:19], a[180:183], v[28:31], v[16:19]
    v_and_b32_dpp v36, v55, v4 row_shl:4 row_mask:0xf bank_mask:0xf bound_ctrl:1
    v_and_b32_dpp v37, v55, v5 row_shl:4 row_mask:0xf bank_mask:0xf bound_ctrl:1
    v_and_b32 v38, v55, v6
    v_and_b32 v39, v55, v7
    v_mfma_f32_16x16x32_bf16 v[16:19], a[184:187], v[32:35], v[16:19]
    s_nop 0
    v_mfma_f32_16x16x32_bf16 v[16:19], a[188:191], v[36:39], v[16:19]
    s_add_u32 s34, s57, 3145728
    s_xor_b32 s35, s34, 4096
    s_waitcnt vmcnt(55)
    v_mfma_f32_16x16x32_bf16 v[24:27], a[192:195], v[8:11], 0
    v_mfma_f32_16x16x32_bf16 v[24:27], a[196:199], v[12:15], v[24:27]
    buffer_load_dwordx4 a[192:195], v3, s[8:11], s34 offen offset:0
    buffer_load_dwordx4 a[196:199], v3, s[8:11], s34 offen offset:1024
    v_mfma_f32_16x16x32_bf16 v[28:31], a[200:203], v[8:11], 0
    v_mfma_f32_16x16x32_bf16 v[28:31], a[204:207], v[12:15], v[28:31]
    buffer_load_dwordx4 a[200:203], v3, s[8:11], s34 offen offset:2048
    buffer_load_dwordx4 a[204:207], v3, s[8:11], s34 offen offset:3072
    v_mfma_f32_16x16x32_bf16 v[32:35], a[208:211], v[8:11], 0
    v_mfma_f32_16x16x32_bf16 v[32:35], a[212:215], v[12:15], v[32:35]
    buffer_load_dwordx4 a[208:211], v3, s[8:11], s35 offen offset:0
    buffer_load_dwordx4 a[212:215], v3, s[8:11], s35 offen offset:1024
    v_mfma_f32_16x16x32_bf16 v[36:39], a[216:219], v[8:11], 0
    v_mfma_f32_16x16x32_bf16 v[36:39], a[220:223], v[12:15], v[36:39]
    buffer_load_dwordx4 a[216:219], v3, s[8:11], s35 offen offset:2048
    buffer_load_dwordx4 a[220:223], v3, s[8:11], s35 offen offset:3072
    v_mov_b32_dpp v52, v24 quad_perm:[0,0,0,0] row_mask:0xf bank_mask:0xf
    v_mov_b32_dpp v53, v28 quad_perm:[0,0,0,0] row_mask:0xf bank_mask:0xf
    v_mov_b32_dpp v54, v32 quad_perm:[0,0,0,0] row_mask:0xf bank_mask:0xf
    v_add_f32_dpp v52, v25, v52 quad_perm:[1,1,1,1] row_mask:0xf bank_mask:0xf
    v_add_f32_dpp v53, v29, v53 quad_perm:[1,1,1,1] row_mask:0xf bank_mask:0xf
    v_add_f32_dpp v54, v33, v54 quad_perm:[1,1,1,1] row_mask:0xf bank_mask:0xf
    v_add_f32_dpp v52, v26, v52 quad_perm:[2,2,2,2] row_mask:0xf bank_mask:0xf
    v_add_f32_dpp v53, v30, v53 quad_perm:[2,2,2,2] row_mask:0xf bank_mask:0xf
    v_mov_b32_dpp v55, v36 quad_perm:[0,0,0,0] row_mask:0xf bank_mask:0xf
    v_add_f32_dpp v54, v34, v54 quad_perm:[2,2,2,2] row_mask:0xf bank_mask:0xf
    v_add_f32_dpp v52, v27, v52 quad_perm:[3,3,3,3] row_mask:0xf bank_mask:0xf
    v_add_f32_dpp v55, v37, v55 quad_perm:[1,1,1,1] row_mask:0xf bank_mask:0xf
    v_add_f32_dpp v53, v31, v53 quad_perm:[3,3,3,3] row_mask:0xf bank_mask:0xf
    v_add_f32_dpp v54, v35, v54 quad_perm:[3,3,3,3] row_mask:0xf bank_mask:0xf
    v_add_f32_dpp v55, v38, v55 quad_perm:[2,2,2,2] row_mask:0xf bank_mask:0xf
    s_nop 1
    v_add_f32_dpp v55, v39, v55 quad_perm:[3,3,3,3] row_mask:0xf bank_mask:0xf
    s_mov_b32 s101, 0
    s_mov_b32 s55, 235
    s_add_u32 s36, s36, 1
    s_branch LRINGGO
LRET8:
    v_max3_f32 v44, v52, v53, v20
    v_max3_f32 v44, v44, v54, v55
    s_nop 1
    v_max_f32_dpp v44, v44, v44 row_half_mirror row_mask:0xf bank_mask:0xf
    v_mov_b32 v45, v44
    s_nop 1
    v_permlane16_swap_b32 v44, v45
    v_max_f32 v44, v44, v45
    v_mov_b32 v45, v44
    s_nop 1
    v_permlane32_swap_b32 v44, v45
    v_max_f32 v44, v44, v45
    v_sub_f32 v45, v20, v44
    v_mul_f32 v45, s30, v45
    v_exp_f32 v45, v45
    v_mov_b32 v20, v44
    v_mul_f32 v22, s30, v44
    v_fma_f32 v52, v52, s30, -v22
    v_fma_f32 v53, v53, s30, -v22
    v_fma_f32 v54, v54, s30, -v22
    v_fma_f32 v55, v55, s30, -v22
    v_exp_f32 v52, v52
    v_exp_f32 v53, v53
    v_exp_f32 v54, v54
    v_exp_f32 v55, v55
    v_mul_f32 v21, v21, v45
    v_mul_f32 v16, v16, v45
    v_mul_f32 v17, v17, v45
    v_mul_f32 v18, v18, v45
    v_mul_f32 v19, v19, v45
    v_add_f32 v46, v52, v53
    v_add_f32 v47, v54, v55
    v_cvt_pk_bf16_f32 v52, v52, v52
    v_cvt_pk_bf16_f32 v53, v53, v53
    v_cvt_pk_bf16_f32 v54, v54, v54
    v_cvt_pk_bf16_f32 v55, v55, v55
    v_add_f32 v46, v46, v47
    v_add_f32 v21, v21, v46
    v_and_b32 v24, v52, v4
    v_and_b32 v25, v52, v5
    v_and_b32_dpp v26, v52, v6 row_shr:4 row_mask:0xf bank_mask:0xf bound_ctrl:1
    v_and_b32_dpp v27, v52, v7 row_shr:4 row_mask:0xf bank_mask:0xf bound_ctrl:1
    s_cmp_ge_u32 s101, 2
    s_nop 0
    s_cbranch_scc1 Lsw_13
    s_cmp_eq_u32 s101, 1
    s_cbranch_scc1 Lsw_14
    s_waitcnt vmcnt(0)
Lsw_14:
    s_waitcnt vmcnt(16)
Lsw_13:
    s_waitcnt vmcnt(32)
    v_and_b32_dpp v28, v52, v4 row_shl:4 row_mask:0xf bank_mask:0xf bound_ctrl:1
    v_and_b32_dpp v29, v52, v5 row_shl:4 row_mask:0xf bank_mask:0xf bound_ctrl:1
    v_and_b32 v30, v52, v6
    v_and_b32 v31, v52, v7
    v_mfma_f32_16x16x32_bf16 v[16:19], a[192:195], v[24:27], v[16:19]
    v_and_b32 v32, v53, v4
    v_and_b32 v33, v53, v5
    v_and_b32_dpp v34, v53, v6 row_shr:4 row_mask:0xf bank_mask:0xf bound_ctrl:1
    v_and_b32_dpp v35, v53, v7 row_shr:4 row_mask:0xf bank_mask:0xf bound_ctrl:1
    v_mfma_f32_16x16x32_bf16 v[16:19], a[196:199], v[28:31], v[16:19]
    v_and_b32_dpp v36, v53, v4 row_shl:4 row_mask:0xf bank_mask:0xf bound_ctrl:1
    v_and_b32_dpp v37, v53, v5 row_shl:4 row_mask:0xf bank_mask:0xf bound_ctrl:1
    v_and_b32 v38, v53, v6
    v_and_b32 v39, v53, v7
    v_mfma_f32_16x16x32_bf16 v[16:19], a[200:203], v[32:35], v[16:19]
    v_and_b32 v24, v54, v4
    v_and_b32 v25, v54, v5
    v_and_b32_dpp v26, v54, v6 row_shr:4 row_mask:0xf bank_mask:0xf bound_ctrl:1
    v_and_b32_dpp v27, v54, v7 row_shr:4 row_mask:0xf bank_mask:0xf bound_ctrl:1
    v_mfma_f32_16x16x32_bf16 v[16:19], a[204:207], v[36:39], v[16:19]
    v_and_b32_dpp v28, v54, v4 row_shl:4 row_mask:0xf bank_mask:0xf bound_ctrl:1
    v_and_b32_dpp v29, v54, v5 row_shl:4 row_mask:0xf bank_mask:0xf bound_ctrl:1
    v_and_b32 v30, v54, v6
    v_and_b32 v31, v54, v7
    v_mfma_f32_16x16x32_bf16 v[16:19], a[208:211], v[24:27], v[16:19]
    v_and_b32 v32, v55, v4
    v_and_b32 v33, v55, v5
    v_and_b32_dpp v34, v55, v6 row_shr:4 row_mask:0xf bank_mask:0xf bound_ctrl:1
    v_and_b32_dpp v35, v55, v7 row_shr:4 row_mask:0xf bank_mask:0xf bound_ctrl:1
    v_mfma_f32_16x16x32_bf16 v[16:19], a[212:215], v[28:31], v[16:19]
    v_and_b32_dpp v36, v55, v4 row_shl:4 row_mask:0xf bank_mask:0xf bound_ctrl:1
    v_and_b32_dpp v37, v55, v5 row_shl:4 row_mask:0xf bank_mask:0xf bound_ctrl:1
    v_and_b32 v38, v55, v6
    v_and_b32 v39, v55, v7
    v_mfma_f32_16x16x32_bf16 v[16:19], a[216:219], v[32:35], v[16:19]
    s_nop 0
    v_mfma_f32_16x16x32_bf16 v[16:19], a[220:223], v[36:39], v[16:19]
    s_add_u32 s34, s57, 3670016
    s_xor_b32 s35, s34, 4096
    s_waitcnt vmcnt(55)
    v_mfma_f32_16x16x32_bf16 v[24:27], a[224:227], v[8:11], 0
    v_mfma_f32_16x16x32_bf16 v[24:27], a[228:231], v[12:15], v[24:27]
    buffer_load_dwordx4 a[224:227], v3, s[8:11], s34 offen offset:0
    buffer_load_dwordx4 a[228:231], v3, s[8:11], s34 offen offset:1024
    v_mfma_f32_16x16x32_bf16 v[28:31], a[232:235], v[8:11], 0
    v_mfma_f32_16x16x32_bf16 v[28:31], a[236:239], v[12:15], v[28:31]
    buffer_load_dwordx4 a[232:235], v3, s[8:11], s34 offen offset:2048
    buffer_load_dwordx4 a[236:239], v3, s[8:11], s34 offen offset:3072
    v_mfma_f32_16x16x32_bf16 v[32:35], a[240:243], v[8:11], 0
    v_mfma_f32_16x16x32_bf16 v[32:35], a[244:247], v[12:15], v[32:35]
    buffer_load_dwordx4 a[240:243], v3, s[8:11], s35 offen offset:0
    buffer_load_dwordx4 a[244:247], v3, s[8:11], s35 offen offset:1024
    v_mfma_f32_16x16x32_bf16 v[36:39], a[248:251], v[8:11], 0
    v_mfma_f32_16x16x32_bf16 v[36:39], a[252:255], v[12:15], v[36:39]
    buffer_load_dwordx4 a[248:251], v3, s[8:11], s35 offen offset:2048
    buffer_load_dwordx4 a[252:255], v3, s[8:11], s35 offen offset:3072
    v_mov_b32_dpp v52, v24 quad_perm:[0,0,0,0] row_mask:0xf bank_mask:0xf
    v_mov_b32_dpp v53, v28 quad_perm:[0,0,0,0] row_mask:0xf bank_mask:0xf
    v_mov_b32_dpp v54, v32 quad_perm:[0,0,0,0] row_mask:0xf bank_mask:0xf
    v_add_f32_dpp v52, v25, v52 quad_perm:[1,1,1,1] row_mask:0xf bank_mask:0xf
    v_add_f32_dpp v53, v29, v53 quad_perm:[1,1,1,1] row_mask:0xf bank_mask:0xf
    v_add_f32_dpp v54, v33, v54 quad_perm:[1,1,1,1] row_mask:0xf bank_mask:0xf
    v_add_f32_dpp v52, v26, v52 quad_perm:[2,2,2,2] row_mask:0xf bank_mask:0xf
    v_add_f32_dpp v53, v30, v53 quad_perm:[2,2,2,2] row_mask:0xf bank_mask:0xf
    v_mov_b32_dpp v55, v36 quad_perm:[0,0,0,0] row_mask:0xf bank_mask:0xf
    v_add_f32_dpp v54, v34, v54 quad_perm:[2,2,2,2] row_mask:0xf bank_mask:0xf
    v_add_f32_dpp v52, v27, v52 quad_perm:[3,3,3,3] row_mask:0xf bank_mask:0xf
    v_add_f32_dpp v55, v37, v55 quad_perm:[1,1,1,1] row_mask:0xf bank_mask:0xf
    v_add_f32_dpp v53, v31, v53 quad_perm:[3,3,3,3] row_mask:0xf bank_mask:0xf
    v_add_f32_dpp v54, v35, v54 quad_perm:[3,3,3,3] row_mask:0xf bank_mask:0xf
    v_add_f32_dpp v55, v38, v55 quad_perm:[2,2,2,2] row_mask:0xf bank_mask:0xf
    s_nop 1
    v_add_f32_dpp v55, v39, v55 quad_perm:[3,3,3,3] row_mask:0xf bank_mask:0xf
    s_mov_b32 s101, 0
    s_mov_b32 s55, 264
    s_add_u32 s36, s36, 1
    s_branch LRINGGO
LRET9:
    v_max3_f32 v44, v52, v53, v20
    v_max3_f32 v44, v44, v54, v55
    s_nop 1
    v_max_f32_dpp v44, v44, v44 row_half_mirror row_mask:0xf bank_mask:0xf
    v_mov_b32 v45, v44
    s_nop 1
    v_permlane16_swap_b32 v44, v45
    v_max_f32 v44, v44, v45
    v_mov_b32 v45, v44
    s_nop 1
    v_permlane32_swap_b32 v44, v45
    v_max_f32 v44, v44, v45
    v_sub_f32 v45, v20, v44
    v_mul_f32 v45, s30, v45
    v_exp_f32 v45, v45
    v_mov_b32 v20, v44
    v_mul_f32 v22, s30, v44
    v_fma_f32 v52, v52, s30, -v22
    v_fma_f32 v53, v53, s30, -v22
    v_fma_f32 v54, v54, s30, -v22
    v_fma_f32 v55, v55, s30, -v22
    v_exp_f32 v52, v52
    v_exp_f32 v53, v53
    v_exp_f32 v54, v54
    v_exp_f32 v55, v55
    v_mul_f32 v21, v21, v45
    v_mul_f32 v16, v16, v45
    v_mul_f32 v17, v17, v45
    v_mul_f32 v18, v18, v45
    v_mul_f32 v19, v19, v45
    v_add_f32 v46, v52, v53
    v_add_f32 v47, v54, v55
    v_cvt_pk_bf16_f32 v52, v52, v52
    v_cvt_pk_bf16_f32 v53, v53, v53
    v_cvt_pk_bf16_f32 v54, v54, v54
    v_cvt_pk_bf16_f32 v55, v55, v55
    v_add_f32 v46, v46, v47
    v_add_f32 v21, v21, v46
    v_and_b32 v24, v52, v4
    v_and_b32 v25, v52, v5
    v_and_b32_dpp v26, v52, v6 row_shr:4 row_mask:0xf bank_mask:0xf bound_ctrl:1
    v_and_b32_dpp v27, v52, v7 row_shr:4 row_mask:0xf bank_mask:0xf bound_ctrl:1
    s_cmp_ge_u32 s101, 2
    s_nop 0
    s_cbranch_scc1 Lsw_15
    s_cmp_eq_u32 s101, 1
    s_cbranch_scc1 Lsw_16
    s_waitcnt vmcnt(0)
Lsw_16:
    s_waitcnt vmcnt(16)
Lsw_15:
    s_waitcnt vmcnt(32)
    v_and_b32_dpp v28, v52, v4 row_shl:4 row_mask:0xf bank_mask:0xf bound_ctrl:1
    v_and_b32_dpp v29, v52, v5 row_shl:4 row_mask:0xf bank_mask:0xf bound_ctrl:1
    v_and_b32 v30, v52, v6
    v_and_b32 v31, v52, v7
    v_mfma_f32_16x16x32_bf16 v[16:19], a[224:227], v[24:27], v[16:19]
    v_and_b32 v32, v53, v4
    v_and_b32 v33, v53, v5
    v_and_b32_dpp v34, v53, v6 row_shr:4 row_mask:0xf bank_mask:0xf bound_ctrl:1
    v_and_b32_dpp v35, v53, v7 row_shr:4 row_mask:0xf bank_mask:0xf bound_ctrl:1
    v_mfma_f32_16x16x32_bf16 v[16:19], a[228:231], v[28:31], v[16:19]
    v_and_b32_dpp v36, v53, v4 row_shl:4 row_mask:0xf bank_mask:0xf bound_ctrl:1
    v_and_b32_dpp v37, v53, v5 row_shl:4 row_mask:0xf bank_mask:0xf bound_ctrl:1
    v_and_b32 v38, v53, v6
    v_and_b32 v39, v53, v7
    v_mfma_f32_16x16x32_bf16 v[16:19], a[232:235], v[32:35], v[16:19]
    v_and_b32 v24, v54, v4
    v_and_b32 v25, v54, v5
    v_and_b32_dpp v26, v54, v6 row_shr:4 row_mask:0xf bank_mask:0xf bound_ctrl:1
    v_and_b32_dpp v27, v54, v7 row_shr:4 row_mask:0xf bank_mask:0xf bound_ctrl:1
    v_mfma_f32_16x16x32_bf16 v[16:19], a[236:239], v[36:39], v[16:19]
    v_and_b32_dpp v28, v54, v4 row_shl:4 row_mask:0xf bank_mask:0xf bound_ctrl:1
    v_and_b32_dpp v29, v54, v5 row_shl:4 row_mask:0xf bank_mask:0xf bound_ctrl:1
    v_and_b32 v30, v54, v6
    v_and_b32 v31, v54, v7
    v_mfma_f32_16x16x32_bf16 v[16:19], a[240:243], v[24:27], v[16:19]
    v_and_b32 v32, v55, v4
    v_and_b32 v33, v55, v5
    v_and_b32_dpp v34, v55, v6 row_shr:4 row_mask:0xf bank_mask:0xf bound_ctrl:1
    v_and_b32_dpp v35, v55, v7 row_shr:4 row_mask:0xf bank_mask:0xf bound_ctrl:1
    v_mfma_f32_16x16x32_bf16 v[16:19], a[244:247], v[28:31], v[16:19]
    v_and_b32_dpp v36, v55, v4 row_shl:4 row_mask:0xf bank_mask:0xf bound_ctrl:1
    v_and_b32_dpp v37, v55, v5 row_shl:4 row_mask:0xf bank_mask:0xf bound_ctrl:1
    v_and_b32 v38, v55, v6
    v_and_b32 v39, v55, v7
    v_mfma_f32_16x16x32_bf16 v[16:19], a[248:251], v[32:35], v[16:19]
    s_nop 0
    v_mfma_f32_16x16x32_bf16 v[16:19], a[252:255], v[36:39], v[16:19]
    s_add_u32 s34, s57, 4194304
    s_xor_b32 s34, s34, 8192
    s_xor_b32 s35, s34, 4096
    s_waitcnt vmcnt(55)
    v_mfma_f32_16x16x32_bf16 v[24:27], v[128:131], v[8:11], 0
    v_mfma_f32_16x16x32_bf16 v[24:27], v[132:135], v[12:15], v[24:27]
    buffer_load_dwordx4 v[128:131], v3, s[8:11], s34 offen offset:0
    buffer_load_dwordx4 v[132:135], v3, s[8:11], s34 offen offset:1024
    v_mfma_f32_16x16x32_bf16 v[28:31], v[136:139], v[8:11], 0
    v_mfma_f32_16x16x32_bf16 v[28:31], v[140:143], v[12:15], v[28:31]
    buffer_load_dwordx4 v[136:139], v3, s[8:11], s34 offen offset:2048
    buffer_load_dwordx4 v[140:143], v3, s[8:11], s34 offen offset:3072
    v_mfma_f32_16x16x32_bf16 v[32:35], v[144:147], v[8:11], 0
    v_mfma_f32_16x16x32_bf16 v[32:35], v[148:151], v[12:15], v[32:35]
    buffer_load_dwordx4 v[144:147], v3, s[8:11], s35 offen offset:0
    buffer_load_dwordx4 v[148:151], v3, s[8:11], s35 offen offset:1024
    v_mfma_f32_16x16x32_bf16 v[36:39], v[152:155], v[8:11], 0
    v_mfma_f32_16x16x32_bf16 v[36:39], v[156:159], v[12:15], v[36:39]
    buffer_load_dwordx4 v[152:155], v3, s[8:11], s35 offen offset:2048
    buffer_load_dwordx4 v[156:159], v3, s[8:11], s35 offen offset:3072
    v_mov_b32_dpp v52, v24 quad_perm:[0,0,0,0] row_mask:0xf bank_mask:0xf
    v_mov_b32_dpp v53, v28 quad_perm:[0,0,0,0] row_mask:0xf bank_mask:0xf
    v_mov_b32_dpp v54, v32 quad_perm:[0,0,0,0] row_mask:0xf bank_mask:0xf
    v_add_f32_dpp v52, v25, v52 quad_perm:[1,1,1,1] row_mask:0xf bank_mask:0xf
    v_add_f32_dpp v53, v29, v53 quad_perm:[1,1,1,1] row_mask:0xf bank_mask:0xf
    v_add_f32_dpp v54, v33, v54 quad_perm:[1,1,1,1] row_mask:0xf bank_mask:0xf
    v_add_f32_dpp v52, v26, v52 quad_perm:[2,2,2,2] row_mask:0xf bank_mask:0xf
    v_add_f32_dpp v53, v30, v53 quad_perm:[2,2,2,2] row_mask:0xf bank_mask:0xf
    v_mov_b32_dpp v55, v36 quad_perm:[0,0,0,0] row_mask:0xf bank_mask:0xf
    v_add_f32_dpp v54, v34, v54 quad_perm:[2,2,2,2] row_mask:0xf bank_mask:0xf
    v_add_f32_dpp v52, v27, v52 quad_perm:[3,3,3,3] row_mask:0xf bank_mask:0xf
    v_add_f32_dpp v55, v37, v55 quad_perm:[1,1,1,1] row_mask:0xf bank_mask:0xf
    v_add_f32_dpp v53, v31, v53 quad_perm:[3,3,3,3] row_mask:0xf bank_mask:0xf
    v_add_f32_dpp v54, v35, v54 quad_perm:[3,3,3,3] row_mask:0xf bank_mask:0xf
    v_add_f32_dpp v55, v38, v55 quad_perm:[2,2,2,2] row_mask:0xf bank_mask:0xf
    s_nop 1
    v_add_f32_dpp v55, v39, v55 quad_perm:[3,3,3,3] row_mask:0xf bank_mask:0xf
    s_mov_b32 s101, 0
    s_mov_b32 s55, 293
    s_add_u32 s36, s36, 1
    s_branch LRINGGO
LRET10:
    v_max3_f32 v44, v52, v53, v20
    v_max3_f32 v44, v44, v54, v55
    s_nop 1
    v_max_f32_dpp v44, v44, v44 row_half_mirror row_mask:0xf bank_mask:0xf
    v_mov_b32 v45, v44
    s_nop 1
    v_permlane16_swap_b32 v44, v45
    v_max_f32 v44, v44, v45
    v_mov_b32 v45, v44
    s_nop 1
    v_permlane32_swap_b32 v44, v45
    v_max_f32 v44, v44, v45
    v_sub_f32 v45, v20, v44
    v_mul_f32 v45, s30, v45
    v_exp_f32 v45, v45
    v_mov_b32 v20, v44
    v_mul_f32 v22, s30, v44
    v_fma_f32 v52, v52, s30, -v22
    v_fma_f32 v53, v53, s30, -v22
    v_fma_f32 v54, v54, s30, -v22
    v_fma_f32 v55, v55, s30, -v22
    v_exp_f32 v52, v52
    v_exp_f32 v53, v53
    v_exp_f32 v54, v54
    v_exp_f32 v55, v55
    v_mul_f32 v21, v21, v45
    v_mul_f32 v16, v16, v45
    v_mul_f32 v17, v17, v45
    v_mul_f32 v18, v18, v45
    v_mul_f32 v19, v19, v45
    v_add_f32 v46, v52, v53
    v_add_f32 v47, v54, v55
    v_cvt_pk_bf16_f32 v52, v52, v52
    v_cvt_pk_bf16_f32 v53, v53, v53
    v_cvt_pk_bf16_f32 v54, v54, v54
    v_cvt_pk_bf16_f32 v55, v55, v55
    v_add_f32 v46, v46, v47
    v_add_f32 v21, v21, v46
    v_and_b32 v24, v52, v4
    v_and_b32 v25, v52, v5
    v_and_b32_dpp v26, v52, v6 row_shr:4 row_mask:0xf bank_mask:0xf bound_ctrl:1
    v_and_b32_dpp v27, v52, v7 row_shr:4 row_mask:0xf bank_mask:0xf bound_ctrl:1
    s_cmp_ge_u32 s101, 2
    s_nop 0
    s_cbranch_scc1 Lsw_17
    s_cmp_eq_u32 s101, 1
    s_cbranch_scc1 Lsw_18
    s_waitcnt vmcnt(0)
Lsw_18:
    s_waitcnt vmcnt(16)
Lsw_17:
    s_waitcnt vmcnt(32)
    v_and_b32_dpp v28, v52, v4 row_shl:4 row_mask:0xf bank_mask:0xf bound_ctrl:1
    v_and_b32_dpp v29, v52, v5 row_shl:4 row_mask:0xf bank_mask:0xf bound_ctrl:1
    v_and_b32 v30, v52, v6
    v_and_b32 v31, v52, v7
    v_mfma_f32_16x16x32_bf16 v[16:19], v[128:131], v[24:27], v[16:19]
    v_and_b32 v32, v53, v4
    v_and_b32 v33, v53, v5
    v_and_b32_dpp v34, v53, v6 row_shr:4 row_mask:0xf bank_mask:0xf bound_ctrl:1
    v_and_b32_dpp v35, v53, v7 row_shr:4 row_mask:0xf bank_mask:0xf bound_ctrl:1
    v_mfma_f32_16x16x32_bf16 v[16:19], v[132:135], v[28:31], v[16:19]
    v_and_b32_dpp v36, v53, v4 row_shl:4 row_mask:0xf bank_mask:0xf bound_ctrl:1
    v_and_b32_dpp v37, v53, v5 row_shl:4 row_mask:0xf bank_mask:0xf bound_ctrl:1
    v_and_b32 v38, v53, v6
    v_and_b32 v39, v53, v7
    v_mfma_f32_16x16x32_bf16 v[16:19], v[136:139], v[32:35], v[16:19]
    v_and_b32 v24, v54, v4
    v_and_b32 v25, v54, v5
    v_and_b32_dpp v26, v54, v6 row_shr:4 row_mask:0xf bank_mask:0xf bound_ctrl:1
    v_and_b32_dpp v27, v54, v7 row_shr:4 row_mask:0xf bank_mask:0xf bound_ctrl:1
    v_mfma_f32_16x16x32_bf16 v[16:19], v[140:143], v[36:39], v[16:19]
    v_and_b32_dpp v28, v54, v4 row_shl:4 row_mask:0xf bank_mask:0xf bound_ctrl:1
    v_and_b32_dpp v29, v54, v5 row_shl:4 row_mask:0xf bank_mask:0xf bound_ctrl:1
    v_and_b32 v30, v54, v6
    v_and_b32 v31, v54, v7
    v_mfma_f32_16x16x32_bf16 v[16:19], v[144:147], v[24:27], v[16:19]
    v_and_b32 v32, v55, v4
    v_and_b32 v33, v55, v5
    v_and_b32_dpp v34, v55, v6 row_shr:4 row_mask:0xf bank_mask:0xf bound_ctrl:1
    v_and_b32_dpp v35, v55, v7 row_shr:4 row_mask:0xf bank_mask:0xf bound_ctrl:1
    v_mfma_f32_16x16x32_bf16 v[16:19], v[148:151], v[28:31], v[16:19]
    v_and_b32_dpp v36, v55, v4 row_shl:4 row_mask:0xf bank_mask:0xf bound_ctrl:1
    v_and_b32_dpp v37, v55, v5 row_shl:4 row_mask:0xf bank_mask:0xf bound_ctrl:1
    v_and_b32 v38, v55, v6
    v_and_b32 v39, v55, v7
    v_mfma_f32_16x16x32_bf16 v[16:19], v[152:155], v[32:35], v[16:19]
    s_nop 0
    v_mfma_f32_16x16x32_bf16 v[16:19], v[156:159], v[36:39], v[16:19]
    s_add_u32 s34, s57, 4718592
    s_xor_b32 s34, s34, 8192
    s_xor_b32 s35, s34, 4096
    s_waitcnt vmcnt(55)
    v_mfma_f32_16x16x32_bf16 v[24:27], v[160:163], v[8:11], 0
    v_mfma_f32_16x16x32_bf16 v[24:27], v[164:167], v[12:15], v[24:27]
    buffer_load_dwordx4 v[160:163], v3, s[8:11], s34 offen offset:0
    buffer_load_dwordx4 v[164:167], v3, s[8:11], s34 offen offset:1024
    v_mfma_f32_16x16x32_bf16 v[28:31], v[168:171], v[8:11], 0
    v_mfma_f32_16x16x32_bf16 v[28:31], v[172:175], v[12:15], v[28:31]
    buffer_load_dwordx4 v[168:171], v3, s[8:11], s34 offen offset:2048
    buffer_load_dwordx4 v[172:175], v3, s[8:11], s34 offen offset:3072
    v_mfma_f32_16x16x32_bf16 v[32:35], v[176:179], v[8:11], 0
    v_mfma_f32_16x16x32_bf16 v[32:35], v[180:183], v[12:15], v[32:35]
    buffer_load_dwordx4 v[176:179], v3, s[8:11], s35 offen offset:0
    buffer_load_dwordx4 v[180:183], v3, s[8:11], s35 offen offset:1024
    v_mfma_f32_16x16x32_bf16 v[36:39], v[184:187], v[8:11], 0
    v_mfma_f32_16x16x32_bf16 v[36:39], v[188:191], v[12:15], v[36:39]
    buffer_load_dwordx4 v[184:187], v3, s[8:11], s35 offen offset:2048
    buffer_load_dwordx4 v[188:191], v3, s[8:11], s35 offen offset:3072
    v_mov_b32_dpp v52, v24 quad_perm:[0,0,0,0] row_mask:0xf bank_mask:0xf
    v_mov_b32_dpp v53, v28 quad_perm:[0,0,0,0] row_mask:0xf bank_mask:0xf
    v_mov_b32_dpp v54, v32 quad_perm:[0,0,0,0] row_mask:0xf bank_mask:0xf
    v_add_f32_dpp v52, v25, v52 quad_perm:[1,1,1,1] row_mask:0xf bank_mask:0xf
    v_add_f32_dpp v53, v29, v53 quad_perm:[1,1,1,1] row_mask:0xf bank_mask:0xf
    v_add_f32_dpp v54, v33, v54 quad_perm:[1,1,1,1] row_mask:0xf bank_mask:0xf
    v_add_f32_dpp v52, v26, v52 quad_perm:[2,2,2,2] row_mask:0xf bank_mask:0xf
    v_add_f32_dpp v53, v30, v53 quad_perm:[2,2,2,2] row_mask:0xf bank_mask:0xf
    v_mov_b32_dpp v55, v36 quad_perm:[0,0,0,0] row_mask:0xf bank_mask:0xf
    v_add_f32_dpp v54, v34, v54 quad_perm:[2,2,2,2] row_mask:0xf bank_mask:0xf
    v_add_f32_dpp v52, v27, v52 quad_perm:[3,3,3,3] row_mask:0xf bank_mask:0xf
    v_add_f32_dpp v55, v37, v55 quad_perm:[1,1,1,1] row_mask:0xf bank_mask:0xf
    v_add_f32_dpp v53, v31, v53 quad_perm:[3,3,3,3] row_mask:0xf bank_mask:0xf
    v_add_f32_dpp v54, v35, v54 quad_perm:[3,3,3,3] row_mask:0xf bank_mask:0xf
    v_add_f32_dpp v55, v38, v55 quad_perm:[2,2,2,2] row_mask:0xf bank_mask:0xf
    s_nop 1
    v_add_f32_dpp v55, v39, v55 quad_perm:[3,3,3,3] row_mask:0xf bank_mask:0xf
    s_mov_b32 s101, 0
    s_mov_b32 s55, 322
    s_add_u32 s36, s36, 1
    s_branch LRINGGO
LRET11:
    v_max3_f32 v44, v52, v53, v20
    v_max3_f32 v44, v44, v54, v55
    s_nop 1
    v_max_f32_dpp v44, v44, v44 row_half_mirror row_mask:0xf bank_mask:0xf
    v_mov_b32 v45, v44
    s_nop 1
    v_permlane16_swap_b32 v44, v45
    v_max_f32 v44, v44, v45
    v_mov_b32 v45, v44
    s_nop 1
    v_permlane32_swap_b32 v44, v45
    v_max_f32 v44, v44, v45
    v_sub_f32 v45, v20, v44
    v_mul_f32 v45, s30, v45
    v_exp_f32 v45, v45
    v_mov_b32 v20, v44
    v_mul_f32 v22, s30, v44
    v_fma_f32 v52, v52, s30, -v22
    v_fma_f32 v53, v53, s30, -v22
    v_fma_f32 v54, v54, s30, -v22
    v_fma_f32 v55, v55, s30, -v22
    v_exp_f32 v52, v52
    v_exp_f32 v53, v53
    v_exp_f32 v54, v54
    v_exp_f32 v55, v55
    v_mul_f32 v21, v21, v45
    v_mul_f32 v16, v16, v45
    v_mul_f32 v17, v17, v45
    v_mul_f32 v18, v18, v45
    v_mul_f32 v19, v19, v45
    v_add_f32 v46, v52, v53
    v_add_f32 v47, v54, v55
    v_cvt_pk_bf16_f32 v52, v52, v52
    v_cvt_pk_bf16_f32 v53, v53, v53
    v_cvt_pk_bf16_f32 v54, v54, v54
    v_cvt_pk_bf16_f32 v55, v55, v55
    v_add_f32 v46, v46, v47
    v_add_f32 v21, v21, v46
    v_and_b32 v24, v52, v4
    v_and_b32 v25, v52, v5
    v_and_b32_dpp v26, v52, v6 row_shr:4 row_mask:0xf bank_mask:0xf bound_ctrl:1
    v_and_b32_dpp v27, v52, v7 row_shr:4 row_mask:0xf bank_mask:0xf bound_ctrl:1
    s_cmp_ge_u32 s101, 2
    s_nop 0
    s_cbranch_scc1 Lsw_19
    s_cmp_eq_u32 s101, 1
    s_cbranch_scc1 Lsw_20
    s_waitcnt vmcnt(0)
Lsw_20:
    s_waitcnt vmcnt(16)
Lsw_19:
    s_waitcnt vmcnt(32)
    v_and_b32_dpp v28, v52, v4 row_shl:4 row_mask:0xf bank_mask:0xf bound_ctrl:1
    v_and_b32_dpp v29, v52, v5 row_shl:4 row_mask:0xf bank_mask:0xf bound_ctrl:1
    v_and_b32 v30, v52, v6
    v_and_b32 v31, v52, v7
    v_mfma_f32_16x16x32_bf16 v[16:19], v[160:163], v[24:27], v[16:19]
    v_and_b32 v32, v53, v4
    v_and_b32 v33, v53, v5
    v_and_b32_dpp v34, v53, v6 row_shr:4 row_mask:0xf bank_mask:0xf bound_ctrl:1
    v_and_b32_dpp v35, v53, v7 row_shr:4 row_mask:0xf bank_mask:0xf bound_ctrl:1
    v_mfma_f32_16x16x32_bf16 v[16:19], v[164:167], v[28:31], v[16:19]
    v_and_b32_dpp v36, v53, v4 row_shl:4 row_mask:0xf bank_mask:0xf bound_ctrl:1
    v_and_b32_dpp v37, v53, v5 row_shl:4 row_mask:0xf bank_mask:0xf bound_ctrl:1
    v_and_b32 v38, v53, v6
    v_and_b32 v39, v53, v7
    v_mfma_f32_16x16x32_bf16 v[16:19], v[168:171], v[32:35], v[16:19]
    v_and_b32 v24, v54, v4
    v_and_b32 v25, v54, v5
    v_and_b32_dpp v26, v54, v6 row_shr:4 row_mask:0xf bank_mask:0xf bound_ctrl:1
    v_and_b32_dpp v27, v54, v7 row_shr:4 row_mask:0xf bank_mask:0xf bound_ctrl:1
    v_mfma_f32_16x16x32_bf16 v[16:19], v[172:175], v[36:39], v[16:19]
    v_and_b32_dpp v28, v54, v4 row_shl:4 row_mask:0xf bank_mask:0xf bound_ctrl:1
    v_and_b32_dpp v29, v54, v5 row_shl:4 row_mask:0xf bank_mask:0xf bound_ctrl:1
    v_and_b32 v30, v54, v6
    v_and_b32 v31, v54, v7
    v_mfma_f32_16x16x32_bf16 v[16:19], v[176:179], v[24:27], v[16:19]
    v_and_b32 v32, v55, v4
    v_and_b32 v33, v55, v5
    v_and_b32_dpp v34, v55, v6 row_shr:4 row_mask:0xf bank_mask:0xf bound_ctrl:1
    v_and_b32_dpp v35, v55, v7 row_shr:4 row_mask:0xf bank_mask:0xf bound_ctrl:1
    v_mfma_f32_16x16x32_bf16 v[16:19], v[180:183], v[28:31], v[16:19]
    v_and_b32_dpp v36, v55, v4 row_shl:4 row_mask:0xf bank_mask:0xf bound_ctrl:1
    v_and_b32_dpp v37, v55, v5 row_shl:4 row_mask:0xf bank_mask:0xf bound_ctrl:1
    v_and_b32 v38, v55, v6
    v_and_b32 v39, v55, v7
    v_mfma_f32_16x16x32_bf16 v[16:19], v[184:187], v[32:35], v[16:19]
    s_nop 0
    v_mfma_f32_16x16x32_bf16 v[16:19], v[188:191], v[36:39], v[16:19]
    s_add_u32 s34, s57, 5242880
    s_xor_b32 s34, s34, 8192
    s_xor_b32 s35, s34, 4096
    s_waitcnt vmcnt(55)
    v_mfma_f32_16x16x32_bf16 v[24:27], v[192:195], v[8:11], 0
    v_mfma_f32_16x16x32_bf16 v[24:27], v[196:199], v[12:15], v[24:27]
    buffer_load_dwordx4 v[192:195], v3, s[8:11], s34 offen offset:0
    buffer_load_dwordx4 v[196:199], v3, s[8:11], s34 offen offset:1024
    v_mfma_f32_16x16x32_bf16 v[28:31], v[200:203], v[8:11], 0
    v_mfma_f32_16x16x32_bf16 v[28:31], v[204:207], v[12:15], v[28:31]
    buffer_load_dwordx4 v[200:203], v3, s[8:11], s34 offen offset:2048
    buffer_load_dwordx4 v[204:207], v3, s[8:11], s34 offen offset:3072
    v_mfma_f32_16x16x32_bf16 v[32:35], v[208:211], v[8:11], 0
    v_mfma_f32_16x16x32_bf16 v[32:35], v[212:215], v[12:15], v[32:35]
    buffer_load_dwordx4 v[208:211], v3, s[8:11], s35 offen offset:0
    buffer_load_dwordx4 v[212:215], v3, s[8:11], s35 offen offset:1024
    v_mfma_f32_16x16x32_bf16 v[36:39], v[216:219], v[8:11], 0
    v_mfma_f32_16x16x32_bf16 v[36:39], v[220:223], v[12:15], v[36:39]
    buffer_load_dwordx4 v[216:219], v3, s[8:11], s35 offen offset:2048
    buffer_load_dwordx4 v[220:223], v3, s[8:11], s35 offen offset:3072
    v_mov_b32_dpp v52, v24 quad_perm:[0,0,0,0] row_mask:0xf bank_mask:0xf
    v_mov_b32_dpp v53, v28 quad_perm:[0,0,0,0] row_mask:0xf bank_mask:0xf
    v_mov_b32_dpp v54, v32 quad_perm:[0,0,0,0] row_mask:0xf bank_mask:0xf
    v_add_f32_dpp v52, v25, v52 quad_perm:[1,1,1,1] row_mask:0xf bank_mask:0xf
    v_add_f32_dpp v53, v29, v53 quad_perm:[1,1,1,1] row_mask:0xf bank_mask:0xf
    v_add_f32_dpp v54, v33, v54 quad_perm:[1,1,1,1] row_mask:0xf bank_mask:0xf
    v_add_f32_dpp v52, v26, v52 quad_perm:[2,2,2,2] row_mask:0xf bank_mask:0xf
    v_add_f32_dpp v53, v30, v53 quad_perm:[2,2,2,2] row_mask:0xf bank_mask:0xf
    v_mov_b32_dpp v55, v36 quad_perm:[0,0,0,0] row_mask:0xf bank_mask:0xf
    v_add_f32_dpp v54, v34, v54 quad_perm:[2,2,2,2] row_mask:0xf bank_mask:0xf
    v_add_f32_dpp v52, v27, v52 quad_perm:[3,3,3,3] row_mask:0xf bank_mask:0xf
    v_add_f32_dpp v55, v37, v55 quad_perm:[1,1,1,1] row_mask:0xf bank_mask:0xf
    v_add_f32_dpp v53, v31, v53 quad_perm:[3,3,3,3] row_mask:0xf bank_mask:0xf
    v_add_f32_dpp v54, v35, v54 quad_perm:[3,3,3,3] row_mask:0xf bank_mask:0xf
    v_add_f32_dpp v55, v38, v55 quad_perm:[2,2,2,2] row_mask:0xf bank_mask:0xf
    s_nop 1
    v_add_f32_dpp v55, v39, v55 quad_perm:[3,3,3,3] row_mask:0xf bank_mask:0xf
    s_mov_b32 s101, 0
    s_mov_b32 s55, 351
    s_add_u32 s36, s36, 1
    s_branch LRINGGO
LRET12:
    v_max3_f32 v44, v52, v53, v20
    v_max3_f32 v44, v44, v54, v55
    s_nop 1
    v_max_f32_dpp v44, v44, v44 row_half_mirror row_mask:0xf bank_mask:0xf
    v_mov_b32 v45, v44
    s_nop 1
    v_permlane16_swap_b32 v44, v45
    v_max_f32 v44, v44, v45
    v_mov_b32 v45, v44
    s_nop 1
    v_permlane32_swap_b32 v44, v45
    v_max_f32 v44, v44, v45
    v_sub_f32 v45, v20, v44
    v_mul_f32 v45, s30, v45
    v_exp_f32 v45, v45
    v_mov_b32 v20, v44
    v_mul_f32 v22, s30, v44
    v_fma_f32 v52, v52, s30, -v22
    v_fma_f32 v53, v53, s30, -v22
    v_fma_f32 v54, v54, s30, -v22
    v_fma_f32 v55, v55, s30, -v22
    v_exp_f32 v52, v52
    v_exp_f32 v53, v53
    v_exp_f32 v54, v54
    v_exp_f32 v55, v55
    v_mul_f32 v21, v21, v45
    v_mul_f32 v16, v16, v45
    v_mul_f32 v17, v17, v45
    v_mul_f32 v18, v18, v45
    v_mul_f32 v19, v19, v45
    v_add_f32 v46, v52, v53
    v_add_f32 v47, v54, v55
    v_cvt_pk_bf16_f32 v52, v52, v52
    v_cvt_pk_bf16_f32 v53, v53, v53
    v_cvt_pk_bf16_f32 v54, v54, v54
    v_cvt_pk_bf16_f32 v55, v55, v55
    v_add_f32 v46, v46, v47
    v_add_f32 v21, v21, v46
    v_and_b32 v24, v52, v4
    v_and_b32 v25, v52, v5
    v_and_b32_dpp v26, v52, v6 row_shr:4 row_mask:0xf bank_mask:0xf bound_ctrl:1
    v_and_b32_dpp v27, v52, v7 row_shr:4 row_mask:0xf bank_mask:0xf bound_ctrl:1
    s_cmp_ge_u32 s101, 2
    s_nop 0
    s_cbranch_scc1 Lsw_21
    s_cmp_eq_u32 s101, 1
    s_cbranch_scc1 Lsw_22
    s_waitcnt vmcnt(0)
Lsw_22:
    s_waitcnt vmcnt(16)
Lsw_21:
    s_waitcnt vmcnt(32)
    v_and_b32_dpp v28, v52, v4 row_shl:4 row_mask:0xf bank_mask:0xf bound_ctrl:1
    v_and_b32_dpp v29, v52, v5 row_shl:4 row_mask:0xf bank_mask:0xf bound_ctrl:1
    v_and_b32 v30, v52, v6
    v_and_b32 v31, v52, v7
    v_mfma_f32_16x16x32_bf16 v[16:19], v[192:195], v[24:27], v[16:19]
    v_and_b32 v32, v53, v4
    v_and_b32 v33, v53, v5
    v_and_b32_dpp v34, v53, v6 row_shr:4 row_mask:0xf bank_mask:0xf bound_ctrl:1
    v_and_b32_dpp v35, v53, v7 row_shr:4 row_mask:0xf bank_mask:0xf bound_ctrl:1
    v_mfma_f32_16x16x32_bf16 v[16:19], v[196:199], v[28:31], v[16:19]
    v_and_b32_dpp v36, v53, v4 row_shl:4 row_mask:0xf bank_mask:0xf bound_ctrl:1
    v_and_b32_dpp v37, v53, v5 row_shl:4 row_mask:0xf bank_mask:0xf bound_ctrl:1
    v_and_b32 v38, v53, v6
    v_and_b32 v39, v53, v7
    v_mfma_f32_16x16x32_bf16 v[16:19], v[200:203], v[32:35], v[16:19]
    v_and_b32 v24, v54, v4
    v_and_b32 v25, v54, v5
    v_and_b32_dpp v26, v54, v6 row_shr:4 row_mask:0xf bank_mask:0xf bound_ctrl:1
    v_and_b32_dpp v27, v54, v7 row_shr:4 row_mask:0xf bank_mask:0xf bound_ctrl:1
    v_mfma_f32_16x16x32_bf16 v[16:19], v[204:207], v[36:39], v[16:19]
    v_and_b32_dpp v28, v54, v4 row_shl:4 row_mask:0xf bank_mask:0xf bound_ctrl:1
    v_and_b32_dpp v29, v54, v5 row_shl:4 row_mask:0xf bank_mask:0xf bound_ctrl:1
    v_and_b32 v30, v54, v6
    v_and_b32 v31, v54, v7
    v_mfma_f32_16x16x32_bf16 v[16:19], v[208:211], v[24:27], v[16:19]
    v_and_b32 v32, v55, v4
    v_and_b32 v33, v55, v5
    v_and_b32_dpp v34, v55, v6 row_shr:4 row_mask:0xf bank_mask:0xf bound_ctrl:1
    v_and_b32_dpp v35, v55, v7 row_shr:4 row_mask:0xf bank_mask:0xf bound_ctrl:1
    v_mfma_f32_16x16x32_bf16 v[16:19], v[212:215], v[28:31], v[16:19]
    v_and_b32_dpp v36, v55, v4 row_shl:4 row_mask:0xf bank_mask:0xf bound_ctrl:1
    v_and_b32_dpp v37, v55, v5 row_shl:4 row_mask:0xf bank_mask:0xf bound_ctrl:1
    v_and_b32 v38, v55, v6
    v_and_b32 v39, v55, v7
    v_mfma_f32_16x16x32_bf16 v[16:19], v[216:219], v[32:35], v[16:19]
    s_nop 0
    v_mfma_f32_16x16x32_bf16 v[16:19], v[220:223], v[36:39], v[16:19]
    s_add_u32 s34, s57, 5767168
    s_xor_b32 s34, s34, 8192
    s_xor_b32 s35, s34, 4096
    s_waitcnt vmcnt(55)
    v_mfma_f32_16x16x32_bf16 v[24:27], v[224:227], v[8:11], 0
    v_mfma_f32_16x16x32_bf16 v[24:27], v[228:231], v[12:15], v[24:27]
    buffer_load_dwordx4 v[224:227], v3, s[8:11], s34 offen offset:0
    buffer_load_dwordx4 v[228:231], v3, s[8:11], s34 offen offset:1024
    v_mfma_f32_16x16x32_bf16 v[28:31], v[232:235], v[8:11], 0
    v_mfma_f32_16x16x32_bf16 v[28:31], v[236:239], v[12:15], v[28:31]
    buffer_load_dwordx4 v[232:235], v3, s[8:11], s34 offen offset:2048
    buffer_load_dwordx4 v[236:239], v3, s[8:11], s34 offen offset:3072
    v_mfma_f32_16x16x32_bf16 v[32:35], v[240:243], v[8:11], 0
    v_mfma_f32_16x16x32_bf16 v[32:35], v[244:247], v[12:15], v[32:35]
    buffer_load_dwordx4 v[240:243], v3, s[8:11], s35 offen offset:0
    buffer_load_dwordx4 v[244:247], v3, s[8:11], s35 offen offset:1024
    v_mfma_f32_16x16x32_bf16 v[36:39], v[248:251], v[8:11], 0
    v_mfma_f32_16x16x32_bf16 v[36:39], v[252:255], v[12:15], v[36:39]
    buffer_load_dwordx4 v[248:251], v3, s[8:11], s35 offen offset:2048
    buffer_load_dwordx4 v[252:255], v3, s[8:11], s35 offen offset:3072
    v_mov_b32_dpp v52, v24 quad_perm:[0,0,0,0] row_mask:0xf bank_mask:0xf
    v_mov_b32_dpp v53, v28 quad_perm:[0,0,0,0] row_mask:0xf bank_mask:0xf
    v_mov_b32_dpp v54, v32 quad_perm:[0,0,0,0] row_mask:0xf bank_mask:0xf
    v_add_f32_dpp v52, v25, v52 quad_perm:[1,1,1,1] row_mask:0xf bank_mask:0xf
    v_add_f32_dpp v53, v29, v53 quad_perm:[1,1,1,1] row_mask:0xf bank_mask:0xf
    v_add_f32_dpp v54, v33, v54 quad_perm:[1,1,1,1] row_mask:0xf bank_mask:0xf
    v_add_f32_dpp v52, v26, v52 quad_perm:[2,2,2,2] row_mask:0xf bank_mask:0xf
    v_add_f32_dpp v53, v30, v53 quad_perm:[2,2,2,2] row_mask:0xf bank_mask:0xf
    v_mov_b32_dpp v55, v36 quad_perm:[0,0,0,0] row_mask:0xf bank_mask:0xf
    v_add_f32_dpp v54, v34, v54 quad_perm:[2,2,2,2] row_mask:0xf bank_mask:0xf
    v_add_f32_dpp v52, v27, v52 quad_perm:[3,3,3,3] row_mask:0xf bank_mask:0xf
    v_add_f32_dpp v55, v37, v55 quad_perm:[1,1,1,1] row_mask:0xf bank_mask:0xf
    v_add_f32_dpp v53, v31, v53 quad_perm:[3,3,3,3] row_mask:0xf bank_mask:0xf
    v_add_f32_dpp v54, v35, v54 quad_perm:[3,3,3,3] row_mask:0xf bank_mask:0xf
    v_add_f32_dpp v55, v38, v55 quad_perm:[2,2,2,2] row_mask:0xf bank_mask:0xf
    s_nop 1
    v_add_f32_dpp v55, v39, v55 quad_perm:[3,3,3,3] row_mask:0xf bank_mask:0xf
    s_mov_b32 s101, 0
    s_mov_b32 s55, 380
    s_add_u32 s36, s36, 1
    s_branch LRINGGO
LRET13:
    s_lshl_b32 s44, s24, 13
    s_add_u32 s44, s44, 130304
    v_add_u32 v40, s44, v3
    ds_read_b128 a[0:3], v40 offset:0
    ds_read_b128 a[4:7], v40 offset:1024
    ds_read_b128 a[8:11], v40 offset:2048
    ds_read_b128 a[12:15], v40 offset:3072
    ds_read_b128 a[16:19], v40 offset:4096
    ds_read_b128 a[20:23], v40 offset:5120
    ds_read_b128 a[24:27], v40 offset:6144
    ds_read_b128 a[28:31], v40 offset:7168
    v_max3_f32 v44, v52, v53, v20
    v_max3_f32 v44, v44, v54, v55
    s_nop 1
    v_max_f32_dpp v44, v44, v44 row_half_mirror row_mask:0xf bank_mask:0xf
    v_mov_b32 v45, v44
    s_nop 1
    v_permlane16_swap_b32 v44, v45
    v_max_f32 v44, v44, v45
    v_mov_b32 v45, v44
    s_nop 1
    v_permlane32_swap_b32 v44, v45
    v_max_f32 v44, v44, v45
    v_sub_f32 v45, v20, v44
    v_mul_f32 v45, s30, v45
    v_exp_f32 v45, v45
    v_mov_b32 v20, v44
    v_mul_f32 v22, s30, v44
    v_fma_f32 v52, v52, s30, -v22
    v_fma_f32 v53, v53, s30, -v22
    v_fma_f32 v54, v54, s30, -v22
    v_fma_f32 v55, v55, s30, -v22
    v_exp_f32 v52, v52
    v_exp_f32 v53, v53
    v_exp_f32 v54, v54
    v_exp_f32 v55, v55
    v_mul_f32 v21, v21, v45
    v_mul_f32 v16, v16, v45
    v_mul_f32 v17, v17, v45
    v_mul_f32 v18, v18, v45
    v_mul_f32 v19, v19, v45
    v_add_f32 v46, v52, v53
    v_add_f32 v47, v54, v55
    v_cvt_pk_bf16_f32 v52, v52, v52
    v_cvt_pk_bf16_f32 v53, v53, v53
    v_cvt_pk_bf16_f32 v54, v54, v54
    v_cvt_pk_bf16_f32 v55, v55, v55
    v_add_f32 v46, v46, v47
    v_add_f32 v21, v21, v46
    v_and_b32 v24, v52, v4
    v_and_b32 v25, v52, v5
    v_and_b32_dpp v26, v52, v6 row_shr:4 row_mask:0xf bank_mask:0xf bound_ctrl:1
    v_and_b32_dpp v27, v52, v7 row_shr:4 row_mask:0xf bank_mask:0xf bound_ctrl:1
    s_cmp_ge_u32 s101, 2
    s_nop 0
    s_cbranch_scc1 Lsw_23
    s_cmp_eq_u32 s101, 1
    s_cbranch_scc1 Lsw_24
    s_waitcnt vmcnt(0)
Lsw_24:
    s_waitcnt vmcnt(16)
Lsw_23:
    s_waitcnt vmcnt(32)
    v_and_b32_dpp v28, v52, v4 row_shl:4 row_mask:0xf bank_mask:0xf bound_ctrl:1
    v_and_b32_dpp v29, v52, v5 row_shl:4 row_mask:0xf bank_mask:0xf bound_ctrl:1
    v_and_b32 v30, v52, v6
    v_and_b32 v31, v52, v7
    v_mfma_f32_16x16x32_bf16 v[16:19], v[224:227], v[24:27], v[16:19]
    v_and_b32 v32, v53, v4
    v_and_b32 v33, v53, v5
    v_and_b32_dpp v34, v53, v6 row_shr:4 row_mask:0xf bank_mask:0xf bound_ctrl:1
    v_and_b32_dpp v35, v53, v7 row_shr:4 row_mask:0xf bank_mask:0xf bound_ctrl:1
    v_mfma_f32_16x16x32_bf16 v[16:19], v[228:231], v[28:31], v[16:19]
    v_and_b32_dpp v36, v53, v4 row_shl:4 row_mask:0xf bank_mask:0xf bound_ctrl:1
    v_and_b32_dpp v37, v53, v5 row_shl:4 row_mask:0xf bank_mask:0xf bound_ctrl:1
    v_and_b32 v38, v53, v6
    v_and_b32 v39, v53, v7
    v_mfma_f32_16x16x32_bf16 v[16:19], v[232:235], v[32:35], v[16:19]
    v_and_b32 v24, v54, v4
    v_and_b32 v25, v54, v5
    v_and_b32_dpp v26, v54, v6 row_shr:4 row_mask:0xf bank_mask:0xf bound_ctrl:1
    v_and_b32_dpp v27, v54, v7 row_shr:4 row_mask:0xf bank_mask:0xf bound_ctrl:1
    v_mfma_f32_16x16x32_bf16 v[16:19], v[236:239], v[36:39], v[16:19]
    v_and_b32_dpp v28, v54, v4 row_shl:4 row_mask:0xf bank_mask:0xf bound_ctrl:1
    v_and_b32_dpp v29, v54, v5 row_shl:4 row_mask:0xf bank_mask:0xf bound_ctrl:1
    v_and_b32 v30, v54, v6
    v_and_b32 v31, v54, v7
    v_mfma_f32_16x16x32_bf16 v[16:19], v[240:243], v[24:27], v[16:19]
    v_and_b32 v32, v55, v4
    v_and_b32 v33, v55, v5
    v_and_b32_dpp v34, v55, v6 row_shr:4 row_mask:0xf bank_mask:0xf bound_ctrl:1
    v_and_b32_dpp v35, v55, v7 row_shr:4 row_mask:0xf bank_mask:0xf bound_ctrl:1
    v_mfma_f32_16x16x32_bf16 v[16:19], v[244:247], v[28:31], v[16:19]
    v_and_b32_dpp v36, v55, v4 row_shl:4 row_mask:0xf bank_mask:0xf bound_ctrl:1
    v_and_b32_dpp v37, v55, v5 row_shl:4 row_mask:0xf bank_mask:0xf bound_ctrl:1
    v_and_b32 v38, v55, v6
    v_and_b32 v39, v55, v7
    v_mfma_f32_16x16x32_bf16 v[16:19], v[248:251], v[32:35], v[16:19]
    s_nop 0
    v_mfma_f32_16x16x32_bf16 v[16:19], v[252:255], v[36:39], v[16:19]
    s_add_u32 s34, s57, 6291456
    s_xor_b32 s35, s34, 4096
    s_waitcnt lgkmcnt(0)
    s_waitcnt vmcnt(55)
    v_mfma_f32_16x16x32_bf16 v[24:27], a[0:3], v[8:11], 0
    v_mfma_f32_16x16x32_bf16 v[24:27], a[4:7], v[12:15], v[24:27]
    buffer_load_dwordx4 a[0:3], v3, s[8:11], s34 offen offset:0
    buffer_load_dwordx4 a[4:7], v3, s[8:11], s34 offen offset:1024
    v_mfma_f32_16x16x32_bf16 v[28:31], a[8:11], v[8:11], 0
    v_mfma_f32_16x16x32_bf16 v[28:31], a[12:15], v[12:15], v[28:31]
    buffer_load_dwordx4 a[8:11], v3, s[8:11], s34 offen offset:2048
    buffer_load_dwordx4 a[12:15], v3, s[8:11], s34 offen offset:3072
    v_mfma_f32_16x16x32_bf16 v[32:35], a[16:19], v[8:11], 0
    v_mfma_f32_16x16x32_bf16 v[32:35], a[20:23], v[12:15], v[32:35]
    buffer_load_dwordx4 a[16:19], v3, s[8:11], s35 offen offset:0
    buffer_load_dwordx4 a[20:23], v3, s[8:11], s35 offen offset:1024
    v_mfma_f32_16x16x32_bf16 v[36:39], a[24:27], v[8:11], 0
    v_mfma_f32_16x16x32_bf16 v[36:39], a[28:31], v[12:15], v[36:39]
    buffer_load_dwordx4 a[24:27], v3, s[8:11], s35 offen offset:2048
    buffer_load_dwordx4 a[28:31], v3, s[8:11], s35 offen offset:3072
    v_mov_b32_dpp v52, v24 quad_perm:[0,0,0,0] row_mask:0xf bank_mask:0xf
    v_mov_b32_dpp v53, v28 quad_perm:[0,0,0,0] row_mask:0xf bank_mask:0xf
    v_mov_b32_dpp v54, v32 quad_perm:[0,0,0,0] row_mask:0xf bank_mask:0xf
    v_add_f32_dpp v52, v25, v52 quad_perm:[1,1,1,1] row_mask:0xf bank_mask:0xf
    v_add_f32_dpp v53, v29, v53 quad_perm:[1,1,1,1] row_mask:0xf bank_mask:0xf
    v_add_f32_dpp v54, v33, v54 quad_perm:[1,1,1,1] row_mask:0xf bank_mask:0xf
    v_add_f32_dpp v52, v26, v52 quad_perm:[2,2,2,2] row_mask:0xf bank_mask:0xf
    v_add_f32_dpp v53, v30, v53 quad_perm:[2,2,2,2] row_mask:0xf bank_mask:0xf
    v_mov_b32_dpp v55, v36 quad_perm:[0,0,0,0] row_mask:0xf bank_mask:0xf
    v_add_f32_dpp v54, v34, v54 quad_perm:[2,2,2,2] row_mask:0xf bank_mask:0xf
    v_add_f32_dpp v52, v27, v52 quad_perm:[3,3,3,3] row_mask:0xf bank_mask:0xf
    v_add_f32_dpp v55, v37, v55 quad_perm:[1,1,1,1] row_mask:0xf bank_mask:0xf
    v_add_f32_dpp v53, v31, v53 quad_perm:[3,3,3,3] row_mask:0xf bank_mask:0xf
    v_add_f32_dpp v54, v35, v54 quad_perm:[3,3,3,3] row_mask:0xf bank_mask:0xf
    v_add_f32_dpp v55, v38, v55 quad_perm:[2,2,2,2] row_mask:0xf bank_mask:0xf
    s_nop 1
    v_add_f32_dpp v55, v39, v55 quad_perm:[3,3,3,3] row_mask:0xf bank_mask:0xf
    s_mov_b32 s101, 0
    s_mov_b32 s55, 409
    s_add_u32 s36, s36, 1
    s_branch LRINGGO
LRET14:
    v_max3_f32 v44, v52, v53, v20
    v_max3_f32 v44, v44, v54, v55
    s_nop 1
    v_max_f32_dpp v44, v44, v44 row_half_mirror row_mask:0xf bank_mask:0xf
    v_mov_b32 v45, v44
    s_nop 1
    v_permlane16_swap_b32 v44, v45
    v_max_f32 v44, v44, v45
    v_mov_b32 v45, v44
    s_nop 1
    v_permlane32_swap_b32 v44, v45
    v_max_f32 v44, v44, v45
    v_sub_f32 v45, v20, v44
    v_mul_f32 v45, s30, v45
    v_exp_f32 v45, v45
    v_mov_b32 v20, v44
    v_mul_f32 v22, s30, v44
    v_fma_f32 v52, v52, s30, -v22
    v_fma_f32 v53, v53, s30, -v22
    v_fma_f32 v54, v54, s30, -v22
    v_fma_f32 v55, v55, s30, -v22
    v_exp_f32 v52, v52
    v_exp_f32 v53, v53
    v_exp_f32 v54, v54
    v_exp_f32 v55, v55
    v_mul_f32 v21, v21, v45
    v_mul_f32 v16, v16, v45
    v_mul_f32 v17, v17, v45
    v_mul_f32 v18, v18, v45
    v_mul_f32 v19, v19, v45
    v_add_f32 v46, v52, v53
    v_add_f32 v47, v54, v55
    v_cvt_pk_bf16_f32 v52, v52, v52
    v_cvt_pk_bf16_f32 v53, v53, v53
    v_cvt_pk_bf16_f32 v54, v54, v54
    v_cvt_pk_bf16_f32 v55, v55, v55
    v_add_f32 v46, v46, v47
    v_add_f32 v21, v21, v46
    v_and_b32 v24, v52, v4
    v_and_b32 v25, v52, v5
    v_and_b32_dpp v26, v52, v6 row_shr:4 row_mask:0xf bank_mask:0xf bound_ctrl:1
    v_and_b32_dpp v27, v52, v7 row_shr:4 row_mask:0xf bank_mask:0xf bound_ctrl:1
    s_cmp_ge_u32 s101, 2
    s_nop 0
    s_cbranch_scc1 Lsw_25
    s_cmp_eq_u32 s101, 1
    s_cbranch_scc1 Lsw_26
    s_waitcnt vmcnt(0)
Lsw_26:
    s_waitcnt vmcnt(16)
Lsw_25:
    s_waitcnt vmcnt(32)
    v_and_b32_dpp v28, v52, v4 row_shl:4 row_mask:0xf bank_mask:0xf bound_ctrl:1
    v_and_b32_dpp v29, v52, v5 row_shl:4 row_mask:0xf bank_mask:0xf bound_ctrl:1
    v_and_b32 v30, v52, v6
    v_and_b32 v31, v52, v7
    v_mfma_f32_16x16x32_bf16 v[16:19], a[0:3], v[24:27], v[16:19]
    v_and_b32 v32, v53, v4
    v_and_b32 v33, v53, v5
    v_and_b32_dpp v34, v53, v6 row_shr:4 row_mask:0xf bank_mask:0xf bound_ctrl:1
    v_and_b32_dpp v35, v53, v7 row_shr:4 row_mask:0xf bank_mask:0xf bound_ctrl:1
    v_mfma_f32_16x16x32_bf16 v[16:19], a[4:7], v[28:31], v[16:19]
    v_and_b32_dpp v36, v53, v4 row_shl:4 row_mask:0xf bank_mask:0xf bound_ctrl:1
    v_and_b32_dpp v37, v53, v5 row_shl:4 row_mask:0xf bank_mask:0xf bound_ctrl:1
    v_and_b32 v38, v53, v6
    v_and_b32 v39, v53, v7
    v_mfma_f32_16x16x32_bf16 v[16:19], a[8:11], v[32:35], v[16:19]
    v_and_b32 v24, v54, v4
    v_and_b32 v25, v54, v5
    v_and_b32_dpp v26, v54, v6 row_shr:4 row_mask:0xf bank_mask:0xf bound_ctrl:1
    v_and_b32_dpp v27, v54, v7 row_shr:4 row_mask:0xf bank_mask:0xf bound_ctrl:1
    v_mfma_f32_16x16x32_bf16 v[16:19], a[12:15], v[36:39], v[16:19]
    v_and_b32_dpp v28, v54, v4 row_shl:4 row_mask:0xf bank_mask:0xf bound_ctrl:1
    v_and_b32_dpp v29, v54, v5 row_shl:4 row_mask:0xf bank_mask:0xf bound_ctrl:1
    v_and_b32 v30, v54, v6
    v_and_b32 v31, v54, v7
    v_mfma_f32_16x16x32_bf16 v[16:19], a[16:19], v[24:27], v[16:19]
    v_and_b32 v32, v55, v4
    v_and_b32 v33, v55, v5
    v_and_b32_dpp v34, v55, v6 row_shr:4 row_mask:0xf bank_mask:0xf bound_ctrl:1
    v_and_b32_dpp v35, v55, v7 row_shr:4 row_mask:0xf bank_mask:0xf bound_ctrl:1
    v_mfma_f32_16x16x32_bf16 v[16:19], a[20:23], v[28:31], v[16:19]
    v_and_b32_dpp v36, v55, v4 row_shl:4 row_mask:0xf bank_mask:0xf bound_ctrl:1
    v_and_b32_dpp v37, v55, v5 row_shl:4 row_mask:0xf bank_mask:0xf bound_ctrl:1
    v_and_b32 v38, v55, v6
    v_and_b32 v39, v55, v7
    v_mfma_f32_16x16x32_bf16 v[16:19], a[24:27], v[32:35], v[16:19]
    s_nop 0
    v_mfma_f32_16x16x32_bf16 v[16:19], a[28:31], v[36:39], v[16:19]
    s_mov_b32 s55, -1
    s_mov_b32 s37, -1
    s_nop 5
LRINGGO:
    s_branch LRING0
LPASSEND:
    v_add_f32_dpp v21, v21, v21 row_half_mirror row_mask:0xf bank_mask:0xf
    v_mov_b32 v44, v21
    s_nop 1
    v_permlane16_swap_b32 v21, v44
    v_add_f32 v21, v21, v44
    v_mov_b32 v44, v21
    s_nop 1
    v_permlane32_swap_b32 v21, v44
    v_add_f32 v21, v21, v44
    v_mul_f32 v22, s30, v20
    v_mov_b32 v23, v21
    v_bfe_u32 v40, v1, 3, 1
    v_lshlrev_b32 v41, 9, v40
    v_lshrrev_b32 v42, 4, v1
    v_lshl_add_u32 v41, v42, 7, v41
    v_and_b32 v42, 7, v1
    v_lshl_add_u32 v41, v42, 2, v41
    s_lshl_b32 s44, s24, 10
    s_add_u32 s44, s44, 122880
    v_add_u32 v41, s44, v41
    ds_write_b32 v41, v16 offset:0
    ds_write_b32 v41, v17 offset:32
    ds_write_b32 v41, v18 offset:64
    ds_write_b32 v41, v19 offset:96
    s_lshl_b32 s44, s24, 3
    s_add_u32 s44, s44, 126976
    v_lshlrev_b32 v40, 5, v40
    v_add_u32 v40, s44, v40
    ds_write_b64 v40, v[22:23]
    v_lshlrev_b32 v40, 2, v0
    v_add_u32 v40, 128000, v40
    ds_write_b32 v40, v50
    s_nop 0
LCNT:
    s_waitcnt vmcnt(0)
    v_readfirstlane_b32 s44, v49
    s_cmp_ge_u32 s44, 256
    s_nop 3
    s_cbranch_scc1 LCNTOK
    v_mov_b32 v48, 0
    buffer_load_dword v49, v48, s[20:23], 0 offen sc1
    s_cmp_eq_u32 s38, 0
    s_cbranch_scc1 LCNTOK
    s_sub_u32 s38, s38, 1
    s_sleep 1
    s_branch LCNT
LCNTOK:
    s_waitcnt lgkmcnt(0)
    s_barrier
    v_lshlrev_b32 v8, 2, v0
    v_add_u32 v8, 122880, v8
    s_lshr_b32 s44, s24, 1
    s_lshl_b32 s44, s44, 5
    s_add_u32 s44, s44, 126976
    v_mov_b32 v9, s44
    ds_read_b128 v[12:15], v9
    ds_read_b128 v[16:19], v9 offset:16
    ds_read_b32 v20, v8 offset:0
    ds_read_b32 v21, v8 offset:1024
    ds_read_b32 v22, v8 offset:2048
    ds_read_b32 v23, v8 offset:3072
    s_waitcnt lgkmcnt(4)
    v_max3_f32 v26, v12, v14, v16
    v_max_f32 v26, v26, v18
    v_sub_f32 v12, v12, v26
    v_sub_f32 v14, v14, v26
    v_sub_f32 v16, v16, v26
    v_sub_f32 v18, v18, v26
    v_exp_f32 v12, v12
    v_exp_f32 v14, v14
    v_exp_f32 v16, v16
    v_exp_f32 v18, v18
    v_mul_f32 v27, v13, v12
    v_fmac_f32 v27, v15, v14
    v_fmac_f32 v27, v17, v16
    v_fmac_f32 v27, v19, v18
    s_waitcnt lgkmcnt(0)
    v_mul_f32 v24, v20, v12
    v_fmac_f32 v24, v21, v14
    v_fmac_f32 v24, v22, v16
    v_fmac_f32 v24, v23, v18
    s_mul_i32 s44, s2, 1280
    s_add_u32 s44, s44, s39
    v_lshlrev_b32 v8, 2, v0
    buffer_store_dword v24, v8, s[12:15], s44 offen sc1
    s_lshl_b32 s45, s24, 6
    v_mov_b32 v9, s45
    s_bitcmp0_b32 s24, 0
    s_nop 0
    s_cbranch_scc0 LPUB1
    s_mov_b64 exec, 1
    buffer_store_dwordx2 v[26:27], v9, s[12:15], s44 offen offset:1024 sc1
    s_mov_b64 exec, -1
LPUB1:
    s_cmp_eq_u32 s31, 0
    s_cbranch_scc0 LPUB2
    s_getreg_b32 s47, hwreg(HW_REG_XCC_ID)
    s_bfe_u32 s47, s47, 0x10002
    s_add_u32 s88, s88, 4096
    s_addc_u32 s89, s89, 0
    s_mov_b32 s63, 0
    s_cmp_gt_i32 s98, 0
    s_cselect_b32 s61, 1, 0
    s_xor_b32 s61, s61, s47
    s_lshl_b32 s61, s61, 13
    s_xor_b32 s98, s98, s99
    s_cmp_lt_i32 s98, 0
    s_cselect_b32 s62, 8192, 0
    s_mov_b32 s98, 14
    s_mov_b32 s99, 8192
    s_mov_b32 s90, 1
    s_lshr_b32 s59, s61, 11
    s_atomic_add s90, s[88:89], s59 glc
LPUB2:
    s_cmp_lt_u32 s27, 18
    s_cbranch_scc1 LSTC
    s_cmp_lt_u32 s27, 30
    s_cbranch_scc0 LSTQ
    s_sub_u32 s47, s27, 18
    s_lshl_b32 s46, s28, 1
    s_cmp_ge_u32 s47, 6
    s_addc_u32 s46, s46, 0
    s_cmp_ge_u32 s47, 6
    s_cselect_b32 s48, 6, 0
    s_sub_u32 s47, s47, s48
    s_mul_i32 s48, s46, 20480
    s_add_u32 s48, s48, s39
    s_add_u32 s49, s48, 5120
    s_add_u32 s50, s48, 10240
    s_add_u32 s51, s48, 15360
    v_lshlrev_b32 v8, 2, v0
    v_and_b32 v9, 15, v1
    v_mul_u32_u24 v9, 1280, v9
    s_lshr_b32 s44, s24, 1
    s_lshl_b32 s44, s44, 7
    v_add_u32 v9, s44, v9
    v_lshlrev_b32 v10, 1, v0
    v_add_u32 v10, 127488, v10
    s_mul_i32 s44, s24, 16384
    v_lshlrev_b32 v58, 3, v1
    v_add_u32 v58, s44, v58
    v_lshrrev_b32 v57, 4, v1
    v_lshlrev_b32 v57, 4, v57
    v_add_u32 v57, 127488, v57
    s_nop 1
LE1:
    buffer_load_dwordx2 v[28:29], v9, s[12:15], s48 offen offset:1024 sc1
    buffer_load_dword v12, v8, s[12:15], s48 offen offset:0 sc1
    buffer_load_dword v13, v8, s[12:15], s48 offen offset:1280 sc1
    buffer_load_dword v14, v8, s[12:15], s48 offen offset:2560 sc1
    buffer_load_dword v15, v8, s[12:15], s48 offen offset:3840 sc1
    buffer_load_dword v16, v8, s[12:15], s49 offen offset:0 sc1
    buffer_load_dword v17, v8, s[12:15], s49 offen offset:1280 sc1
    buffer_load_dword v18, v8, s[12:15], s49 offen offset:2560 sc1
    buffer_load_dword v19, v8, s[12:15], s49 offen offset:3840 sc1
    buffer_load_dword v20, v8, s[12:15], s50 offen offset:0 sc1
    buffer_load_dword v21, v8, s[12:15], s50 offen offset:1280 sc1
    buffer_load_dword v22, v8, s[12:15], s50 offen offset:2560 sc1
    buffer_load_dword v23, v8, s[12:15], s50 offen offset:3840 sc1
    buffer_load_dword v24, v8, s[12:15], s51 offen offset:0 sc1
    buffer_load_dword v25, v8, s[12:15], s51 offen offset:1280 sc1
    buffer_load_dword v26, v8, s[12:15], s51 offen offset:2560 sc1
    buffer_load_dword v27, v8, s[12:15], s51 offen offset:3840 sc1
    s_waitcnt vmcnt(16)
    v_cmp_u_f32 vcc, v28, v29
    s_nop 4
    s_cbranch_vccnz LE1R
    v_max_f32_dpp v30, v28, v28 quad_perm:[1,0,3,2] row_mask:0xf bank_mask:0xf
    s_nop 1
    v_max_f32_dpp v30, v30, v30 quad_perm:[2,3,0,1] row_mask:0xf bank_mask:0xf
    s_nop 1
    v_max_f32_dpp v30, v30, v30 row_half_mirror row_mask:0xf bank_mask:0xf
    s_nop 1
    v_max_f32_dpp v30, v30, v30 row_mirror row_mask:0xf bank_mask:0xf
    v_sub_f32 v28, v28, v30
    v_exp_f32 v28, v28
    s_nop 0
    v_mul_f32 v29, v29, v28
    s_nop 1
    v_add_f32_dpp v29, v29, v29 quad_perm:[1,0,3,2] row_mask:0xf bank_mask:0xf
    s_nop 1
    v_add_f32_dpp v29, v29, v29 quad_perm:[2,3,0,1] row_mask:0xf bank_mask:0xf
    s_nop 1
    v_add_f32_dpp v29, v29, v29 row_half_mirror row_mask:0xf bank_mask:0xf
    s_nop 1
    v_add_f32_dpp v29, v29, v29 row_mirror row_mask:0xf bank_mask:0xf
    v_rcp_f32 v29, v29
    s_nop 0
    v_mul_f32 v28, v28, v29
    s_waitcnt vmcnt(0)
    s_nop 0
    v_mul_f32_dpp v32, v28, v12 row_newbcast:0 row_mask:0xf bank_mask:0xf
    v_mul_f32_dpp v33, v28, v13 row_newbcast:1 row_mask:0xf bank_mask:0xf
    v_mul_f32_dpp v34, v28, v14 row_newbcast:2 row_mask:0xf bank_mask:0xf
    v_mul_f32_dpp v35, v28, v15 row_newbcast:3 row_mask:0xf bank_mask:0xf
    v_fmac_f32_dpp v32, v28, v16 row_newbcast:4 row_mask:0xf bank_mask:0xf
    v_fmac_f32_dpp v33, v28, v17 row_newbcast:5 row_mask:0xf bank_mask:0xf
    v_fmac_f32_dpp v34, v28, v18 row_newbcast:6 row_mask:0xf bank_mask:0xf
    v_fmac_f32_dpp v35, v28, v19 row_newbcast:7 row_mask:0xf bank_mask:0xf
    v_fmac_f32_dpp v32, v28, v20 row_newbcast:8 row_mask:0xf bank_mask:0xf
    v_fmac_f32_dpp v33, v28, v21 row_newbcast:9 row_mask:0xf bank_mask:0xf
    v_fmac_f32_dpp v34, v28, v22 row_newbcast:10 row_mask:0xf bank_mask:0xf
    v_fmac_f32_dpp v35, v28, v23 row_newbcast:11 row_mask:0xf bank_mask:0xf
    v_fmac_f32_dpp v32, v28, v24 row_newbcast:12 row_mask:0xf bank_mask:0xf
    v_fmac_f32_dpp v33, v28, v25 row_newbcast:13 row_mask:0xf bank_mask:0xf
    v_fmac_f32_dpp v34, v28, v26 row_newbcast:14 row_mask:0xf bank_mask:0xf
    v_fmac_f32_dpp v35, v28, v27 row_newbcast:15 row_mask:0xf bank_mask:0xf
    v_add_f32 v32, v32, v33
    v_add_f32 v34, v34, v35
    v_add_f32 v32, v32, v34
    v_cmp_u_f32 vcc, v32, v32
    s_nop 4
    s_cbranch_vccz LE1OK
LE1R:
    s_cmp_eq_u32 s38, 0
    s_cbranch_scc1 LE1OK
    s_sub_u32 s38, s38, 1
    s_sleep 1
    s_branch LE1
LE1OK:
    s_waitcnt vmcnt(0)
    v_cvt_pk_bf16_f32 v32, v32, v32
    ds_write_b16 v10, v32
    s_waitcnt lgkmcnt(0)
    s_barrier
    s_cmp_eq_u32 s24, 3
    s_cbranch_scc1 LSTQ
    ds_read_b128 v[8:11], v57 offset:0
    ds_read_b64_tr_b16 v[12:13], v58 offset:0
    ds_read_b64_tr_b16 v[14:15], v58 offset:512
    ds_read_b64_tr_b16 v[16:17], v58 offset:8192
    ds_read_b64_tr_b16 v[18:19], v58 offset:8704
    ds_read_b128 v[20:23], v57 offset:64
    ds_read_b64_tr_b16 v[24:25], v58 offset:1024
    ds_read_b64_tr_b16 v[26:27], v58 offset:1536
    ds_read_b64_tr_b16 v[28:29], v58 offset:9216
    ds_read_b64_tr_b16 v[30:31], v58 offset:9728
    ds_read_b128 v[32:35], v57 offset:128
    ds_read_b64_tr_b16 v[36:37], v58 offset:2048
    ds_read_b64_tr_b16 v[38:39], v58 offset:2560
    ds_read_b64_tr_b16 v[40:41], v58 offset:10240
    ds_read_b64_tr_b16 v[42:43], v58 offset:10752
    s_waitcnt lgkmcnt(10)
    v_mfma_f32_16x16x32_bf16 v[48:51], v[8:11], v[12:15], 0
    v_mfma_f32_16x16x32_bf16 v[52:55], v[8:11], v[16:19], 0
    ds_read_b128 v[8:11], v57 offset:192
    ds_read_b64_tr_b16 v[12:13], v58 offset:3072
    ds_read_b64_tr_b16 v[14:15], v58 offset:3584
    ds_read_b64_tr_b16 v[16:17], v58 offset:11264
    ds_read_b64_tr_b16 v[18:19], v58 offset:11776
    s_waitcnt lgkmcnt(10)
    v_mfma_f32_16x16x32_bf16 v[48:51], v[20:23], v[24:27], v[48:51]
    v_mfma_f32_16x16x32_bf16 v[52:55], v[20:23], v[28:31], v[52:55]
    ds_read_b128 v[20:23], v57 offset:256
    ds_read_b64_tr_b16 v[24:25], v58 offset:4096
    ds_read_b64_tr_b16 v[26:27], v58 offset:4608
    ds_read_b64_tr_b16 v[28:29], v58 offset:12288
    ds_read_b64_tr_b16 v[30:31], v58 offset:12800
    s_waitcnt lgkmcnt(10)
    v_mfma_f32_16x16x32_bf16 v[48:51], v[32:35], v[36:39], v[48:51]
    v_mfma_f32_16x16x32_bf16 v[52:55], v[32:35], v[40:43], v[52:55]
    ds_read_b128 v[32:35], v57 offset:320
    ds_read_b64_tr_b16 v[36:37], v58 offset:5120
    ds_read_b64_tr_b16 v[38:39], v58 offset:5632
    ds_read_b64_tr_b16 v[40:41], v58 offset:13312
    ds_read_b64_tr_b16 v[42:43], v58 offset:13824
    s_waitcnt lgkmcnt(10)
    v_mfma_f32_16x16x32_bf16 v[48:51], v[8:11], v[12:15], v[48:51]
    v_mfma_f32_16x16x32_bf16 v[52:55], v[8:11], v[16:19], v[52:55]
    ds_read_b128 v[8:11], v57 offset:384
    ds_read_b64_tr_b16 v[12:13], v58 offset:6144
    ds_read_b64_tr_b16 v[14:15], v58 offset:6656
    ds_read_b64_tr_b16 v[16:17], v58 offset:14336
    ds_read_b64_tr_b16 v[18:19], v58 offset:14848
    s_waitcnt lgkmcnt(10)
    v_mfma_f32_16x16x32_bf16 v[48:51], v[20:23], v[24:27], v[48:51]
    v_mfma_f32_16x16x32_bf16 v[52:55], v[20:23], v[28:31], v[52:55]
    ds_read_b128 v[20:23], v57 offset:448
    ds_read_b64_tr_b16 v[24:25], v58 offset:7168
    ds_read_b64_tr_b16 v[26:27], v58 offset:7680
    ds_read_b64_tr_b16 v[28:29], v58 offset:15360
    ds_read_b64_tr_b16 v[30:31], v58 offset:15872
    s_waitcnt lgkmcnt(10)
    v_mfma_f32_16x16x32_bf16 v[48:51], v[32:35], v[36:39], v[48:51]
    v_mfma_f32_16x16x32_bf16 v[52:55], v[32:35], v[40:43], v[52:55]
    s_waitcnt lgkmcnt(5)
    v_mfma_f32_16x16x32_bf16 v[48:51], v[8:11], v[12:15], v[48:51]
    v_mfma_f32_16x16x32_bf16 v[52:55], v[8:11], v[16:19], v[52:55]
    s_waitcnt lgkmcnt(0)
    v_mfma_f32_16x16x32_bf16 v[48:51], v[20:23], v[24:27], v[48:51]
    v_mfma_f32_16x16x32_bf16 v[52:55], v[20:23], v[28:31], v[52:55]
    s_mul_i32 s44, s46, 2304
    s_mul_i32 s45, s47, 384
    s_add_u32 s44, s44, s45
    s_lshl_b32 s45, s24, 7
    s_add_u32 s44, s44, s45
    s_add_u32 s44, s44, s39
    s_add_u32 s44, s44, 327680
    s_mov_b32 s48, 0xffff0000
    s_mov_b32 s49, 0xffff0000
    v_lshlrev_b32 v8, 2, v1
    v_cndmask_b32 v48, v48, v52, s[48:49]
    s_mov_b32 exec_hi, 0
    buffer_store_dword v48, v8, s[12:15], s44 offen sc1
    s_mov_b64 exec, -1
    s_branch LSTQ
LSTC:
    s_cmp_eq_u32 s31, 0
    s_cbranch_scc0 LSTC0
    s_load_dwordx2 s[32:33], s[0:1], 48
    s_load_dwordx2 s[44:45], s[0:1], 56
    s_load_dwordx2 s[48:49], s[0:1], 64
    v_lshrrev_b32 v4, 2, v1
    v_and_b32 v5, 3, v1
    v_mul_u32_u24 v60, 9216, v4
    v_lshl_add_u32 v60, v5, 4, v60
    v_mul_u32_u24 v61, 18432, v5
    v_and_b32 v5, 3, v4
    v_lshl_add_u32 v61, v5, 5, v61
    v_bfe_u32 v5, v4, 2, 1
    v_lshl_add_u32 v61, v5, 9, v61
    v_lshrrev_b32 v5, 3, v4
    v_lshl_add_u32 v61, v5, 7, v61
    s_mul_i32 s52, s24, 9
    s_add_u32 s52, s52, 1
    s_lshr_b32 s53, s52, 1
    s_lshl_b32 s53, s53, 10
    s_and_b32 s52, s52, 1
    s_lshl_b32 s52, s52, 8
    s_add_u32 s52, s52, s53
    v_add_u32 v62, s52, v61
    s_mul_i32 s52, s24, 9
    s_add_u32 s52, s52, 0
    s_lshr_b32 s53, s52, 1
    s_lshl_b32 s53, s53, 10
    s_and_b32 s52, s52, 1
    s_lshl_b32 s52, s52, 8
    s_add_u32 s52, s52, s53
    v_add_u32 v61, s52, v61
    s_mul_i32 s52, s24, 9216
    s_add_u32 s53, s52, 73728
    v_add_u32 v63, s53, v3
    s_mul_i32 s53, s28, 18
    s_add_u32 s53, s53, s27
    s_mul_i32 s54, s53, 36864
    s_add_u32 s54, s54, s52
    s_lshl_b32 s53, s53, 6
    s_mul_i32 s52, s24, 1327104
    s_add_u32 s52, s52, s53
    s_mov_b32 s34, 5308416
    s_mov_b32 s35, 0x20000
    s_mov_b32 s46, 5308416
    s_mov_b32 s47, 0x20000
    s_mov_b32 s50, 5308416
    s_mov_b32 s51, 0x20000
    s_waitcnt lgkmcnt(0)
    s_and_b32 s33, s33, 0xffff
    s_and_b32 s45, s45, 0xffff
    s_and_b32 s49, s49, 0xffff
    buffer_load_dwordx4 v[8:11], v3, s[48:51], s54 offen nt
    s_add_u32 s54, s54, 1024
    buffer_load_dwordx4 v[12:15], v3, s[48:51], s54 offen nt
    s_add_u32 s54, s54, 1024
    buffer_load_dwordx4 v[16:19], v3, s[48:51], s54 offen nt
    s_add_u32 s54, s54, 1024
    buffer_load_dwordx4 v[20:23], v3, s[48:51], s54 offen nt
    s_add_u32 s54, s54, 1024
    buffer_load_dwordx4 v[24:27], v3, s[48:51], s54 offen nt
    s_add_u32 s54, s54, 1024
    buffer_load_dwordx4 v[28:31], v3, s[48:51], s54 offen nt
    s_add_u32 s54, s54, 1024
    buffer_load_dwordx4 v[32:35], v3, s[48:51], s54 offen nt
    s_add_u32 s54, s54, 1024
    buffer_load_dwordx4 v[36:39], v3, s[48:51], s54 offen nt
    s_add_u32 s54, s54, 1024
    buffer_load_dwordx4 v[40:43], v3, s[48:51], s54 offen nt
    s_add_u32 s54, s54, 1024
    s_waitcnt vmcnt(8)
    ds_write_b128 v63, v[8:11] offset:0
    s_waitcnt vmcnt(7)
    ds_write_b128 v63, v[12:15] offset:1024
    s_waitcnt vmcnt(6)
    ds_write_b128 v63, v[16:19] offset:2048
    s_waitcnt vmcnt(5)
    ds_write_b128 v63, v[20:23] offset:3072
    s_waitcnt vmcnt(4)
    ds_write_b128 v63, v[24:27] offset:4096
    s_waitcnt vmcnt(3)
    ds_write_b128 v63, v[28:31] offset:5120
    s_waitcnt vmcnt(2)
    ds_write_b128 v63, v[32:35] offset:6144
    s_waitcnt vmcnt(1)
    ds_write_b128 v63, v[36:39] offset:7168
    s_waitcnt vmcnt(0)
    ds_write_b128 v63, v[40:43] offset:8192
LSTC0:
    s_mov_b32 s44, 122880
    s_mul_i32 s45, s24, 18432
    v_add_u32 v2, s44, v3
    v_mov_b32 v57, s44
    v_mov_b32 v58, 129088
    s_mov_b32 s46, 0x00020002
    s_mov_b32 s47, 0x00020002
    v_cndmask_b32 v57, v57, v58, s[46:47]
    v_lshrrev_b32 v58, 4, v1
    v_lshl_add_u32 v57, v58, 4, v57
    v_lshlrev_b32 v58, 3, v1
    v_add_u32 v58, s45, v58
    v_lshrrev_b32 v5, 4, v1
    v_lshlrev_b32 v4, 3, v5
    v_bfe_u32 v6, v1, 2, 2
    v_add_u32 v4, v4, v6
    v_mul_u32_u24 v4, 1152, v4
    v_and_b32 v6, 3, v1
    v_lshl_add_u32 v4, v6, 3, v4
    s_lshl_b32 s44, s24, 7
    s_add_u32 s44, s44, 73728
    v_add_u32 v4, s44, v4
    v_lshlrev_b32 v5, 4, v5
    v_add_u32 v5, 111104, v5
    s_lshl_b32 s44, s24, 4
    s_add_u32 s44, s44, 111104
    v_lshlrev_b32 v6, 1, v1
    v_add_u32 v6, s44, v6
    v_lshrrev_b32 v7, 5, v1
    v_mul_u32_u24 v7, 18432, v7
    v_and_b32 v59, 31, v1
    v_lshl_add_u32 v7, v59, 2, v7
    s_mul_i32 s50, s28, 18
    s_add_u32 s50, s50, s27
    s_lshl_b32 s50, s50, 7
    s_mul_i32 s45, s24, 36864
    s_add_u32 s50, s50, s45
    s_add_u32 s50, s50, s39
    s_add_u32 s50, s50, 364544
    s_mov_b32 s52, 0xffff0000
    s_mov_b32 s53, 0xffff0000
    s_mov_b32 s40, 0
    s_mov_b32 s41, -1
    s_cmp_eq_u32 s24, 3
    s_cbranch_scc0 LC_G
    v_and_b32 v8, 15, v1
    v_mul_u32_u24 v8, 2304, v8
    v_lshrrev_b32 v9, 4, v1
    v_mul_u32_u24 v9, 384, v9
    v_add_u32 v8, v8, v9
    s_add_u32 s44, s39, 327680
    v_mov_b32 v11, 0
    s_nop 1
LE2W:
    buffer_load_dword v10, v8, s[12:15], s44 offen offset:256 sc1
    s_waitcnt vmcnt(0)
    v_cmp_u_f32 vcc, v10, v11
    s_nop 4
    s_cbranch_vccz LE2WOK
    s_cmp_eq_u32 s38, 0
    s_cbranch_scc1 LE2WOK
    s_sub_u32 s38, s38, 1
    s_sleep 1
    s_branch LE2W
LE2WOK:
    s_barrier
    s_branch LC_BAR
LC_G:
    v_lshrrev_b32 v56, 4, v1
    v_mul_u32_u24 v56, 2304, v56
    v_and_b32 v8, 15, v1
    v_lshl_add_u32 v56, v8, 4, v56
    s_mul_i32 s48, s24, 768
    s_add_u32 s44, s48, s39
    s_add_u32 s44, s44, 327680
    s_add_u32 s45, s44, 9216
    s_add_u32 s46, s44, 18432
    s_add_u32 s47, s44, 27648
    v_bfe_u32 v9, v1, 4, 1
    v_lshlrev_b32 v9, 1, v9
    v_lshrrev_b32 v10, 5, v1
    v_add_u32 v9, v9, v10
    v_lshl_add_u32 v9, v8, 2, v9
    v_lshrrev_b32 v10, 5, v9
    v_lshlrev_b32 v10, 6, v10
    v_lshl_add_u32 v10, v9, 1, v10
    s_add_u32 s49, s48, 827392
    s_lshr_b32 s48, s48, 1
    v_lshlrev_b32 v9, 1, v9
    v_add_u32 v9, s48, v9
    v_add_u32 v59, 122880, v9
    s_cmp_eq_u32 s31, 0
    s_nop 0
    s_cbranch_scc0 LC_X2
    s_load_dwordx2 s[32:33], s[0:1], 0
    s_mov_b32 s34, 1152
    s_mov_b32 s35, 0x20000
    s_waitcnt lgkmcnt(0)
    s_and_b32 s33, s33, 0xffff
    buffer_load_ushort v60, v9, s[32:35], 0 offen offset:0
    buffer_load_ushort v61, v9, s[32:35], 0 offen offset:128
    buffer_load_ushort v62, v9, s[32:35], 0 offen offset:256
    s_branch LC_X3
LC_X2:
    buffer_load_ushort v60, v10, s[12:15], s49 offen offset:0 sc1
    buffer_load_ushort v61, v10, s[12:15], s49 offen offset:256 sc1
    buffer_load_ushort v62, v10, s[12:15], s49 offen offset:512 sc1
LC_X3:
    s_waitcnt vmcnt(0)
    v_lshlrev_b32 v60, 16, v60
    v_lshlrev_b32 v61, 16, v61
    v_lshlrev_b32 v62, 16, v62
    s_barrier
    s_nop 0
LE2:
    buffer_load_dwordx4 v[8:11], v56, s[12:15], s44 offen offset:0 sc1
    buffer_load_dwordx4 v[12:15], v56, s[12:15], s45 offen offset:0 sc1
    buffer_load_dwordx4 v[16:19], v56, s[12:15], s46 offen offset:0 sc1
    buffer_load_dwordx4 v[20:23], v56, s[12:15], s47 offen offset:0 sc1
    buffer_load_dwordx4 v[24:27], v56, s[12:15], s44 offen offset:256 sc1
    buffer_load_dwordx4 v[28:31], v56, s[12:15], s45 offen offset:256 sc1
    buffer_load_dwordx4 v[32:35], v56, s[12:15], s46 offen offset:256 sc1
    buffer_load_dwordx4 v[36:39], v56, s[12:15], s47 offen offset:256 sc1
    buffer_load_dwordx4 v[40:43], v56, s[12:15], s44 offen offset:512 sc1
    buffer_load_dwordx4 v[44:47], v56, s[12:15], s45 offen offset:512 sc1
    buffer_load_dwordx4 v[48:51], v56, s[12:15], s46 offen offset:512 sc1
    buffer_load_dwordx4 v[52:55], v56, s[12:15], s47 offen offset:512 sc1
    s_waitcnt vmcnt(8)
    v_add_f32 v8, v8, v12
    v_add_f32 v16, v16, v20
    v_add_f32 v9, v9, v13
    v_add_f32 v17, v17, v21
    v_add_f32 v10, v10, v14
    v_add_f32 v18, v18, v22
    v_add_f32 v11, v11, v15
    v_add_f32 v19, v19, v23
    v_add_f32 v8, v8, v16
    v_add_f32 v9, v9, v17
    v_add_f32 v10, v10, v18
    v_add_f32 v11, v11, v19
    v_cmp_u_f32 vcc, v8, v11
    s_nop 4
    s_cbranch_vccnz LE2R
    v_permlane32_swap_b32 v8, v9
    v_permlane32_swap_b32 v10, v11
    v_add_f32 v8, v8, v9
    v_add_f32 v10, v10, v11
    s_nop 1
    v_permlane16_swap_b32 v8, v10
    v_add_f32 v8, v8, v10
    s_waitcnt vmcnt(4)
    v_add_f32 v24, v24, v28
    v_add_f32 v32, v32, v36
    v_add_f32 v25, v25, v29
    v_add_f32 v33, v33, v37
    v_add_f32 v26, v26, v30
    v_add_f32 v34, v34, v38
    v_add_f32 v27, v27, v31
    v_add_f32 v35, v35, v39
    v_add_f32 v24, v24, v32
    v_add_f32 v25, v25, v33
    v_add_f32 v26, v26, v34
    v_add_f32 v27, v27, v35
    v_cmp_u_f32 vcc, v24, v27
    s_nop 4
    s_cbranch_vccnz LE2R
    v_permlane32_swap_b32 v24, v25
    v_permlane32_swap_b32 v26, v27
    v_add_f32 v24, v24, v25
    v_add_f32 v26, v26, v27
    s_nop 1
    v_permlane16_swap_b32 v24, v26
    v_add_f32 v24, v24, v26
    s_waitcnt vmcnt(0)
    v_add_f32 v40, v40, v44
    v_add_f32 v48, v48, v52
    v_add_f32 v41, v41, v45
    v_add_f32 v49, v49, v53
    v_add_f32 v42, v42, v46
    v_add_f32 v50, v50, v54
    v_add_f32 v43, v43, v47
    v_add_f32 v51, v51, v55
    v_add_f32 v40, v40, v48
    v_add_f32 v41, v41, v49
    v_add_f32 v42, v42, v50
    v_add_f32 v43, v43, v51
    v_permlane32_swap_b32 v40, v41
    s_nop 0
    v_permlane32_swap_b32 v42, v43
    v_add_f32 v40, v40, v41
    v_add_f32 v42, v42, v43
    s_nop 1
    v_permlane16_swap_b32 v40, v42
    v_add_f32 v40, v40, v42
    v_add_f32 v9, v8, v24
    v_cmp_u_f32 vcc, v9, v40
    s_nop 4
    s_cbranch_vccz LE2OK
LE2R:
    s_cmp_eq_u32 s38, 0
    s_cbranch_scc1 LE2OK
    s_sub_u32 s38, s38, 1
    s_sleep 1
    s_branch LE2
LE2OK:
    s_waitcnt vmcnt(0)
    v_cvt_pk_bf16_f32 v8, v8, v8
    v_and_b32 v8, 0xffff0000, v8
    v_cvt_pk_bf16_f32 v24, v24, v24
    v_and_b32 v24, 0xffff0000, v24
    v_cvt_pk_bf16_f32 v40, v40, v40
    v_and_b32 v40, 0xffff0000, v40
    v_add_f32 v60, v60, v8
    v_add_f32 v61, v61, v24
    v_add_f32 v62, v62, v40
    v_cvt_pk_bf16_f32 v60, v60, v60
    v_cvt_pk_bf16_f32 v61, v61, v61
    v_cvt_pk_bf16_f32 v62, v62, v62
    ds_write_b16 v59, v60 offset:0
    ds_write_b16 v59, v61 offset:128
    ds_write_b16 v59, v62 offset:256
LC_BAR:
    s_waitcnt lgkmcnt(0)
    s_barrier
    s_call_b64 s[36:37], LLNG
    v_mov_b32_dpp v41, v60 row_shl:8 row_mask:0xf bank_mask:0xf bound_ctrl:1
    v_cvt_pk_bf16_f32 v41, v60, v41
    v_lshlrev_b32 v42, 16, v41
    v_and_b32 v41, 0xffff0000, v41
    v_max_f32 v42, 0, v42
    v_mul_f32 v41, v42, v41
    v_cvt_pk_bf16_f32 v41, v41, v41
    s_mov_b64 exec, 0xff
    ds_write_b16 v6, v41
    s_mov_b64 exec, -1
    ds_read_b64_tr_b16 v[8:9], v4 offset:0
    ds_read_b64_tr_b16 v[10:11], v4 offset:4608
    ds_read_b64_tr_b16 v[12:13], v4 offset:32
    ds_read_b64_tr_b16 v[14:15], v4 offset:4640
    ds_read_b64_tr_b16 v[16:17], v4 offset:64
    ds_read_b64_tr_b16 v[18:19], v4 offset:4672
    ds_read_b64_tr_b16 v[20:21], v4 offset:96
    ds_read_b64_tr_b16 v[22:23], v4 offset:4704
    s_waitcnt lgkmcnt(8)
    s_barrier
    ds_read_b128 v[60:63], v5
    s_waitcnt lgkmcnt(5)
    ds_read_b64_tr_b16 v[24:25], v4 offset:512
    ds_read_b64_tr_b16 v[26:27], v4 offset:5120
    ds_read_b64_tr_b16 v[28:29], v4 offset:544
    ds_read_b64_tr_b16 v[30:31], v4 offset:5152
    ds_read_b64_tr_b16 v[32:33], v4 offset:576
    ds_read_b64_tr_b16 v[34:35], v4 offset:5184
    ds_read_b64_tr_b16 v[36:37], v4 offset:608
    ds_read_b64_tr_b16 v[38:39], v4 offset:5216
    s_waitcnt lgkmcnt(8)
    v_mfma_f32_16x16x32_bf16 v[40:43], v[60:63], v[8:11], 0
    v_mfma_f32_16x16x32_bf16 v[44:47], v[60:63], v[12:15], 0
    v_mfma_f32_16x16x32_bf16 v[48:51], v[60:63], v[16:19], 0
    v_mfma_f32_16x16x32_bf16 v[52:55], v[60:63], v[20:23], 0
    s_nop 5
    v_cndmask_b32 v40, v40, v44, s[52:53]
    s_nop 0
    v_cndmask_b32 v48, v48, v52, s[52:53]
    v_cndmask_b32 v40, v40, v48, s[40:41]
    buffer_store_dword v40, v7, s[12:15], s50 offen sc1
    s_add_u32 s50, s50, 147456
    s_cmp_eq_u32 s24, 0
    s_cbranch_scc1 LDOWN3
    s_waitcnt lgkmcnt(0)
    v_mfma_f32_16x16x32_bf16 v[40:43], v[60:63], v[24:27], 0
    v_mfma_f32_16x16x32_bf16 v[44:47], v[60:63], v[28:31], 0
    v_mfma_f32_16x16x32_bf16 v[48:51], v[60:63], v[32:35], 0
    v_mfma_f32_16x16x32_bf16 v[52:55], v[60:63], v[36:39], 0
    s_nop 5
    v_cndmask_b32 v40, v40, v44, s[52:53]
    s_nop 0
    v_cndmask_b32 v48, v48, v52, s[52:53]
    v_cndmask_b32 v40, v40, v48, s[40:41]
    buffer_store_dword v40, v7, s[12:15], s50 offen sc1
    s_add_u32 s50, s50, 147456
    s_branch LSTD
LDOWN3:
    s_waitcnt lgkmcnt(0)
    ds_read_b64_tr_b16 v[8:9], v4 offset:1024
    ds_read_b64_tr_b16 v[10:11], v4 offset:5632
    ds_read_b64_tr_b16 v[12:13], v4 offset:1056
    ds_read_b64_tr_b16 v[14:15], v4 offset:5664
    ds_read_b64_tr_b16 v[16:17], v4 offset:1088
    ds_read_b64_tr_b16 v[18:19], v4 offset:5696
    ds_read_b64_tr_b16 v[20:21], v4 offset:1120
    ds_read_b64_tr_b16 v[22:23], v4 offset:5728
    s_waitcnt lgkmcnt(8)
    v_mfma_f32_16x16x32_bf16 v[40:43], v[60:63], v[24:27], 0
    v_mfma_f32_16x16x32_bf16 v[44:47], v[60:63], v[28:31], 0
    v_mfma_f32_16x16x32_bf16 v[48:51], v[60:63], v[32:35], 0
    v_mfma_f32_16x16x32_bf16 v[52:55], v[60:63], v[36:39], 0
    s_nop 5
    v_cndmask_b32 v40, v40, v44, s[52:53]
    s_nop 0
    v_cndmask_b32 v48, v48, v52, s[52:53]
    v_cndmask_b32 v40, v40, v48, s[40:41]
    buffer_store_dword v40, v7, s[12:15], s50 offen sc1
    s_add_u32 s50, s50, 147456
    s_waitcnt lgkmcnt(0)
    v_mfma_f32_16x16x32_bf16 v[40:43], v[60:63], v[8:11], 0
    v_mfma_f32_16x16x32_bf16 v[44:47], v[60:63], v[12:15], 0
    v_mfma_f32_16x16x32_bf16 v[48:51], v[60:63], v[16:19], 0
    v_mfma_f32_16x16x32_bf16 v[52:55], v[60:63], v[20:23], 0
    s_nop 5
    v_cndmask_b32 v40, v40, v44, s[52:53]
    s_nop 0
    v_cndmask_b32 v48, v48, v52, s[52:53]
    v_cndmask_b32 v40, v40, v48, s[40:41]
    buffer_store_dword v40, v7, s[12:15], s50 offen sc1
    s_add_u32 s50, s50, 147456
LSTD:
    s_lshl_b32 s50, s27, 3
    s_add_u32 s50, s50, s28
    s_cmp_lt_u32 s50, 18
    s_cbranch_scc0 LSTQ
    s_mul_i32 s44, s50, 18432
    s_mul_i32 s45, s24, 4608
    s_add_u32 s44, s44, s45
    s_add_u32 s44, s44, s39
    s_add_u32 s44, s44, 364544
    s_add_u32 s45, s44, 4096
    v_bfe_u32 v58, v1, 4, 1
    v_lshlrev_b32 v58, 1, v58
    v_lshrrev_b32 v59, 5, v1
    v_add_u32 v58, v58, v59
    v_and_b32 v59, 7, v1
    v_lshl_add_u32 v58, v59, 2, v58
    v_lshlrev_b32 v58, 2, v58
    s_lshl_b32 s46, s24, 7
    s_add_u32 s46, s46, 110592
    v_add_u32 v58, s46, v58
    v_mov_b32 v24, 0
    v_mov_b32 v25, 0
    v_mov_b32 v26, 0
    v_mov_b32 v27, 0
    s_nop 1
LE3:
    buffer_load_dwordx4 v[8:11], v3, s[12:15], s44 offen offset:0 sc1
    buffer_load_dwordx4 v[12:15], v3, s[12:15], s44 offen offset:1024 sc1
    buffer_load_dwordx4 v[16:19], v3, s[12:15], s44 offen offset:2048 sc1
    buffer_load_dwordx4 v[20:23], v3, s[12:15], s44 offen offset:3072 sc1
    s_mov_b32 exec_hi, 0
    buffer_load_dwordx4 v[24:27], v3, s[12:15], s45 offen sc1
    s_mov_b64 exec, -1
    s_waitcnt vmcnt(0)
    v_add_f32 v8, v8, v12
    v_add_f32 v16, v16, v20
    v_add_f32 v9, v9, v13
    v_add_f32 v17, v17, v21
    v_add_f32 v10, v10, v14
    v_add_f32 v18, v18, v22
    v_add_f32 v11, v11, v15
    v_add_f32 v19, v19, v23
    v_add_f32 v8, v8, v24
    v_add_f32 v9, v9, v25
    v_add_f32 v10, v10, v26
    v_add_f32 v11, v11, v27
    v_add_f32 v8, v8, v16
    v_add_f32 v9, v9, v17
    v_add_f32 v10, v10, v18
    v_add_f32 v11, v11, v19
    v_permlane32_swap_b32 v8, v9
    s_nop 0
    v_permlane32_swap_b32 v10, v11
    v_add_f32 v8, v8, v9
    v_add_f32 v10, v10, v11
    s_nop 1
    v_permlane16_swap_b32 v8, v10
    v_add_f32 v8, v8, v10
    s_nop 1
    v_add_f32_dpp v8, v8, v8 row_ror:8 row_mask:0xf bank_mask:0xf
    v_cmp_u_f32 vcc, v8, v8
    s_nop 4
    s_cbranch_vccz LE3OK
    s_cmp_eq_u32 s38, 0
    s_cbranch_scc1 LE3OK
    s_sub_u32 s38, s38, 1
    s_sleep 1
    s_branch LE3
LE3OK:
    ds_write_b32 v58, v8
    v_lshlrev_b32 v8, 2, v1
    v_add_u32 v9, 110592, v8
    s_lshl_b32 s45, s50, 6
    s_add_u32 s46, s45, 122880
    v_lshlrev_b32 v8, 1, v1
    v_add_u32 v10, s46, v8
    s_waitcnt lgkmcnt(0)
    s_barrier
    s_cmp_eq_u32 s24, 0
    s_cbranch_scc0 LSTQ
    s_mov_b32 exec_hi, 0
    ds_read_b32 v12, v9 offset:0
    ds_read_b32 v13, v9 offset:128
    ds_read_b32 v14, v9 offset:256
    ds_read_b32 v15, v9 offset:384
    ds_read_u16 v16, v10
    s_waitcnt lgkmcnt(0)
    v_lshlrev_b32 v16, 16, v16
    v_add_f32 v12, v12, v13
    v_add_f32 v14, v14, v15
    v_add_f32 v12, v12, v14
    v_cvt_pk_bf16_f32 v12, v12, v12
    v_and_b32 v12, 0xffff0000, v12
    v_add_f32 v12, v12, v16
    s_nop 1
    v_mov_b32_dpp v13, v12 quad_perm:[1,1,3,3] row_mask:0xf bank_mask:0xf
    v_cvt_pk_bf16_f32 v12, v12, v13
    s_mov_b32 exec_lo, 0x55555555
    s_cmp_eq_u32 s31, 0
    s_cbranch_scc0 LFINAL
    s_lshl_b32 s45, s50, 7
    s_add_u32 s45, s45, s39
    s_add_u32 s45, s45, 696320
    buffer_store_dword v12, v8, s[12:15], s45 offen sc1
    s_mov_b64 exec, -1
    s_branch LSTQ
LFINAL:
    buffer_store_dword v12, v8, s[16:19], s45 offen
    s_mov_b64 exec, 1
    s_cmp_eq_u32 s50, 0
    s_cbranch_scc0 LNOEP
    v_mov_b32 v9, s29
    buffer_store_dword v9, v8, s[12:15], 0 offen sc1
    s_nop 0
LNOEP:
    s_mov_b64 exec, -1
LSTQ:
    s_cmp_eq_u32 s31, 0
    s_cbranch_scc0 LDONE
    s_cmp_ge_u32 s27, 24
    s_cbranch_scc0 LQ5
    s_mul_i32 s44, s24, 1152
    s_add_u32 s44, s44, 122880
    s_mul_i32 s45, s24, 18432
    s_add_u32 s45, s45, 49152
    v_add_u32 v2, s44, v3
    v_mov_b32 v57, s44
    v_mov_b32 v58, 129088
    s_mov_b32 s46, 0x00020002
    s_mov_b32 s47, 0x00020002
    v_cndmask_b32 v57, v57, v58, s[46:47]
    v_lshrrev_b32 v58, 4, v1
    v_lshl_add_u32 v57, v58, 4, v57
    v_lshlrev_b32 v58, 3, v1
    v_add_u32 v58, s45, v58
    s_lshl_b32 s54, s28, 3
    s_add_u32 s54, s54, s27
    s_sub_u32 s54, s54, 24
    s_lshl_b32 s54, s54, 2
    s_add_u32 s54, s54, s24
    s_lshl_b32 s54, s54, 7
    s_add_u32 s54, s54, 36864
    s_waitcnt lgkmcnt(0)
    s_add_u32 s44, s39, 696320
    v_lshrrev_b32 v16, 2, v1
    v_lshlrev_b32 v16, 7, v16
    v_and_b32 v17, 3, v1
    v_lshl_add_u32 v16, v17, 4, v16
    v_mov_b32 v12, 0
    v_mov_b32 v13, 0
    v_mov_b32 v14, 0
    v_mov_b32 v15, 0
    s_nop 1
LE4:
    buffer_load_dwordx4 v[8:11], v16, s[12:15], s44 offen sc1
    s_mov_b64 exec, 0xff
    buffer_load_dwordx4 v[12:15], v16, s[12:15], s44 offen offset:2048 sc1
    s_mov_b64 exec, -1
    s_waitcnt vmcnt(0)
    v_max3_u32 v17, v8, v9, v10
    v_max3_u32 v18, v11, v12, v13
    v_max3_u32 v17, v17, v14, v15
    v_max_u32 v17, v17, v18
    v_cmp_eq_u32 vcc, -1, v17
    s_nop 4
    s_cbranch_vccz LE4OK
    s_cmp_eq_u32 s38, 0
    s_cbranch_scc1 LE4OK
    s_sub_u32 s38, s38, 1
    s_sleep 1
    s_branch LE4
LE4OK:
    s_call_b64 s[36:37], LQSTAGE
LQ5:
    s_mov_b32 s31, 1
    s_add_u32 s39, s39, 786432
    v_bfe_u32 v40, v1, 2, 2
    v_lshlrev_b32 v2, 8, v40
    v_lshrrev_b32 v40, 4, v1
    v_lshl_add_u32 v2, v40, 6, v2
    v_and_b32 v40, 3, v1
    v_lshl_add_u32 v2, v40, 4, v2
    v_and_b32 v40, 1, v1
    v_lshlrev_b32 v40, 4, v40
    v_mov_b32 v41, 0xffff
    v_lshlrev_b32 v40, v40, v41
    s_mov_b32 s46, 0x03030303
    s_mov_b32 s47, 0x03030303
    v_cndmask_b32 v4, 0, v40, s[46:47]
    s_mov_b32 s46, 0x0c0c0c0c
    s_mov_b32 s47, 0x0c0c0c0c
    v_cndmask_b32 v5, 0, v40, s[46:47]
    s_mov_b32 s46, 0x30303030
    s_mov_b32 s47, 0x30303030
    v_cndmask_b32 v6, 0, v40, s[46:47]
    s_mov_b32 s46, 0xc0c0c0c0
    s_mov_b32 s47, 0xc0c0c0c0
    v_cndmask_b32 v7, 0, v40, s[46:47]
    s_mov_b32 s96, 512
    s_mov_b32 s91, 0
    s_mov_b32 s95, s97
    v_lshlrev_b32 v40, 2, v0
    v_add_u32 v40, 128000, v40
    ds_read_b32 v50, v40
    s_lshl_b32 s45, s25, 11
    s_add_u32 s45, s45, 36864
    v_bfe_u32 v32, v1, 3, 1
    v_lshlrev_b32 v32, 10, v32
    v_lshrrev_b32 v33, 4, v1
    v_lshl_add_u32 v32, v33, 8, v32
    v_bfe_u32 v33, v1, 1, 1
    v_lshl_add_u32 v32, v33, 7, v32
    v_and_b32 v33, 1, v1
    v_lshl_add_u32 v32, v33, 5, v32
    v_lshlrev_b32 v33, 2, v1
    v_add_u32 v33, 122880, v33
    s_waitcnt lgkmcnt(0)
    s_cmp_eq_u32 s24, 0
    s_cbranch_scc1 LQPOLL
    s_barrier
    ds_read_b32 v24, v33 offset:0
    ds_read_b32 v26, v33 offset:256
    ds_read_b32 v28, v33 offset:512
    ds_read_b32 v30, v33 offset:768
    s_waitcnt lgkmcnt(0)
    s_branch LQREADY2
LQSTAGE:
    ds_write_b128 v2, v[8:11]
    s_mov_b64 exec, 0xff
    ds_write_b128 v2, v[12:15] offset:1024
    s_mov_b64 exec, -1
    s_mov_b64 s[52:53], s[36:37]
    s_waitcnt lgkmcnt(1)
    s_call_b64 s[36:37], LLNG
    v_lshlrev_b32 v8, 2, v1
    v_mov_b32 v11, s29
    v_mov_b32_dpp v9, v60 quad_perm:[1,1,3,3] row_mask:0xf bank_mask:0xf
    v_cvt_pk_bf16_f32 v10, v60, v9
    s_mov_b64 exec, 0x5555
    buffer_store_dwordx2 v[10:11], v8, s[12:15], s54 offen sc1
    s_mov_b64 exec, -1
    s_setpc_b64 s[52:53]
LLNG:
    v_mov_b32 v44, 0
    v_mov_b32 v45, 0
    v_mov_b32 v46, 0
    v_mov_b32 v47, 0
    ds_read_b128 v[40:43], v2
    s_mov_b64 exec, 0xff
    ds_read_b128 v[44:47], v2 offset:1024
    s_mov_b64 exec, -1
    ds_read_b128 v[8:11], v57 offset:0
    ds_read_b64_tr_b16 v[12:13], v58 offset:0
    ds_read_b64_tr_b16 v[14:15], v58 offset:512
    ds_read_b128 v[16:19], v57 offset:64
    ds_read_b64_tr_b16 v[20:21], v58 offset:1024
    ds_read_b64_tr_b16 v[22:23], v58 offset:1536
    ds_read_b128 v[24:27], v57 offset:128
    ds_read_b64_tr_b16 v[28:29], v58 offset:2048
    ds_read_b64_tr_b16 v[30:31], v58 offset:2560
    ds_read_b128 v[32:35], v57 offset:192
    ds_read_b64_tr_b16 v[36:37], v58 offset:3072
    ds_read_b64_tr_b16 v[38:39], v58 offset:3584
    v_mov_b32 v48, 0
    v_mov_b32 v49, 0
    v_mov_b32 v52, 0x3f803f80
    s_waitcnt lgkmcnt(6)
    v_mfma_f32_16x16x32_bf16 v[60:63], v[8:11], v[12:15], 0
    v_mfma_f32_16x16x32_bf16 v[60:63], v[16:19], v[20:23], v[60:63]
    ds_read_b128 v[8:11], v57 offset:256
    ds_read_b64_tr_b16 v[12:13], v58 offset:4096
    ds_read_b64_tr_b16 v[14:15], v58 offset:4608
    ds_read_b128 v[16:19], v57 offset:320
    ds_read_b64_tr_b16 v[20:21], v58 offset:5120
    ds_read_b64_tr_b16 v[22:23], v58 offset:5632
    v_dot2c_f32_bf16 v48, v40, v52
    v_dot2c_f32_bf16 v49, v40, v40
    v_dot2c_f32_bf16 v48, v41, v52
    v_dot2c_f32_bf16 v49, v41, v41
    v_dot2c_f32_bf16 v48, v42, v52
    s_waitcnt lgkmcnt(6)
    v_mfma_f32_16x16x32_bf16 v[60:63], v[24:27], v[28:31], v[60:63]
    v_mfma_f32_16x16x32_bf16 v[60:63], v[32:35], v[36:39], v[60:63]
    ds_read_b128 v[24:27], v57 offset:384
    ds_read_b64_tr_b16 v[28:29], v58 offset:6144
    ds_read_b64_tr_b16 v[30:31], v58 offset:6656
    ds_read_b128 v[32:35], v57 offset:448
    ds_read_b64_tr_b16 v[36:37], v58 offset:7168
    ds_read_b64_tr_b16 v[38:39], v58 offset:7680
    v_dot2c_f32_bf16 v49, v42, v42
    v_dot2c_f32_bf16 v48, v43, v52
    v_dot2c_f32_bf16 v49, v43, v43
    v_dot2c_f32_bf16 v48, v44, v52
    v_dot2c_f32_bf16 v49, v44, v44
    s_waitcnt lgkmcnt(6)
    v_mfma_f32_16x16x32_bf16 v[60:63], v[8:11], v[12:15], v[60:63]
    v_mfma_f32_16x16x32_bf16 v[60:63], v[16:19], v[20:23], v[60:63]
    ds_read_b128 v[8:11], v57 offset:512
    ds_read_b64_tr_b16 v[12:13], v58 offset:8192
    ds_read_b64_tr_b16 v[14:15], v58 offset:8704
    ds_read_b128 v[16:19], v57 offset:576
    ds_read_b64_tr_b16 v[20:21], v58 offset:9216
    ds_read_b64_tr_b16 v[22:23], v58 offset:9728
    v_dot2c_f32_bf16 v48, v45, v52
    v_dot2c_f32_bf16 v49, v45, v45
    v_dot2c_f32_bf16 v48, v46, v52
    v_dot2c_f32_bf16 v49, v46, v46
    v_dot2c_f32_bf16 v48, v47, v52
    s_waitcnt lgkmcnt(6)
    v_mfma_f32_16x16x32_bf16 v[60:63], v[24:27], v[28:31], v[60:63]
    v_mfma_f32_16x16x32_bf16 v[60:63], v[32:35], v[36:39], v[60:63]
    ds_read_b128 v[24:27], v57 offset:640
    ds_read_b64_tr_b16 v[28:29], v58 offset:10240
    ds_read_b64_tr_b16 v[30:31], v58 offset:10752
    ds_read_b128 v[32:35], v57 offset:704
    ds_read_b64_tr_b16 v[36:37], v58 offset:11264
    ds_read_b64_tr_b16 v[38:39], v58 offset:11776
    v_dot2c_f32_bf16 v49, v47, v47
    s_nop 1
    v_add_f32_dpp v48, v48, v48 quad_perm:[1,0,3,2] row_mask:0xf bank_mask:0xf
    v_add_f32_dpp v49, v49, v49 quad_perm:[1,0,3,2] row_mask:0xf bank_mask:0xf
    s_nop 0
    v_add_f32_dpp v48, v48, v48 quad_perm:[2,3,0,1] row_mask:0xf bank_mask:0xf
    s_waitcnt lgkmcnt(6)
    v_mfma_f32_16x16x32_bf16 v[60:63], v[8:11], v[12:15], v[60:63]
    v_mfma_f32_16x16x32_bf16 v[60:63], v[16:19], v[20:23], v[60:63]
    ds_read_b128 v[8:11], v57 offset:768
    ds_read_b64_tr_b16 v[12:13], v58 offset:12288
    ds_read_b64_tr_b16 v[14:15], v58 offset:12800
    ds_read_b128 v[16:19], v57 offset:832
    ds_read_b64_tr_b16 v[20:21], v58 offset:13312
    ds_read_b64_tr_b16 v[22:23], v58 offset:13824
    v_add_f32_dpp v49, v49, v49 quad_perm:[2,3,0,1] row_mask:0xf bank_mask:0xf
    v_add_f32_dpp v48, v48, v48 row_half_mirror row_mask:0xf bank_mask:0xf
    s_nop 0
    v_add_f32_dpp v49, v49, v49 row_half_mirror row_mask:0xf bank_mask:0xf
    v_add_f32_dpp v48, v48, v48 row_mirror row_mask:0xf bank_mask:0xf
    s_nop 0
    v_add_f32_dpp v49, v49, v49 row_mirror row_mask:0xf bank_mask:0xf
    s_waitcnt lgkmcnt(6)
    v_mfma_f32_16x16x32_bf16 v[60:63], v[24:27], v[28:31], v[60:63]
    v_mfma_f32_16x16x32_bf16 v[60:63], v[32:35], v[36:39], v[60:63]
    ds_read_b128 v[24:27], v57 offset:896
    ds_read_b64_tr_b16 v[28:29], v58 offset:14336
    ds_read_b64_tr_b16 v[30:31], v58 offset:14848
    ds_read_b128 v[32:35], v57 offset:960
    ds_read_b64_tr_b16 v[36:37], v58 offset:15360
    ds_read_b64_tr_b16 v[38:39], v58 offset:15872
    v_permlane16_swap_b32 v48, v49
    v_add_f32 v48, v48, v49
    v_mov_b32 v50, v48
    s_nop 1
    v_permlane32_swap_b32 v48, v50
    v_add_f32 v48, v48, v50
    s_waitcnt lgkmcnt(6)
    v_mfma_f32_16x16x32_bf16 v[60:63], v[8:11], v[12:15], v[60:63]
    v_mfma_f32_16x16x32_bf16 v[60:63], v[16:19], v[20:23], v[60:63]
    ds_read_b128 v[8:11], v57 offset:1024
    ds_read_b64_tr_b16 v[12:13], v58 offset:16384
    ds_read_b64_tr_b16 v[14:15], v58 offset:16896
    ds_read_b128 v[16:19], v57 offset:1088
    ds_read_b64_tr_b16 v[20:21], v58 offset:17408
    ds_read_b64_tr_b16 v[22:23], v58 offset:17920
    v_mul_f32 v48, 0x3ae38e39, v48
    v_mov_b32 v49, v48
    s_nop 1
    v_permlane16_swap_b32 v48, v49
    v_fma_f32 v49, -v48, v48, v49
    v_max_f32 v49, 0, v49
    s_waitcnt lgkmcnt(6)
    v_mfma_f32_16x16x32_bf16 v[60:63], v[24:27], v[28:31], v[60:63]
    v_mfma_f32_16x16x32_bf16 v[60:63], v[32:35], v[36:39], v[60:63]
    v_cvt_pk_bf16_f32 v49, v48, v49
    v_lshlrev_b32 v48, 16, v49
    v_and_b32 v49, 0xffff0000, v49
    v_add_f32 v49, 0x3727c5ac, v49
    v_cvt_pk_bf16_f32 v49, v49, v49
    s_waitcnt lgkmcnt(0)
    v_mfma_f32_16x16x32_bf16 v[60:63], v[8:11], v[12:15], v[60:63]
    v_mfma_f32_16x16x32_bf16 v[60:63], v[16:19], v[20:23], v[60:63]
    v_and_b32 v49, 0xffff0000, v49
    v_sqrt_f32 v49, v49
    s_nop 0
    v_cvt_pk_bf16_f32 v49, v49, v49
    v_and_b32 v49, 0xffff0000, v49
    v_rcp_f32 v49, v49
    s_nop 1
    v_fma_f32 v60, -v48, v61, v60
    v_mul_f32 v60, v60, v49
    s_nop 1
    s_setpc_b64 s[36:37]
LRING0:
    s_mov_b32 s3, 0
    s_waitcnt lgkmcnt(0)
    s_cmp_lt_u32 s91, s92
    s_cbranch_scc0 Lpool_27
    v_readlane_b32 s32, v50, s91
    s_add_u32 s91, s91, 1
    s_nop 3
    s_branch Lgo_28
Lpool_27:
    s_cmp_ge_u32 s90, s55
    s_cbranch_scc1 LRINGX
    s_cmp_ge_u32 s101, s37
    s_cbranch_scc1 LRINGX
    s_cmp_lt_u32 s90, s96
    s_cbranch_scc1 Ltok_34
    s_cmp_lg_u32 s63, 0
    s_cbranch_scc1 LDRAINE0
    s_add_u32 s63, s63, 1
    s_mov_b32 s62, 0
    s_xor_b32 s61, s61, 8192
    s_mov_b32 s90, 1
    s_lshr_b32 s59, s61, 11
    s_atomic_add s90, s[88:89], s59 glc
    s_waitcnt lgkmcnt(0)
    s_cmp_lt_u32 s90, s96
    s_cbranch_scc0 LDRAINE0
Ltok_34:
    s_cmp_ge_u32 s90, s60
    s_cselect_b32 s32, s56, 0
    s_add_u32 s32, s32, s90
    s_lshl_b32 s33, s32, 6
    s_xor_b32 s33, s33, s61
    s_and_b32 s33, s33, s99
    s_lshl_b32 s32, s32, s98
    s_add_u32 s32, s32, s33
    s_bitset0_b32 s97, 0
    s_cmp_ge_u32 s90, s54
    s_cbranch_scc0 Lnoapp_32
    s_bitset1_b32 s97, 0
    s_mov_b32 m0, s94
    s_nop 0
    v_writelane_b32 v50, s32, m0
    s_add_u32 s94, s94, 1
    s_cmp_lt_u32 s94, 60
    s_cbranch_scc1 Lnoapp_32
    s_mov_b32 s90, 0x7fffffff
    s_add_u32 s63, s63, 1
    s_branch Lgo_33
Lnoapp_32:
    s_xor_b32 s61, s61, s62
    s_mov_b32 s90, 1
    s_lshr_b32 s59, s61, 11
    s_atomic_add s90, s[88:89], s59 glc
Lgo_33:
Lgo_28:
    s_mov_b32 s34, s32
    s_xor_b32 s35, s34, 4096
    s_xor_b32 s33, s32, 4096
    s_add_u32 s101, s101, 1
    s_bitcmp1_b32 s95, 0
    s_cbranch_scc0 Lbonly_30
    s_waitcnt vmcnt(14)
    v_mfma_f32_16x16x32_bf16 v[24:27], v[64:67], v[8:11], 0
    v_mfma_f32_16x16x32_bf16 v[24:27], v[68:71], v[12:15], v[24:27]
    s_waitcnt vmcnt(8)
    buffer_load_dwordx4 v[64:67], v2, s[4:7], s32 offen offset:0 nt
    buffer_load_dwordx4 v[68:71], v2, s[4:7], s32 offen offset:1024 nt
    s_waitcnt vmcnt(14)
    v_mfma_f32_16x16x32_bf16 v[28:31], v[72:75], v[8:11], 0
    v_mfma_f32_16x16x32_bf16 v[28:31], v[76:79], v[12:15], v[28:31]
    s_waitcnt vmcnt(8)
    buffer_load_dwordx4 v[72:75], v2, s[4:7], s32 offen offset:2048 nt
    buffer_load_dwordx4 v[76:79], v2, s[4:7], s32 offen offset:3072 nt
    s_waitcnt vmcnt(14)
    v_mfma_f32_16x16x32_bf16 v[32:35], v[80:83], v[8:11], 0
    v_mfma_f32_16x16x32_bf16 v[32:35], v[84:87], v[12:15], v[32:35]
    s_waitcnt vmcnt(8)
    buffer_load_dwordx4 v[80:83], v2, s[4:7], s33 offen offset:0 nt
    buffer_load_dwordx4 v[84:87], v2, s[4:7], s33 offen offset:1024 nt
    s_waitcnt vmcnt(14)
    v_mfma_f32_16x16x32_bf16 v[36:39], v[88:91], v[8:11], 0
    v_mfma_f32_16x16x32_bf16 v[36:39], v[92:95], v[12:15], v[36:39]
    s_waitcnt vmcnt(8)
    buffer_load_dwordx4 v[88:91], v2, s[4:7], s33 offen offset:2048 nt
    buffer_load_dwordx4 v[92:95], v2, s[4:7], s33 offen offset:3072 nt
    v_mov_b32_dpp v40, v24 quad_perm:[0,0,0,0] row_mask:0xf bank_mask:0xf
    v_mov_b32_dpp v41, v28 quad_perm:[0,0,0,0] row_mask:0xf bank_mask:0xf
    v_mov_b32_dpp v42, v32 quad_perm:[0,0,0,0] row_mask:0xf bank_mask:0xf
    v_add_f32_dpp v40, v25, v40 quad_perm:[1,1,1,1] row_mask:0xf bank_mask:0xf
    v_add_f32_dpp v41, v29, v41 quad_perm:[1,1,1,1] row_mask:0xf bank_mask:0xf
    v_add_f32_dpp v42, v33, v42 quad_perm:[1,1,1,1] row_mask:0xf bank_mask:0xf
    v_add_f32_dpp v40, v26, v40 quad_perm:[2,2,2,2] row_mask:0xf bank_mask:0xf
    v_add_f32_dpp v41, v30, v41 quad_perm:[2,2,2,2] row_mask:0xf bank_mask:0xf
    v_mov_b32_dpp v43, v36 quad_perm:[0,0,0,0] row_mask:0xf bank_mask:0xf
    v_add_f32_dpp v42, v34, v42 quad_perm:[2,2,2,2] row_mask:0xf bank_mask:0xf
    v_add_f32_dpp v40, v27, v40 quad_perm:[3,3,3,3] row_mask:0xf bank_mask:0xf
    v_add_f32_dpp v43, v37, v43 quad_perm:[1,1,1,1] row_mask:0xf bank_mask:0xf
    v_add_f32_dpp v41, v31, v41 quad_perm:[3,3,3,3] row_mask:0xf bank_mask:0xf
    v_add_f32_dpp v42, v35, v42 quad_perm:[3,3,3,3] row_mask:0xf bank_mask:0xf
    v_add_f32_dpp v43, v38, v43 quad_perm:[2,2,2,2] row_mask:0xf bank_mask:0xf
    v_max3_f32 v44, v40, v41, v20
    s_nop 0
    v_add_f32_dpp v43, v39, v43 quad_perm:[3,3,3,3] row_mask:0xf bank_mask:0xf
    v_max3_f32 v44, v44, v42, v43
    s_nop 1
    v_max_f32_dpp v44, v44, v44 row_half_mirror row_mask:0xf bank_mask:0xf
    v_mov_b32 v45, v44
    s_nop 1
    v_permlane16_swap_b32 v44, v45
    v_max_f32 v44, v44, v45
    v_mov_b32 v45, v44
    s_nop 1
    v_permlane32_swap_b32 v44, v45
    v_max_f32 v44, v44, v45
    v_sub_f32 v45, v20, v44
    v_mul_f32 v45, s30, v45
    v_exp_f32 v45, v45
    v_mov_b32 v20, v44
    v_mul_f32 v22, s30, v44
    v_fma_f32 v40, v40, s30, -v22
    v_fma_f32 v41, v41, s30, -v22
    v_fma_f32 v42, v42, s30, -v22
    v_fma_f32 v43, v43, s30, -v22
    v_exp_f32 v40, v40
    v_exp_f32 v41, v41
    v_exp_f32 v42, v42
    v_exp_f32 v43, v43
    v_mul_f32 v21, v21, v45
    v_mul_f32 v16, v16, v45
    v_mul_f32 v17, v17, v45
    v_mul_f32 v18, v18, v45
    v_mul_f32 v19, v19, v45
    v_add_f32 v46, v40, v41
    v_add_f32 v47, v42, v43
    v_cvt_pk_bf16_f32 v40, v40, v40
    v_cvt_pk_bf16_f32 v41, v41, v41
    v_cvt_pk_bf16_f32 v42, v42, v42
    v_cvt_pk_bf16_f32 v43, v43, v43
    v_add_f32 v46, v46, v47
    v_add_f32 v21, v21, v46
    v_and_b32 v24, v40, v4
    v_and_b32 v25, v40, v5
    v_and_b32_dpp v26, v40, v6 row_shr:4 row_mask:0xf bank_mask:0xf bound_ctrl:1
    v_and_b32_dpp v27, v40, v7 row_shr:4 row_mask:0xf bank_mask:0xf bound_ctrl:1
    v_and_b32_dpp v28, v40, v4 row_shl:4 row_mask:0xf bank_mask:0xf bound_ctrl:1
    v_and_b32_dpp v29, v40, v5 row_shl:4 row_mask:0xf bank_mask:0xf bound_ctrl:1
    v_and_b32 v30, v40, v6
    v_and_b32 v31, v40, v7
    s_waitcnt vmcnt(15)
    v_mfma_f32_16x16x32_bf16 v[16:19], v[96:99], v[24:27], v[16:19]
    s_waitcnt vmcnt(8)
    buffer_load_dwordx4 v[96:99], v3, s[8:11], s34 offen offset:0
    v_and_b32 v32, v41, v4
    v_and_b32 v33, v41, v5
    v_and_b32_dpp v34, v41, v6 row_shr:4 row_mask:0xf bank_mask:0xf bound_ctrl:1
    v_and_b32_dpp v35, v41, v7 row_shr:4 row_mask:0xf bank_mask:0xf bound_ctrl:1
    s_waitcnt vmcnt(15)
    v_mfma_f32_16x16x32_bf16 v[16:19], v[100:103], v[28:31], v[16:19]
    buffer_load_dwordx4 v[100:103], v3, s[8:11], s34 offen offset:1024
    v_and_b32_dpp v36, v41, v4 row_shl:4 row_mask:0xf bank_mask:0xf bound_ctrl:1
    v_and_b32_dpp v37, v41, v5 row_shl:4 row_mask:0xf bank_mask:0xf bound_ctrl:1
    v_and_b32 v38, v41, v6
    v_and_b32 v39, v41, v7
    s_waitcnt vmcnt(15)
    v_mfma_f32_16x16x32_bf16 v[16:19], v[104:107], v[32:35], v[16:19]
    s_waitcnt vmcnt(8)
    buffer_load_dwordx4 v[104:107], v3, s[8:11], s34 offen offset:2048
    v_and_b32 v24, v42, v4
    v_and_b32 v25, v42, v5
    v_and_b32_dpp v26, v42, v6 row_shr:4 row_mask:0xf bank_mask:0xf bound_ctrl:1
    v_and_b32_dpp v27, v42, v7 row_shr:4 row_mask:0xf bank_mask:0xf bound_ctrl:1
    s_waitcnt vmcnt(15)
    v_mfma_f32_16x16x32_bf16 v[16:19], v[108:111], v[36:39], v[16:19]
    buffer_load_dwordx4 v[108:111], v3, s[8:11], s34 offen offset:3072
    v_and_b32_dpp v28, v42, v4 row_shl:4 row_mask:0xf bank_mask:0xf bound_ctrl:1
    v_and_b32_dpp v29, v42, v5 row_shl:4 row_mask:0xf bank_mask:0xf bound_ctrl:1
    v_and_b32 v30, v42, v6
    v_and_b32 v31, v42, v7
    s_waitcnt vmcnt(15)
    v_mfma_f32_16x16x32_bf16 v[16:19], v[112:115], v[24:27], v[16:19]
    s_waitcnt vmcnt(8)
    buffer_load_dwordx4 v[112:115], v3, s[8:11], s35 offen offset:0
    v_and_b32 v32, v43, v4
    v_and_b32 v33, v43, v5
    v_and_b32_dpp v34, v43, v6 row_shr:4 row_mask:0xf bank_mask:0xf bound_ctrl:1
    v_and_b32_dpp v35, v43, v7 row_shr:4 row_mask:0xf bank_mask:0xf bound_ctrl:1
    s_waitcnt vmcnt(15)
    v_mfma_f32_16x16x32_bf16 v[16:19], v[116:119], v[28:31], v[16:19]
    buffer_load_dwordx4 v[116:119], v3, s[8:11], s35 offen offset:1024
    v_and_b32_dpp v36, v43, v4 row_shl:4 row_mask:0xf bank_mask:0xf bound_ctrl:1
    v_and_b32_dpp v37, v43, v5 row_shl:4 row_mask:0xf bank_mask:0xf bound_ctrl:1
    v_and_b32 v38, v43, v6
    v_and_b32 v39, v43, v7
    s_waitcnt vmcnt(15)
    v_mfma_f32_16x16x32_bf16 v[16:19], v[120:123], v[32:35], v[16:19]
    s_waitcnt vmcnt(8)
    buffer_load_dwordx4 v[120:123], v3, s[8:11], s35 offen offset:2048
    s_waitcnt vmcnt(15)
    v_mfma_f32_16x16x32_bf16 v[16:19], v[124:127], v[36:39], v[16:19]
    buffer_load_dwordx4 v[124:127], v3, s[8:11], s35 offen offset:3072
    s_nop 6
    s_branch LRING0
Lbonly_30:
    s_bitset1_b32 s95, 0
    buffer_load_dwordx4 v[64:67], v2, s[4:7], s32 offen offset:0 nt
    buffer_load_dwordx4 v[68:71], v2, s[4:7], s32 offen offset:1024 nt
    buffer_load_dwordx4 v[72:75], v2, s[4:7], s32 offen offset:2048 nt
    buffer_load_dwordx4 v[76:79], v2, s[4:7], s32 offen offset:3072 nt
    buffer_load_dwordx4 v[80:83], v2, s[4:7], s33 offen offset:0 nt
    buffer_load_dwordx4 v[84:87], v2, s[4:7], s33 offen offset:1024 nt
    buffer_load_dwordx4 v[88:91], v2, s[4:7], s33 offen offset:2048 nt
    buffer_load_dwordx4 v[92:95], v2, s[4:7], s33 offen offset:3072 nt
    buffer_load_dwordx4 v[96:99], v3, s[8:11], s34 offen offset:0
    buffer_load_dwordx4 v[100:103], v3, s[8:11], s34 offen offset:1024
    buffer_load_dwordx4 v[104:107], v3, s[8:11], s34 offen offset:2048
    buffer_load_dwordx4 v[108:111], v3, s[8:11], s34 offen offset:3072
    buffer_load_dwordx4 v[112:115], v3, s[8:11], s35 offen offset:0
    buffer_load_dwordx4 v[116:119], v3, s[8:11], s35 offen offset:1024
    buffer_load_dwordx4 v[120:123], v3, s[8:11], s35 offen offset:2048
    buffer_load_dwordx4 v[124:127], v3, s[8:11], s35 offen offset:3072
    s_branch LRING0
LRINGX:
    s_cmp_eq_u32 s36, 1
    s_cbranch_scc1 LRET1
    s_cmp_eq_u32 s36, 2
    s_cbranch_scc1 LRET2
    s_cmp_eq_u32 s36, 3
    s_cbranch_scc1 LRET3
    s_cmp_eq_u32 s36, 4
    s_cbranch_scc1 LRET4
    s_cmp_eq_u32 s36, 5
    s_cbranch_scc1 LRET5
    s_cmp_eq_u32 s36, 6
    s_cbranch_scc1 LRET6
    s_cmp_eq_u32 s36, 7
    s_cbranch_scc1 LRET7
    s_cmp_eq_u32 s36, 8
    s_cbranch_scc1 LRET8
    s_cmp_eq_u32 s36, 9
    s_cbranch_scc1 LRET9
    s_cmp_eq_u32 s36, 10
    s_cbranch_scc1 LRET10
    s_cmp_eq_u32 s36, 11
    s_cbranch_scc1 LRET11
    s_cmp_eq_u32 s36, 12
    s_cbranch_scc1 LRET12
    s_cmp_eq_u32 s36, 13
    s_cbranch_scc1 LRET13
    s_branch LRET14
LDRAINE0:
    v_mov_b32 v48, 0
    buffer_load_dword v49, v48, s[20:23], 0 offen sc1
    s_mov_b32 s93, 0
    s_mov_b64 s[98:99], 0
    s_atomic_add_x2 s[98:99], s[88:89], 16 glc
    s_bcnt1_i32_b32 s44, s97
    s_sub_u32 s92, s94, s44
    s_branch LDRAIN0
LDRAIN0:
    s_bitcmp1_b32 s95, 0
    s_cbranch_scc0 Ldsk_35
    s_waitcnt vmcnt(15)
    v_mfma_f32_16x16x32_bf16 v[24:27], v[64:67], v[8:11], 0
    v_mfma_f32_16x16x32_bf16 v[24:27], v[68:71], v[12:15], v[24:27]
    s_waitcnt vmcnt(13)
    v_mfma_f32_16x16x32_bf16 v[28:31], v[72:75], v[8:11], 0
    v_mfma_f32_16x16x32_bf16 v[28:31], v[76:79], v[12:15], v[28:31]
    s_waitcnt vmcnt(11)
    v_mfma_f32_16x16x32_bf16 v[32:35], v[80:83], v[8:11], 0
    v_mfma_f32_16x16x32_bf16 v[32:35], v[84:87], v[12:15], v[32:35]
    s_waitcnt vmcnt(9)
    v_mfma_f32_16x16x32_bf16 v[36:39], v[88:91], v[8:11], 0
    v_mfma_f32_16x16x32_bf16 v[36:39], v[92:95], v[12:15], v[36:39]
    v_mov_b32_dpp v40, v24 quad_perm:[0,0,0,0] row_mask:0xf bank_mask:0xf
    s_nop 0
    v_mov_b32_dpp v41, v28 quad_perm:[0,0,0,0] row_mask:0xf bank_mask:0xf
    s_nop 1
    v_mov_b32_dpp v42, v32 quad_perm:[0,0,0,0] row_mask:0xf bank_mask:0xf
    v_add_f32_dpp v40, v25, v40 quad_perm:[1,1,1,1] row_mask:0xf bank_mask:0xf
    v_add_f32_dpp v41, v29, v41 quad_perm:[1,1,1,1] row_mask:0xf bank_mask:0xf
    v_add_f32_dpp v42, v33, v42 quad_perm:[1,1,1,1] row_mask:0xf bank_mask:0xf
    v_add_f32_dpp v40, v26, v40 quad_perm:[2,2,2,2] row_mask:0xf bank_mask:0xf
    v_add_f32_dpp v41, v30, v41 quad_perm:[2,2,2,2] row_mask:0xf bank_mask:0xf
    v_mov_b32_dpp v43, v36 quad_perm:[0,0,0,0] row_mask:0xf bank_mask:0xf
    v_add_f32_dpp v42, v34, v42 quad_perm:[2,2,2,2] row_mask:0xf bank_mask:0xf
    v_add_f32_dpp v40, v27, v40 quad_perm:[3,3,3,3] row_mask:0xf bank_mask:0xf
    v_add_f32_dpp v43, v37, v43 quad_perm:[1,1,1,1] row_mask:0xf bank_mask:0xf
    v_add_f32_dpp v41, v31, v41 quad_perm:[3,3,3,3] row_mask:0xf bank_mask:0xf
    v_add_f32_dpp v42, v35, v42 quad_perm:[3,3,3,3] row_mask:0xf bank_mask:0xf
    v_add_f32_dpp v43, v38, v43 quad_perm:[2,2,2,2] row_mask:0xf bank_mask:0xf
    v_max3_f32 v44, v40, v41, v20
    s_nop 0
    v_add_f32_dpp v43, v39, v43 quad_perm:[3,3,3,3] row_mask:0xf bank_mask:0xf
    v_max3_f32 v44, v44, v42, v43
    s_nop 1
    v_max_f32_dpp v44, v44, v44 row_half_mirror row_mask:0xf bank_mask:0xf
    v_mov_b32 v45, v44
    s_nop 1
    v_permlane16_swap_b32 v44, v45
    v_max_f32 v44, v44, v45
    v_mov_b32 v45, v44
    s_nop 1
    v_permlane32_swap_b32 v44, v45
    v_max_f32 v44, v44, v45
    v_sub_f32 v45, v20, v44
    v_mul_f32 v45, s30, v45
    v_exp_f32 v45, v45
    v_mov_b32 v20, v44
    v_mul_f32 v22, s30, v44
    v_fma_f32 v40, v40, s30, -v22
    v_fma_f32 v41, v41, s30, -v22
    v_fma_f32 v42, v42, s30, -v22
    v_fma_f32 v43, v43, s30, -v22
    v_exp_f32 v40, v40
    v_exp_f32 v41, v41
    v_exp_f32 v42, v42
    v_exp_f32 v43, v43
    v_mul_f32 v21, v21, v45
    v_mul_f32 v16, v16, v45
    v_mul_f32 v17, v17, v45
    v_mul_f32 v18, v18, v45
    v_mul_f32 v19, v19, v45
    v_add_f32 v46, v40, v41
    v_add_f32 v47, v42, v43
    v_cvt_pk_bf16_f32 v40, v40, v40
    v_cvt_pk_bf16_f32 v41, v41, v41
    v_cvt_pk_bf16_f32 v42, v42, v42
    v_cvt_pk_bf16_f32 v43, v43, v43
    v_add_f32 v46, v46, v47
    v_add_f32 v21, v21, v46
    v_and_b32 v24, v40, v4
    v_and_b32 v25, v40, v5
    v_and_b32_dpp v26, v40, v6 row_shr:4 row_mask:0xf bank_mask:0xf bound_ctrl:1
    v_and_b32_dpp v27, v40, v7 row_shr:4 row_mask:0xf bank_mask:0xf bound_ctrl:1
    v_and_b32_dpp v28, v40, v4 row_shl:4 row_mask:0xf bank_mask:0xf bound_ctrl:1
    v_and_b32_dpp v29, v40, v5 row_shl:4 row_mask:0xf bank_mask:0xf bound_ctrl:1
    v_and_b32 v30, v40, v6
    v_and_b32 v31, v40, v7
    s_waitcnt vmcnt(8)
    v_mfma_f32_16x16x32_bf16 v[16:19], v[96:99], v[24:27], v[16:19]
    v_and_b32 v32, v41, v4
    v_and_b32 v33, v41, v5
    v_and_b32_dpp v34, v41, v6 row_shr:4 row_mask:0xf bank_mask:0xf bound_ctrl:1
    v_and_b32_dpp v35, v41, v7 row_shr:4 row_mask:0xf bank_mask:0xf bound_ctrl:1
    s_waitcnt vmcnt(7)
    v_mfma_f32_16x16x32_bf16 v[16:19], v[100:103], v[28:31], v[16:19]
    v_and_b32_dpp v36, v41, v4 row_shl:4 row_mask:0xf bank_mask:0xf bound_ctrl:1
    v_and_b32_dpp v37, v41, v5 row_shl:4 row_mask:0xf bank_mask:0xf bound_ctrl:1
    v_and_b32 v38, v41, v6
    v_and_b32 v39, v41, v7
    s_waitcnt vmcnt(6)
    v_mfma_f32_16x16x32_bf16 v[16:19], v[104:107], v[32:35], v[16:19]
    v_and_b32 v24, v42, v4
    v_and_b32 v25, v42, v5
    v_and_b32_dpp v26, v42, v6 row_shr:4 row_mask:0xf bank_mask:0xf bound_ctrl:1
    v_and_b32_dpp v27, v42, v7 row_shr:4 row_mask:0xf bank_mask:0xf bound_ctrl:1
    s_waitcnt vmcnt(5)
    v_mfma_f32_16x16x32_bf16 v[16:19], v[108:111], v[36:39], v[16:19]
    v_and_b32_dpp v28, v42, v4 row_shl:4 row_mask:0xf bank_mask:0xf bound_ctrl:1
    v_and_b32_dpp v29, v42, v5 row_shl:4 row_mask:0xf bank_mask:0xf bound_ctrl:1
    v_and_b32 v30, v42, v6
    v_and_b32 v31, v42, v7
    s_waitcnt vmcnt(4)
    v_mfma_f32_16x16x32_bf16 v[16:19], v[112:115], v[24:27], v[16:19]
    v_and_b32 v32, v43, v4
    v_and_b32 v33, v43, v5
    v_and_b32_dpp v34, v43, v6 row_shr:4 row_mask:0xf bank_mask:0xf bound_ctrl:1
    v_and_b32_dpp v35, v43, v7 row_shr:4 row_mask:0xf bank_mask:0xf bound_ctrl:1
    s_waitcnt vmcnt(3)
    v_mfma_f32_16x16x32_bf16 v[16:19], v[116:119], v[28:31], v[16:19]
    v_and_b32_dpp v36, v43, v4 row_shl:4 row_mask:0xf bank_mask:0xf bound_ctrl:1
    v_and_b32_dpp v37, v43, v5 row_shl:4 row_mask:0xf bank_mask:0xf bound_ctrl:1
    v_and_b32 v38, v43, v6
    v_and_b32 v39, v43, v7
    s_waitcnt vmcnt(2)
    v_mfma_f32_16x16x32_bf16 v[16:19], v[120:123], v[32:35], v[16:19]
    s_waitcnt vmcnt(1)
    v_mfma_f32_16x16x32_bf16 v[16:19], v[124:127], v[36:39], v[16:19]
    s_nop 7
Ldsk_35:
    s_add_u32 s93, s93, 1
    s_cmp_eq_u32 s93, 1
    s_cbranch_scc1 LPASSEND
    s_branch LDRAIN0
LDONE:
LEND:
    s_endpgm
.section .rodata,"a"
.p2align 6
.amdhsa_kernel interleave_layers__gqa_block_cached__glu_gated_reglu__decode_kernel
  .amdhsa_next_free_vgpr 512
  .amdhsa_next_free_sgpr 102
  .amdhsa_accum_offset 256
  .amdhsa_group_segment_fixed_size 0
  .amdhsa_kernarg_size 96
  .amdhsa_user_sgpr_count 2
  .amdhsa_user_sgpr_kernarg_segment_ptr 1
  .amdhsa_system_sgpr_workgroup_id_x 1
.end_amdhsa_kernel
```
